```python
import torch

def _softmax(x, axis=-1):
    return torch.softmax(x, dim=axis)
def _gelu(x):
    return torch.nn.functional.gelu(x, approximate="tanh")
def _silu(x):
    return torch.nn.functional.silu(x)
def _sigmoid(x):
    return torch.sigmoid(x)
def _layernorm(x, axis=-1, eps=1e-5):
    m = x.mean(dim=axis, keepdim=True)
    v = x.var(dim=axis, keepdim=True, unbiased=False)
    return (x - m) / torch.sqrt(v + eps)
def _scatter_add(tgt, idx, src, axis=0):
    return tgt.clone().index_add_(axis, idx, src)
def _segment_sum(src, seg, n):
    out = torch.zeros((n,) + src.shape[1:], dtype=src.dtype)
    return out.index_add_(0, seg, src)
def _pad(x, pw):
    flat = tuple(v for pair in reversed(pw) for v in pair)
    return torch.nn.functional.pad(x, flat)

kernel_name = 'parallel_sum__sliding_block__mixer_channel_mlp__prompt'

def setup_inputs():

    _w = (lambda a: (lambda t: t.to(torch.bfloat16) if t.is_floating_point() else t)(torch.as_tensor(a)))
    def _A_setup():
        B, S, D = 1, 2048, 640
        return {
            "x": _w((lambda *s: torch.randn(*s, dtype=torch.bfloat16) * 0.05)(B, S, D)),
            "wqkv": _w((lambda *s: torch.randn(*s, dtype=torch.bfloat16) * 0.05)(D, 3 * D)),
            "wo": _w((lambda *s: torch.randn(*s, dtype=torch.bfloat16) * 0.05)(D, D)),
        }
    _A_in = _A_setup()

    def _B_setup():
        B, S, D, F = 1, 2048, 640, 1536
        return {
            "x": _w((lambda *s: torch.randn(*s, dtype=torch.bfloat16) * 0.05)(B, S, D)),
            "w1": _w((lambda *s: torch.randn(*s, dtype=torch.bfloat16) * 0.8)(D, F) * (D ** -0.5)),
            "b1": _w((lambda *s: torch.randn(*s, dtype=torch.bfloat16) * 0.8)(F)),
            "w2": _w((lambda *s: torch.randn(*s, dtype=torch.bfloat16) * 0.8)(F, D) * (F ** -0.5)),
            "b2": _w((lambda *s: torch.randn(*s, dtype=torch.bfloat16) * 0.4)(D)),
        }
    _B_in = _B_setup()

    return {
        "A_x": _A_in["x"],
        "A_wqkv": _A_in["wqkv"],
        "A_wo": _A_in["wo"],
        "B_x": _B_in["x"],
        "B_w1": _B_in["w1"],
        "B_b1": _B_in["b1"],
        "B_w2": _B_in["w2"],
        "B_b2": _B_in["b2"],
    }

def reference(A_x, A_wqkv, A_wo, B_x, B_w1, B_b1, B_w2, B_b2):
    def _A_ref(x, wqkv, wo):
        B, S, D = x.shape
        H = 32; Dh = D // H; W = 256
        qkv = (lambda x, *d: x.permute(*d))((x @ wqkv).reshape(B, S, 3, H, Dh), 2, 0, 3, 1, 4)
        q, k, v = qkv[0], qkv[1], qkv[2]
        scores = torch.einsum("bhqd,bhkd->bhqk", q, k) * (Dh ** -0.5)
        idx = torch.arange(S)
        mask = (idx[:, None] - idx[None, :] >= 0) & (idx[:, None] - idx[None, :] < W)
        scores = torch.where(mask[None, None], scores, -1e9)
        p = _softmax(scores, axis=-1)
        o = torch.einsum("bhqk,bhkd->bhqd", p, v)
        return (lambda x, *d: x.permute(*d))(o, 0, 2, 1, 3).reshape(B, S, D) @ wo

    def _B_ref(x, w1, b1, w2, b2):
        y = _layernorm(x, axis=-1)
        h = _gelu(torch.einsum("bsd,df->bsf", y, w1) + b1)
        return torch.einsum("bsf,fd->bsd", h, w2) + b2

    x = A_x
    xn = _layernorm(x, axis=-1)
    return x + _A_ref(xn, A_wqkv, A_wo) + _B_ref(xn, B_w1, B_b1, B_w2, B_b2)
```

```asm
; @launch grid=(256,1,1) block=(512,1,1) lds=162816
.amdgcn_target "amdgcn-amd-amdhsa--gfx950"
.text
.globl parallel_sum__sliding_block__mixer_channel_mlp__prompt_kernel
.p2align 8
.type parallel_sum__sliding_block__mixer_channel_mlp__prompt_kernel,@function
parallel_sum__sliding_block__mixer_channel_mlp__prompt_kernel:
    s_cmp_ge_u32 s2, 256
    s_cbranch_scc1 Lend
    s_load_dwordx16 s[64:79], s[0:1], 0
    s_load_dwordx4 s[80:83], s[0:1], 64
    s_load_dwordx2 s[84:85], s[0:1], 80
    v_lshrrev_b32 v2, 6, v0
    v_and_b32 v1, 63, v0
    s_nop 0
    v_readfirstlane_b32 s3, v2
    s_getpc_b64 s[40:41]
pf_1_pc:
    s_sub_u32 s40, s40, pf_1_pc-parallel_sum__sliding_block__mixer_channel_mlp__prompt_kernel
    s_subb_u32 s41, s41, 0
    s_lshr_b32 s42, s2, 3
    s_lshl_b32 s42, s42, 11
    s_cmp_ge_u32 s42, Lcode_end-parallel_sum__sliding_block__mixer_channel_mlp__prompt_kernel
    s_cbranch_scc1 pf_1
    v_lshlrev_b32 v2, 2, v0
    v_add_u32 v2, s42, v2
    global_load_dword v240, v2, s[40:41]
pf_1:
    s_mov_b32 s86, 0
    s_mov_b32 s60, 0
    s_and_b32 s40, s2, 7
    s_lshr_b32 s41, s2, 3
    s_and_b32 s42, s40, 1
    s_lshr_b32 s43, s40, 1
    s_cmp_lt_u32 s43, 3
    s_cselect_b32 s44, 28, 24
    s_cmp_lt_u32 s41, s44
    s_cbranch_scc1 Lp1_gemm
    s_sub_u32 s45, s41, s44
    s_cmp_lt_u32 s40, 6
    s_cbranch_scc0 Lp1_side2
    s_lshl_b32 s12, s40, 2
    s_add_u32 s12, s12, s45
    s_branch Lside
Lp1_side2:
    s_sub_u32 s12, s40, 6
    s_lshl_b32 s12, s12, 3
    s_add_u32 s12, s12, 24
    s_add_u32 s12, s12, s45
    s_branch Lside
Lp1_gemm:
    s_and_b32 s45, s41, 3
    s_lshl_b32 s12, s42, 2
    s_add_u32 s12, s12, s45
    s_lshr_b32 s45, s41, 2
    s_mul_i32 s13, s43, 7
    s_add_u32 s13, s13, s45
    s_lshl_b32 s14, s12, 8
    s_cmp_lt_u32 s13, 10
    s_cbranch_scc0 Lp1_d1
    s_add_u32 s15, s13, 20
    s_mov_b32 s16, s13
    s_mov_b32 s17, 2
    s_mov_b32 s18, 1
    s_branch Lp1_d3
Lp1_d1:
    s_cmp_lt_u32 s13, 24
    s_cbranch_scc0 Lp1_d2
    s_sub_u32 s15, s13, 10
    s_mov_b32 s16, s13
    s_cmp_ge_u32 s15, 10
    s_cselect_b32 s17, 1, 0
    s_mov_b32 s18, 1
    s_branch Lp1_d3
Lp1_d2:
    s_sub_u32 s15, s13, 24
    s_lshl_b32 s15, s15, 1
    s_add_u32 s15, s15, 14
    s_add_u32 s16, s15, 1
    s_mov_b32 s17, 1
    s_mov_b32 s18, 0
Lp1_d3:
    s_lshr_b32 s40, s3, 2
    s_and_b32 s41, s3, 3
    s_and_b32 s42, s40, s18
    s_cmp_eq_u32 s40, 0
    s_cselect_b32 s43, s15, s16
    s_lshl_b32 s43, s43, 7
    s_cmp_eq_u32 s42, 1
    s_movk_i32 s44, 3840
    s_cselect_b32 s44, 3072, s44
    s_lshl_b32 s29, s44, 6
    s_mov_b32 s28, s43
    v_lshrrev_b32 v2, 3, v1
    v_and_b32 v3, 7, v1
    v_and_b32 v4, 2, v2
    v_xor_b32 v3, v3, v4
    s_lshl_b32 s45, s41, 4
    v_add_u32 v5, s45, v2
    v_mul_lo_u32 v5, v5, s44
    v_lshl_add_u32 v199, v3, 4, v5
    v_xor_b32 v3, 4, v3
    s_lshl_b32 s45, s44, 3
    v_add_u32 v5, s45, v5
    v_lshl_add_u32 v200, v3, 4, v5
    s_lshl_b32 s31, s40, 13
    s_lshl_b32 s45, s41, 11
    s_add_u32 s31, s31, s45
    v_and_b32 v3, 7, v1
    v_and_b32 v4, 6, v2
    v_xor_b32 v3, v3, v4
    s_lshl_b32 s45, s3, 3
    s_add_u32 s45, s45, s14
    v_add_u32 v2, s45, v2
    v_mul_u32_u24 v2, 1280, v2
    v_lshl_add_u32 v198, v3, 4, v2
    s_mov_b32 s24, 0
    s_mov_b32 s25, 81920
    s_mov_b32 s26, 163840
    s_mov_b32 s27, 245760
    s_lshl_b32 s30, s3, 10
    s_waitcnt lgkmcnt(0)
    s_mov_b32 s4, s84
    s_and_b32 s5, s85, 0xffff
    s_mov_b32 s6, 20971520
    s_mov_b32 s7, 0x20000
    s_mov_b32 s8, s64
    s_and_b32 s9, s65, 0xffff
    s_mov_b32 s10, 2621440
    s_mov_b32 s11, 0x20000
    s_mov_b32 s56, s82
    s_and_b32 s57, s83, 0xffff
    s_mov_b32 s58, 256
    s_mov_b32 s59, 0x20000
    s_lshr_b32 s40, s3, 2
    s_and_b32 s42, s40, s18
    s_cmp_eq_u32 s42, 1
    s_cselect_b32 s20, s72, s66
    s_cselect_b32 s21, s73, s67
    s_mov_b32 s22, 2457600
    s_cselect_b32 s22, 1966080, s22
    s_and_b32 s21, s21, 0xffff
    s_mov_b32 s23, 0x20000
    s_add_u32 m0, s30, 0
    s_nop 0
    buffer_load_dwordx4 v198, s[8:11], s24 offen lds
    s_add_u32 s24, s24, 128
    s_add_u32 m0, s30, 8192
    s_nop 0
    buffer_load_dwordx4 v198, s[8:11], s25 offen lds
    s_add_u32 s25, s25, 128
    s_add_u32 m0, s30, 16384
    s_nop 0
    buffer_load_dwordx4 v198, s[8:11], s26 offen lds
    s_add_u32 s26, s26, 128
    s_add_u32 m0, s30, 24576
    s_nop 0
    buffer_load_dwordx4 v198, s[8:11], s27 offen lds
    s_add_u32 s27, s27, 128
    s_add_u32 m0, s31, 98304
    s_nop 0
    buffer_load_dwordx4 v199, s[20:23], s28 offen lds
    s_add_u32 m0, s31, 99328
    s_nop 0
    buffer_load_dwordx4 v200, s[20:23], s28 offen lds
    s_add_u32 s28, s28, s29
    s_and_b32 s40, s2, 1
    s_lshl_b32 s40, s40, 10
    s_lshr_b32 s41, s2, 1
    s_and_b32 s41, s41, 3
    s_lshl_b32 s41, s41, 8
    s_add_u32 s40, s40, s41
    s_lshr_b32 s41, s2, 3
    s_lshl_b32 s41, s41, 3
    s_add_u32 s40, s40, s41
    s_add_u32 s40, s40, s3
    s_mul_i32 s41, s40, 1280
    v_lshlrev_b32 v2, 5, v1
    v_mov_b32 v208, 0
    v_mov_b32 v209, 0
    v_mov_b32 v210, 0
    v_mov_b32 v211, 0
    v_mov_b32 v212, 0
    v_mov_b32 v213, 0
    v_mov_b32 v214, 0
    v_mov_b32 v215, 0
    s_mov_b32 s42, -1
    s_mov_b32 s43, 0xff
    s_mov_b64 exec, s[42:43]
    buffer_load_dwordx4 v[208:211], v2, s[8:11], s41 offen
    buffer_load_dwordx4 v[212:215], v2, s[8:11], s41 offen offset:16
    s_mov_b64 exec, -1
    s_add_u32 m0, s30, 32768
    s_nop 0
    buffer_load_dwordx4 v198, s[8:11], s24 offen lds
    s_add_u32 s24, s24, 128
    s_add_u32 m0, s30, 40960
    s_nop 0
    buffer_load_dwordx4 v198, s[8:11], s25 offen lds
    s_add_u32 s25, s25, 128
    s_add_u32 m0, s30, 49152
    s_nop 0
    buffer_load_dwordx4 v198, s[8:11], s26 offen lds
    s_add_u32 s26, s26, 128
    s_add_u32 m0, s30, 57344
    s_nop 0
    buffer_load_dwordx4 v198, s[8:11], s27 offen lds
    s_add_u32 s27, s27, 128
    s_add_u32 m0, s31, 114688
    s_nop 0
    buffer_load_dwordx4 v199, s[20:23], s28 offen lds
    s_add_u32 m0, s31, 115712
    s_nop 0
    buffer_load_dwordx4 v200, s[20:23], s28 offen lds
    s_add_u32 s28, s28, s29
    s_lshr_b32 s40, s3, 2
    s_and_b32 s41, s3, 3
    v_and_b32 v2, 3, v1
    v_and_b32 v3, 4, v1
    v_add_u32 v2, v2, v3
    v_and_b32 v3, 8, v1
    v_lshl_add_u32 v2, v3, 1, v2
    s_lshl_b32 s45, s41, 6
    v_add_u32 v2, s45, v2
    v_lshrrev_b32 v4, 4, v1
    v_and_b32 v3, 6, v2
    v_xor_b32 v3, v3, v4
    v_lshlrev_b32 v3, 4, v3
    v_lshl_add_u32 v192, v2, 7, v3
    v_xor_b32 v193, 64, v192
    v_add_u32 v194, 65536, v192
    v_add_u32 v195, 65536, v193
    v_and_b32 v2, 15, v1
    v_lshrrev_b32 v3, 2, v2
    v_lshl_add_u32 v3, v4, 3, v3
    v_and_b32 v5, 3, v2
    v_lshlrev_b32 v5, 3, v5
    s_lshl_b32 s45, s40, 6
    v_add_u32 v5, s45, v5
    v_and_b32 v6, 1, v4
    v_lshlrev_b32 v6, 6, v6
    v_xor_b32 v5, v5, v6
    v_lshrrev_b32 v6, 3, v2
    v_lshlrev_b32 v6, 5, v6
    v_xor_b32 v5, v5, v6
    v_lshl_add_u32 v5, v3, 7, v5
    v_add_u32 v196, 98304, v5
    v_xor_b32 v197, 32, v196
    s_cmp_eq_u32 s17, 2
    s_cbranch_scc1 Lp1_vform
    s_waitcnt vmcnt(8)
    s_barrier
    ds_read_b128 v[128:131], v192 offset:0
    ds_read_b64_tr_b16 v[160:161], v196 offset:0
    ds_read_b64_tr_b16 v[162:163], v196 offset:512
    ds_read_b64_tr_b16 v[164:165], v197 offset:0
    ds_read_b64_tr_b16 v[166:167], v197 offset:512
    ds_read_b64_tr_b16 v[168:169], v196 offset:8192
    ds_read_b64_tr_b16 v[170:171], v196 offset:8704
    ds_read_b64_tr_b16 v[172:173], v197 offset:8192
    ds_read_b64_tr_b16 v[174:175], v197 offset:8704
    ds_read_b128 v[132:135], v192 offset:1024
    ds_read_b128 v[136:139], v192 offset:4096
    ds_read_b128 v[140:143], v192 offset:5120
    s_waitcnt lgkmcnt(3)
    v_mfma_f32_16x16x32_bf16 v[64:67], v[160:163], v[128:131], 0
    ds_read_b128 v[144:147], v193 offset:0
    v_mfma_f32_16x16x32_bf16 v[68:71], v[164:167], v[128:131], 0
    ds_read_b64_tr_b16 v[176:177], v196 offset:4096
    v_mfma_f32_16x16x32_bf16 v[72:75], v[168:171], v[128:131], 0
    ds_read_b64_tr_b16 v[178:179], v196 offset:4608
    s_add_u32 m0, s30, 65536
    s_nop 0
    buffer_load_dwordx4 v198, s[8:11], s24 offen lds
    s_add_u32 s24, s24, 128
    v_mfma_f32_16x16x32_bf16 v[76:79], v[172:175], v[128:131], 0
    ds_read_b64_tr_b16 v[180:181], v197 offset:4096
    s_waitcnt lgkmcnt(6)
    v_mfma_f32_16x16x32_bf16 v[80:83], v[160:163], v[132:135], 0
    ds_read_b64_tr_b16 v[182:183], v197 offset:4608
    s_add_u32 m0, s30, 73728
    s_nop 0
    buffer_load_dwordx4 v198, s[8:11], s25 offen lds
    s_add_u32 s25, s25, 128
    v_mfma_f32_16x16x32_bf16 v[84:87], v[164:167], v[132:135], 0
    ds_read_b64_tr_b16 v[184:185], v196 offset:12288
    v_mfma_f32_16x16x32_bf16 v[88:91], v[168:171], v[132:135], 0
    ds_read_b64_tr_b16 v[186:187], v196 offset:12800
    v_mfma_f32_16x16x32_bf16 v[92:95], v[172:175], v[132:135], 0
    ds_read_b64_tr_b16 v[188:189], v197 offset:12288
    s_add_u32 m0, s30, 81920
    s_nop 0
    buffer_load_dwordx4 v198, s[8:11], s26 offen lds
    s_add_u32 s26, s26, 128
    s_waitcnt lgkmcnt(9)
    v_mfma_f32_16x16x32_bf16 v[96:99], v[160:163], v[136:139], 0
    ds_read_b64_tr_b16 v[190:191], v197 offset:12800
    v_mfma_f32_16x16x32_bf16 v[100:103], v[164:167], v[136:139], 0
    ds_read_b128 v[148:151], v193 offset:1024
    s_add_u32 m0, s30, 90112
    s_nop 0
    buffer_load_dwordx4 v198, s[8:11], s27 offen lds
    s_add_u32 s27, s27, 128
    v_mfma_f32_16x16x32_bf16 v[104:107], v[168:171], v[136:139], 0
    ds_read_b128 v[152:155], v193 offset:4096
    v_mfma_f32_16x16x32_bf16 v[108:111], v[172:175], v[136:139], 0
    ds_read_b128 v[156:159], v193 offset:5120
    s_waitcnt lgkmcnt(12)
    v_mfma_f32_16x16x32_bf16 v[112:115], v[160:163], v[140:143], 0
    s_add_u32 m0, s31, 131072
    s_nop 0
    buffer_load_dwordx4 v199, s[20:23], s28 offen lds
    v_mfma_f32_16x16x32_bf16 v[116:119], v[164:167], v[140:143], 0
    v_mfma_f32_16x16x32_bf16 v[120:123], v[168:171], v[140:143], 0
    s_add_u32 m0, s31, 132096
    s_nop 0
    buffer_load_dwordx4 v200, s[20:23], s28 offen lds
    s_add_u32 s28, s28, s29
    v_mfma_f32_16x16x32_bf16 v[124:127], v[172:175], v[140:143], 0
    s_waitcnt lgkmcnt(0)
    s_waitcnt vmcnt(6)
    v_lshlrev_b32 v216, 16, v208
    v_and_b32 v217, 0xffff0000, v208
    v_lshlrev_b32 v218, 16, v209
    v_and_b32 v219, 0xffff0000, v209
    v_lshlrev_b32 v220, 16, v210
    v_and_b32 v221, 0xffff0000, v210
    v_lshlrev_b32 v222, 16, v211
    v_and_b32 v223, 0xffff0000, v211
    v_lshlrev_b32 v224, 16, v212
    v_and_b32 v225, 0xffff0000, v212
    v_lshlrev_b32 v226, 16, v213
    v_and_b32 v227, 0xffff0000, v213
    v_lshlrev_b32 v228, 16, v214
    v_and_b32 v229, 0xffff0000, v214
    v_lshlrev_b32 v230, 16, v215
    v_and_b32 v231, 0xffff0000, v215
    v_pk_add_f32 v[6:7], v[216:217], v[218:219]
    v_pk_add_f32 v[8:9], v[220:221], v[222:223]
    v_pk_add_f32 v[10:11], v[224:225], v[226:227]
    v_pk_add_f32 v[12:13], v[228:229], v[230:231]
    v_pk_add_f32 v[6:7], v[6:7], v[8:9]
    v_pk_add_f32 v[10:11], v[10:11], v[12:13]
    v_pk_add_f32 v[6:7], v[6:7], v[10:11]
    v_add_f32 v6, v6, v7
    s_nop 1
    v_add_f32_dpp v6, v6, v6 row_ror:8 row_mask:0xf bank_mask:0xf
    s_nop 1
    v_add_f32_dpp v6, v6, v6 row_ror:4 row_mask:0xf bank_mask:0xf
    s_nop 1
    v_add_f32_dpp v6, v6, v6 row_ror:2 row_mask:0xf bank_mask:0xf
    s_nop 1
    v_add_f32_dpp v6, v6, v6 row_ror:1 row_mask:0xf bank_mask:0xf
    s_nop 0
    v_readlane_b32 s44, v6, 0
    v_readlane_b32 s45, v6, 16
    v_readlane_b32 s46, v6, 32
    v_readlane_b32 s47, v6, 48
    s_nop 1
    v_mov_b32 v6, s44
    v_add_f32 v6, s45, v6
    v_add_f32 v6, s46, v6
    v_add_f32 v6, s47, v6
    v_mul_f32 v8, 0x3acccccd, v6
    v_cmp_gt_u32 vcc, 40, v1
    v_sub_f32 v10, 0, v8
    s_nop 0
    v_cndmask_b32 v10, 0, v10, vcc
    v_mov_b32 v11, v10
    v_pk_add_f32 v[216:217], v[216:217], v[10:11]
    v_pk_add_f32 v[218:219], v[218:219], v[10:11]
    v_pk_add_f32 v[220:221], v[220:221], v[10:11]
    v_pk_add_f32 v[222:223], v[222:223], v[10:11]
    v_pk_add_f32 v[224:225], v[224:225], v[10:11]
    v_pk_add_f32 v[226:227], v[226:227], v[10:11]
    v_pk_add_f32 v[228:229], v[228:229], v[10:11]
    v_pk_add_f32 v[230:231], v[230:231], v[10:11]
    v_pk_mul_f32 v[6:7], v[216:217], v[216:217]
    v_pk_mul_f32 v[12:13], v[218:219], v[218:219]
    v_pk_fma_f32 v[6:7], v[220:221], v[220:221], v[6:7]
    v_pk_fma_f32 v[12:13], v[222:223], v[222:223], v[12:13]
    v_pk_fma_f32 v[6:7], v[224:225], v[224:225], v[6:7]
    v_pk_fma_f32 v[12:13], v[226:227], v[226:227], v[12:13]
    v_pk_fma_f32 v[6:7], v[228:229], v[228:229], v[6:7]
    v_pk_fma_f32 v[12:13], v[230:231], v[230:231], v[12:13]
    v_pk_add_f32 v[6:7], v[6:7], v[12:13]
    v_add_f32 v6, v6, v7
    s_nop 1
    v_add_f32_dpp v6, v6, v6 row_ror:8 row_mask:0xf bank_mask:0xf
    s_nop 1
    v_add_f32_dpp v6, v6, v6 row_ror:4 row_mask:0xf bank_mask:0xf
    s_nop 1
    v_add_f32_dpp v6, v6, v6 row_ror:2 row_mask:0xf bank_mask:0xf
    s_nop 1
    v_add_f32_dpp v6, v6, v6 row_ror:1 row_mask:0xf bank_mask:0xf
    s_nop 0
    v_readlane_b32 s44, v6, 0
    v_readlane_b32 s45, v6, 16
    v_readlane_b32 s46, v6, 32
    v_readlane_b32 s47, v6, 48
    s_nop 1
    v_mov_b32 v6, s44
    v_add_f32 v6, s45, v6
    v_add_f32 v6, s46, v6
    v_add_f32 v6, s47, v6
    v_mul_f32 v6, 0x3acccccd, v6
    v_add_f32 v7, 0x3727c5ac, v6
    v_rsq_f32 v9, v7
    s_nop 0
    v_mul_f32 v7, v9, v9
    v_mul_f32 v7, v7, v6
    v_add_f32 v7, 0x3727c5ac, v7
    v_rsq_f32 v7, v7
    s_nop 0
    v_mul_f32 v10, v9, v7
    v_mul_f32 v11, 0x3ea52b5c, v9
    s_and_b32 s40, s2, 1
    s_lshl_b32 s40, s40, 10
    s_lshr_b32 s41, s2, 1
    s_and_b32 s41, s41, 3
    s_lshl_b32 s41, s41, 8
    s_add_u32 s40, s40, s41
    s_lshr_b32 s41, s2, 3
    s_lshl_b32 s41, s41, 3
    s_add_u32 s40, s40, s41
    s_add_u32 s40, s40, s3
    s_lshl_b32 s40, s40, 4
    v_mov_b32 v12, 0
    s_mov_b64 exec, 1
    buffer_store_dwordx4 v[8:11], v12, s[4:7], s40 offen offset:0 sc1
    s_mov_b64 exec, -1
    s_barrier
    s_cmp_lg_u32 s3, 0
    s_cbranch_scc1 w0_2
    v_mov_b32 v250, 0
    buffer_load_dword v250, v250, s[56:59], 0 offen sc1
w0_2:
    v_mfma_f32_16x16x32_bf16 v[64:67], v[176:179], v[144:147], v[64:67]
    ds_read_b128 v[128:131], v192 offset:32768
    v_mfma_f32_16x16x32_bf16 v[68:71], v[180:183], v[144:147], v[68:71]
    ds_read_b64_tr_b16 v[160:161], v196 offset:16384
    v_mfma_f32_16x16x32_bf16 v[72:75], v[184:187], v[144:147], v[72:75]
    ds_read_b64_tr_b16 v[162:163], v196 offset:16896
    v_mfma_f32_16x16x32_bf16 v[76:79], v[188:191], v[144:147], v[76:79]
    ds_read_b64_tr_b16 v[164:165], v197 offset:16384
    v_mfma_f32_16x16x32_bf16 v[80:83], v[176:179], v[148:151], v[80:83]
    ds_read_b64_tr_b16 v[166:167], v197 offset:16896
    s_add_u32 m0, s30, 0
    s_nop 0
    buffer_load_dwordx4 v198, s[8:11], s24 offen lds
    s_add_u32 s24, s24, 128
    v_mfma_f32_16x16x32_bf16 v[84:87], v[180:183], v[148:151], v[84:87]
    ds_read_b64_tr_b16 v[168:169], v196 offset:24576
    v_mfma_f32_16x16x32_bf16 v[88:91], v[184:187], v[148:151], v[88:91]
    ds_read_b64_tr_b16 v[170:171], v196 offset:25088
    v_mfma_f32_16x16x32_bf16 v[92:95], v[188:191], v[148:151], v[92:95]
    ds_read_b64_tr_b16 v[172:173], v197 offset:24576
    v_mfma_f32_16x16x32_bf16 v[96:99], v[176:179], v[152:155], v[96:99]
    ds_read_b64_tr_b16 v[174:175], v197 offset:25088
    v_mfma_f32_16x16x32_bf16 v[100:103], v[180:183], v[152:155], v[100:103]
    ds_read_b128 v[132:135], v192 offset:33792
    s_add_u32 m0, s30, 8192
    s_nop 0
    buffer_load_dwordx4 v198, s[8:11], s25 offen lds
    s_add_u32 s25, s25, 128
    v_mfma_f32_16x16x32_bf16 v[104:107], v[184:187], v[152:155], v[104:107]
    ds_read_b128 v[136:139], v192 offset:36864
    v_mfma_f32_16x16x32_bf16 v[108:111], v[188:191], v[152:155], v[108:111]
    ds_read_b128 v[140:143], v192 offset:37888
    v_mfma_f32_16x16x32_bf16 v[112:115], v[176:179], v[156:159], v[112:115]
    v_mfma_f32_16x16x32_bf16 v[116:119], v[180:183], v[156:159], v[116:119]
    v_mfma_f32_16x16x32_bf16 v[120:123], v[184:187], v[156:159], v[120:123]
    s_add_u32 m0, s30, 16384
    s_nop 0
    buffer_load_dwordx4 v198, s[8:11], s26 offen lds
    s_add_u32 s26, s26, 128
    v_mfma_f32_16x16x32_bf16 v[124:127], v[188:191], v[156:159], v[124:127]
    s_waitcnt lgkmcnt(3)
    v_mfma_f32_16x16x32_bf16 v[64:67], v[160:163], v[128:131], v[64:67]
    ds_read_b128 v[144:147], v193 offset:32768
    v_mfma_f32_16x16x32_bf16 v[68:71], v[164:167], v[128:131], v[68:71]
    ds_read_b64_tr_b16 v[176:177], v196 offset:20480
    v_mfma_f32_16x16x32_bf16 v[72:75], v[168:171], v[128:131], v[72:75]
    ds_read_b64_tr_b16 v[178:179], v196 offset:20992
    v_mfma_f32_16x16x32_bf16 v[76:79], v[172:175], v[128:131], v[76:79]
    ds_read_b64_tr_b16 v[180:181], v197 offset:20480
    s_waitcnt lgkmcnt(6)
    v_mfma_f32_16x16x32_bf16 v[80:83], v[160:163], v[132:135], v[80:83]
    ds_read_b64_tr_b16 v[182:183], v197 offset:20992
    s_add_u32 m0, s30, 24576
    s_nop 0
    buffer_load_dwordx4 v198, s[8:11], s27 offen lds
    s_add_u32 s27, s27, 128
    v_mfma_f32_16x16x32_bf16 v[84:87], v[164:167], v[132:135], v[84:87]
    ds_read_b64_tr_b16 v[184:185], v196 offset:28672
    v_mfma_f32_16x16x32_bf16 v[88:91], v[168:171], v[132:135], v[88:91]
    ds_read_b64_tr_b16 v[186:187], v196 offset:29184
    v_mfma_f32_16x16x32_bf16 v[92:95], v[172:175], v[132:135], v[92:95]
    ds_read_b64_tr_b16 v[188:189], v197 offset:28672
    s_waitcnt lgkmcnt(9)
    v_mfma_f32_16x16x32_bf16 v[96:99], v[160:163], v[136:139], v[96:99]
    ds_read_b64_tr_b16 v[190:191], v197 offset:29184
    v_mfma_f32_16x16x32_bf16 v[100:103], v[164:167], v[136:139], v[100:103]
    ds_read_b128 v[148:151], v193 offset:33792
    s_add_u32 m0, s31, 98304
    s_nop 0
    buffer_load_dwordx4 v199, s[20:23], s28 offen lds
    v_mfma_f32_16x16x32_bf16 v[104:107], v[168:171], v[136:139], v[104:107]
    ds_read_b128 v[152:155], v193 offset:36864
    v_mfma_f32_16x16x32_bf16 v[108:111], v[172:175], v[136:139], v[108:111]
    ds_read_b128 v[156:159], v193 offset:37888
    s_waitcnt lgkmcnt(12)
    v_mfma_f32_16x16x32_bf16 v[112:115], v[160:163], v[140:143], v[112:115]
    v_mfma_f32_16x16x32_bf16 v[116:119], v[164:167], v[140:143], v[116:119]
    v_mfma_f32_16x16x32_bf16 v[120:123], v[168:171], v[140:143], v[120:123]
    s_add_u32 m0, s31, 99328
    s_nop 0
    buffer_load_dwordx4 v200, s[20:23], s28 offen lds
    s_add_u32 s28, s28, s29
    v_mfma_f32_16x16x32_bf16 v[124:127], v[172:175], v[140:143], v[124:127]
    s_waitcnt lgkmcnt(0)
    s_waitcnt vmcnt(6)
    s_cmp_lg_u32 s3, 0
    s_cbranch_scc1 w0_3
    s_cmp_lg_u32 s60, 0
    s_cbranch_scc1 tf_4
    v_readfirstlane_b32 s60, v250
    s_nop 3
tf_4:
    s_cmp_lg_u32 s60, 0
    s_cbranch_scc1 tag_5_ok
    s_mov_b32 s61, 65536
    v_mov_b32 v2, 0
tag_5_loop:
    buffer_load_dword v3, v2, s[56:59], 0 offen sc1
    s_waitcnt vmcnt(0)
    v_readfirstlane_b32 s60, v3
    s_nop 3
    s_cmp_lg_u32 s60, 0
    s_cbranch_scc1 tag_5_ok
    s_sleep 2
    s_sub_u32 s61, s61, 1
    s_cmp_lg_u32 s61, 0
    s_cbranch_scc1 tag_5_loop
tag_5_ok:
w0_3:
    s_barrier
    s_cmp_lg_u32 s3, 0
    s_cbranch_scc1 w0_6
    s_lshl_b32 s62, s2, 4
    s_add_u32 s62, s62, 19959808
    v_mov_b32 v4, 0
    v_mov_b32 v5, s60
    s_mov_b64 s[52:53], exec
    s_mov_b64 exec, 1
    buffer_store_dword v5, v4, s[4:7], s62 offen sc1
    s_mov_b64 exec, s[52:53]
w0_6:
    v_mfma_f32_16x16x32_bf16 v[64:67], v[176:179], v[144:147], v[64:67]
    ds_read_b128 v[128:131], v194 offset:0
    v_mfma_f32_16x16x32_bf16 v[68:71], v[180:183], v[144:147], v[68:71]
    ds_read_b64_tr_b16 v[160:161], v196 offset:32768
    v_mfma_f32_16x16x32_bf16 v[72:75], v[184:187], v[144:147], v[72:75]
    ds_read_b64_tr_b16 v[162:163], v196 offset:33280
    v_mfma_f32_16x16x32_bf16 v[76:79], v[188:191], v[144:147], v[76:79]
    ds_read_b64_tr_b16 v[164:165], v197 offset:32768
    v_mfma_f32_16x16x32_bf16 v[80:83], v[176:179], v[148:151], v[80:83]
    ds_read_b64_tr_b16 v[166:167], v197 offset:33280
    s_add_u32 m0, s30, 32768
    s_nop 0
    buffer_load_dwordx4 v198, s[8:11], s24 offen lds
    s_add_u32 s24, s24, 128
    v_mfma_f32_16x16x32_bf16 v[84:87], v[180:183], v[148:151], v[84:87]
    ds_read_b64_tr_b16 v[168:169], v196 offset:40960
    v_mfma_f32_16x16x32_bf16 v[88:91], v[184:187], v[148:151], v[88:91]
    ds_read_b64_tr_b16 v[170:171], v196 offset:41472
    v_mfma_f32_16x16x32_bf16 v[92:95], v[188:191], v[148:151], v[92:95]
    ds_read_b64_tr_b16 v[172:173], v197 offset:40960
    v_mfma_f32_16x16x32_bf16 v[96:99], v[176:179], v[152:155], v[96:99]
    ds_read_b64_tr_b16 v[174:175], v197 offset:41472
    v_mfma_f32_16x16x32_bf16 v[100:103], v[180:183], v[152:155], v[100:103]
    ds_read_b128 v[132:135], v194 offset:1024
    s_add_u32 m0, s30, 40960
    s_nop 0
    buffer_load_dwordx4 v198, s[8:11], s25 offen lds
    s_add_u32 s25, s25, 128
    v_mfma_f32_16x16x32_bf16 v[104:107], v[184:187], v[152:155], v[104:107]
    ds_read_b128 v[136:139], v194 offset:4096
    v_mfma_f32_16x16x32_bf16 v[108:111], v[188:191], v[152:155], v[108:111]
    ds_read_b128 v[140:143], v194 offset:5120
    v_mfma_f32_16x16x32_bf16 v[112:115], v[176:179], v[156:159], v[112:115]
    v_mfma_f32_16x16x32_bf16 v[116:119], v[180:183], v[156:159], v[116:119]
    v_mfma_f32_16x16x32_bf16 v[120:123], v[184:187], v[156:159], v[120:123]
    s_add_u32 m0, s30, 49152
    s_nop 0
    buffer_load_dwordx4 v198, s[8:11], s26 offen lds
    s_add_u32 s26, s26, 128
    v_mfma_f32_16x16x32_bf16 v[124:127], v[188:191], v[156:159], v[124:127]
    s_waitcnt lgkmcnt(3)
    v_mfma_f32_16x16x32_bf16 v[64:67], v[160:163], v[128:131], v[64:67]
    ds_read_b128 v[144:147], v195 offset:0
    v_mfma_f32_16x16x32_bf16 v[68:71], v[164:167], v[128:131], v[68:71]
    ds_read_b64_tr_b16 v[176:177], v196 offset:36864
    v_mfma_f32_16x16x32_bf16 v[72:75], v[168:171], v[128:131], v[72:75]
    ds_read_b64_tr_b16 v[178:179], v196 offset:37376
    v_mfma_f32_16x16x32_bf16 v[76:79], v[172:175], v[128:131], v[76:79]
    ds_read_b64_tr_b16 v[180:181], v197 offset:36864
    s_waitcnt lgkmcnt(6)
    v_mfma_f32_16x16x32_bf16 v[80:83], v[160:163], v[132:135], v[80:83]
    ds_read_b64_tr_b16 v[182:183], v197 offset:37376
    s_add_u32 m0, s30, 57344
    s_nop 0
    buffer_load_dwordx4 v198, s[8:11], s27 offen lds
    s_add_u32 s27, s27, 128
    v_mfma_f32_16x16x32_bf16 v[84:87], v[164:167], v[132:135], v[84:87]
    ds_read_b64_tr_b16 v[184:185], v196 offset:45056
    v_mfma_f32_16x16x32_bf16 v[88:91], v[168:171], v[132:135], v[88:91]
    ds_read_b64_tr_b16 v[186:187], v196 offset:45568
    v_mfma_f32_16x16x32_bf16 v[92:95], v[172:175], v[132:135], v[92:95]
    ds_read_b64_tr_b16 v[188:189], v197 offset:45056
    s_waitcnt lgkmcnt(9)
    v_mfma_f32_16x16x32_bf16 v[96:99], v[160:163], v[136:139], v[96:99]
    ds_read_b64_tr_b16 v[190:191], v197 offset:45568
    v_mfma_f32_16x16x32_bf16 v[100:103], v[164:167], v[136:139], v[100:103]
    ds_read_b128 v[148:151], v195 offset:1024
    s_add_u32 m0, s31, 114688
    s_nop 0
    buffer_load_dwordx4 v199, s[20:23], s28 offen lds
    v_mfma_f32_16x16x32_bf16 v[104:107], v[168:171], v[136:139], v[104:107]
    ds_read_b128 v[152:155], v195 offset:4096
    v_mfma_f32_16x16x32_bf16 v[108:111], v[172:175], v[136:139], v[108:111]
    ds_read_b128 v[156:159], v195 offset:5120
    s_waitcnt lgkmcnt(12)
    v_mfma_f32_16x16x32_bf16 v[112:115], v[160:163], v[140:143], v[112:115]
    v_mfma_f32_16x16x32_bf16 v[116:119], v[164:167], v[140:143], v[116:119]
    v_mfma_f32_16x16x32_bf16 v[120:123], v[168:171], v[140:143], v[120:123]
    s_add_u32 m0, s31, 115712
    s_nop 0
    buffer_load_dwordx4 v200, s[20:23], s28 offen lds
    s_add_u32 s28, s28, s29
    v_mfma_f32_16x16x32_bf16 v[124:127], v[172:175], v[140:143], v[124:127]
    s_waitcnt lgkmcnt(0)
    s_waitcnt vmcnt(6)
    s_barrier
    v_mfma_f32_16x16x32_bf16 v[64:67], v[176:179], v[144:147], v[64:67]
    ds_read_b128 v[128:131], v192 offset:0
    v_mfma_f32_16x16x32_bf16 v[68:71], v[180:183], v[144:147], v[68:71]
    ds_read_b64_tr_b16 v[160:161], v196 offset:0
    v_mfma_f32_16x16x32_bf16 v[72:75], v[184:187], v[144:147], v[72:75]
    ds_read_b64_tr_b16 v[162:163], v196 offset:512
    v_mfma_f32_16x16x32_bf16 v[76:79], v[188:191], v[144:147], v[76:79]
    ds_read_b64_tr_b16 v[164:165], v197 offset:0
    v_mfma_f32_16x16x32_bf16 v[80:83], v[176:179], v[148:151], v[80:83]
    ds_read_b64_tr_b16 v[166:167], v197 offset:512
    s_add_u32 m0, s30, 65536
    s_nop 0
    buffer_load_dwordx4 v198, s[8:11], s24 offen lds
    s_add_u32 s24, s24, 128
    v_mfma_f32_16x16x32_bf16 v[84:87], v[180:183], v[148:151], v[84:87]
    ds_read_b64_tr_b16 v[168:169], v196 offset:8192
    v_mfma_f32_16x16x32_bf16 v[88:91], v[184:187], v[148:151], v[88:91]
    ds_read_b64_tr_b16 v[170:171], v196 offset:8704
    v_mfma_f32_16x16x32_bf16 v[92:95], v[188:191], v[148:151], v[92:95]
    ds_read_b64_tr_b16 v[172:173], v197 offset:8192
    v_mfma_f32_16x16x32_bf16 v[96:99], v[176:179], v[152:155], v[96:99]
    ds_read_b64_tr_b16 v[174:175], v197 offset:8704
    v_mfma_f32_16x16x32_bf16 v[100:103], v[180:183], v[152:155], v[100:103]
    ds_read_b128 v[132:135], v192 offset:1024
    s_add_u32 m0, s30, 73728
    s_nop 0
    buffer_load_dwordx4 v198, s[8:11], s25 offen lds
    s_add_u32 s25, s25, 128
    v_mfma_f32_16x16x32_bf16 v[104:107], v[184:187], v[152:155], v[104:107]
    ds_read_b128 v[136:139], v192 offset:4096
    v_mfma_f32_16x16x32_bf16 v[108:111], v[188:191], v[152:155], v[108:111]
    ds_read_b128 v[140:143], v192 offset:5120
    v_mfma_f32_16x16x32_bf16 v[112:115], v[176:179], v[156:159], v[112:115]
    v_mfma_f32_16x16x32_bf16 v[116:119], v[180:183], v[156:159], v[116:119]
    v_mfma_f32_16x16x32_bf16 v[120:123], v[184:187], v[156:159], v[120:123]
    s_add_u32 m0, s30, 81920
    s_nop 0
    buffer_load_dwordx4 v198, s[8:11], s26 offen lds
    s_add_u32 s26, s26, 128
    v_mfma_f32_16x16x32_bf16 v[124:127], v[188:191], v[156:159], v[124:127]
    s_waitcnt lgkmcnt(3)
    v_mfma_f32_16x16x32_bf16 v[64:67], v[160:163], v[128:131], v[64:67]
    ds_read_b128 v[144:147], v193 offset:0
    v_mfma_f32_16x16x32_bf16 v[68:71], v[164:167], v[128:131], v[68:71]
    ds_read_b64_tr_b16 v[176:177], v196 offset:4096
    v_mfma_f32_16x16x32_bf16 v[72:75], v[168:171], v[128:131], v[72:75]
    ds_read_b64_tr_b16 v[178:179], v196 offset:4608
    v_mfma_f32_16x16x32_bf16 v[76:79], v[172:175], v[128:131], v[76:79]
    ds_read_b64_tr_b16 v[180:181], v197 offset:4096
    s_waitcnt lgkmcnt(6)
    v_mfma_f32_16x16x32_bf16 v[80:83], v[160:163], v[132:135], v[80:83]
    ds_read_b64_tr_b16 v[182:183], v197 offset:4608
    s_add_u32 m0, s30, 90112
    s_nop 0
    buffer_load_dwordx4 v198, s[8:11], s27 offen lds
    s_add_u32 s27, s27, 128
    v_mfma_f32_16x16x32_bf16 v[84:87], v[164:167], v[132:135], v[84:87]
    ds_read_b64_tr_b16 v[184:185], v196 offset:12288
    v_mfma_f32_16x16x32_bf16 v[88:91], v[168:171], v[132:135], v[88:91]
    ds_read_b64_tr_b16 v[186:187], v196 offset:12800
    v_mfma_f32_16x16x32_bf16 v[92:95], v[172:175], v[132:135], v[92:95]
    ds_read_b64_tr_b16 v[188:189], v197 offset:12288
    s_waitcnt lgkmcnt(9)
    v_mfma_f32_16x16x32_bf16 v[96:99], v[160:163], v[136:139], v[96:99]
    ds_read_b64_tr_b16 v[190:191], v197 offset:12800
    v_mfma_f32_16x16x32_bf16 v[100:103], v[164:167], v[136:139], v[100:103]
    ds_read_b128 v[148:151], v193 offset:1024
    s_add_u32 m0, s31, 131072
    s_nop 0
    buffer_load_dwordx4 v199, s[20:23], s28 offen lds
    v_mfma_f32_16x16x32_bf16 v[104:107], v[168:171], v[136:139], v[104:107]
    ds_read_b128 v[152:155], v193 offset:4096
    v_mfma_f32_16x16x32_bf16 v[108:111], v[172:175], v[136:139], v[108:111]
    ds_read_b128 v[156:159], v193 offset:5120
    s_waitcnt lgkmcnt(12)
    v_mfma_f32_16x16x32_bf16 v[112:115], v[160:163], v[140:143], v[112:115]
    v_mfma_f32_16x16x32_bf16 v[116:119], v[164:167], v[140:143], v[116:119]
    v_mfma_f32_16x16x32_bf16 v[120:123], v[168:171], v[140:143], v[120:123]
    s_add_u32 m0, s31, 132096
    s_nop 0
    buffer_load_dwordx4 v200, s[20:23], s28 offen lds
    s_add_u32 s28, s28, s29
    v_mfma_f32_16x16x32_bf16 v[124:127], v[172:175], v[140:143], v[124:127]
    s_waitcnt lgkmcnt(0)
    s_waitcnt vmcnt(6)
    s_barrier
    v_mfma_f32_16x16x32_bf16 v[64:67], v[176:179], v[144:147], v[64:67]
    ds_read_b128 v[128:131], v192 offset:32768
    v_mfma_f32_16x16x32_bf16 v[68:71], v[180:183], v[144:147], v[68:71]
    ds_read_b64_tr_b16 v[160:161], v196 offset:16384
    v_mfma_f32_16x16x32_bf16 v[72:75], v[184:187], v[144:147], v[72:75]
    ds_read_b64_tr_b16 v[162:163], v196 offset:16896
    v_mfma_f32_16x16x32_bf16 v[76:79], v[188:191], v[144:147], v[76:79]
    ds_read_b64_tr_b16 v[164:165], v197 offset:16384
    v_mfma_f32_16x16x32_bf16 v[80:83], v[176:179], v[148:151], v[80:83]
    ds_read_b64_tr_b16 v[166:167], v197 offset:16896
    s_add_u32 m0, s30, 0
    s_nop 0
    buffer_load_dwordx4 v198, s[8:11], s24 offen lds
    s_add_u32 s24, s24, 128
    v_mfma_f32_16x16x32_bf16 v[84:87], v[180:183], v[148:151], v[84:87]
    ds_read_b64_tr_b16 v[168:169], v196 offset:24576
    v_mfma_f32_16x16x32_bf16 v[88:91], v[184:187], v[148:151], v[88:91]
    ds_read_b64_tr_b16 v[170:171], v196 offset:25088
    v_mfma_f32_16x16x32_bf16 v[92:95], v[188:191], v[148:151], v[92:95]
    ds_read_b64_tr_b16 v[172:173], v197 offset:24576
    v_mfma_f32_16x16x32_bf16 v[96:99], v[176:179], v[152:155], v[96:99]
    ds_read_b64_tr_b16 v[174:175], v197 offset:25088
    v_mfma_f32_16x16x32_bf16 v[100:103], v[180:183], v[152:155], v[100:103]
    ds_read_b128 v[132:135], v192 offset:33792
    s_add_u32 m0, s30, 8192
    s_nop 0
    buffer_load_dwordx4 v198, s[8:11], s25 offen lds
    s_add_u32 s25, s25, 128
    v_mfma_f32_16x16x32_bf16 v[104:107], v[184:187], v[152:155], v[104:107]
    ds_read_b128 v[136:139], v192 offset:36864
    v_mfma_f32_16x16x32_bf16 v[108:111], v[188:191], v[152:155], v[108:111]
    ds_read_b128 v[140:143], v192 offset:37888
    v_mfma_f32_16x16x32_bf16 v[112:115], v[176:179], v[156:159], v[112:115]
    v_mfma_f32_16x16x32_bf16 v[116:119], v[180:183], v[156:159], v[116:119]
    v_mfma_f32_16x16x32_bf16 v[120:123], v[184:187], v[156:159], v[120:123]
    s_add_u32 m0, s30, 16384
    s_nop 0
    buffer_load_dwordx4 v198, s[8:11], s26 offen lds
    s_add_u32 s26, s26, 128
    v_mfma_f32_16x16x32_bf16 v[124:127], v[188:191], v[156:159], v[124:127]
    s_waitcnt lgkmcnt(3)
    v_mfma_f32_16x16x32_bf16 v[64:67], v[160:163], v[128:131], v[64:67]
    ds_read_b128 v[144:147], v193 offset:32768
    v_mfma_f32_16x16x32_bf16 v[68:71], v[164:167], v[128:131], v[68:71]
    ds_read_b64_tr_b16 v[176:177], v196 offset:20480
    v_mfma_f32_16x16x32_bf16 v[72:75], v[168:171], v[128:131], v[72:75]
    ds_read_b64_tr_b16 v[178:179], v196 offset:20992
    v_mfma_f32_16x16x32_bf16 v[76:79], v[172:175], v[128:131], v[76:79]
    ds_read_b64_tr_b16 v[180:181], v197 offset:20480
    s_waitcnt lgkmcnt(6)
    v_mfma_f32_16x16x32_bf16 v[80:83], v[160:163], v[132:135], v[80:83]
    ds_read_b64_tr_b16 v[182:183], v197 offset:20992
    s_add_u32 m0, s30, 24576
    s_nop 0
    buffer_load_dwordx4 v198, s[8:11], s27 offen lds
    s_add_u32 s27, s27, 128
    v_mfma_f32_16x16x32_bf16 v[84:87], v[164:167], v[132:135], v[84:87]
    ds_read_b64_tr_b16 v[184:185], v196 offset:28672
    v_mfma_f32_16x16x32_bf16 v[88:91], v[168:171], v[132:135], v[88:91]
    ds_read_b64_tr_b16 v[186:187], v196 offset:29184
    v_mfma_f32_16x16x32_bf16 v[92:95], v[172:175], v[132:135], v[92:95]
    ds_read_b64_tr_b16 v[188:189], v197 offset:28672
    s_waitcnt lgkmcnt(9)
    v_mfma_f32_16x16x32_bf16 v[96:99], v[160:163], v[136:139], v[96:99]
    ds_read_b64_tr_b16 v[190:191], v197 offset:29184
    v_mfma_f32_16x16x32_bf16 v[100:103], v[164:167], v[136:139], v[100:103]
    ds_read_b128 v[148:151], v193 offset:33792
    s_add_u32 m0, s31, 98304
    s_nop 0
    buffer_load_dwordx4 v199, s[20:23], s28 offen lds
    v_mfma_f32_16x16x32_bf16 v[104:107], v[168:171], v[136:139], v[104:107]
    ds_read_b128 v[152:155], v193 offset:36864
    v_mfma_f32_16x16x32_bf16 v[108:111], v[172:175], v[136:139], v[108:111]
    ds_read_b128 v[156:159], v193 offset:37888
    s_waitcnt lgkmcnt(12)
    v_mfma_f32_16x16x32_bf16 v[112:115], v[160:163], v[140:143], v[112:115]
    v_mfma_f32_16x16x32_bf16 v[116:119], v[164:167], v[140:143], v[116:119]
    v_mfma_f32_16x16x32_bf16 v[120:123], v[168:171], v[140:143], v[120:123]
    s_add_u32 m0, s31, 99328
    s_nop 0
    buffer_load_dwordx4 v200, s[20:23], s28 offen lds
    s_add_u32 s28, s28, s29
    v_mfma_f32_16x16x32_bf16 v[124:127], v[172:175], v[140:143], v[124:127]
    s_waitcnt lgkmcnt(0)
    s_waitcnt vmcnt(6)
    s_barrier
    v_mfma_f32_16x16x32_bf16 v[64:67], v[176:179], v[144:147], v[64:67]
    ds_read_b128 v[128:131], v194 offset:0
    v_mfma_f32_16x16x32_bf16 v[68:71], v[180:183], v[144:147], v[68:71]
    ds_read_b64_tr_b16 v[160:161], v196 offset:32768
    v_mfma_f32_16x16x32_bf16 v[72:75], v[184:187], v[144:147], v[72:75]
    ds_read_b64_tr_b16 v[162:163], v196 offset:33280
    v_mfma_f32_16x16x32_bf16 v[76:79], v[188:191], v[144:147], v[76:79]
    ds_read_b64_tr_b16 v[164:165], v197 offset:32768
    v_mfma_f32_16x16x32_bf16 v[80:83], v[176:179], v[148:151], v[80:83]
    ds_read_b64_tr_b16 v[166:167], v197 offset:33280
    s_add_u32 m0, s30, 32768
    s_nop 0
    buffer_load_dwordx4 v198, s[8:11], s24 offen lds
    s_add_u32 s24, s24, 128
    v_mfma_f32_16x16x32_bf16 v[84:87], v[180:183], v[148:151], v[84:87]
    ds_read_b64_tr_b16 v[168:169], v196 offset:40960
    v_mfma_f32_16x16x32_bf16 v[88:91], v[184:187], v[148:151], v[88:91]
    ds_read_b64_tr_b16 v[170:171], v196 offset:41472
    v_mfma_f32_16x16x32_bf16 v[92:95], v[188:191], v[148:151], v[92:95]
    ds_read_b64_tr_b16 v[172:173], v197 offset:40960
    v_mfma_f32_16x16x32_bf16 v[96:99], v[176:179], v[152:155], v[96:99]
    ds_read_b64_tr_b16 v[174:175], v197 offset:41472
    v_mfma_f32_16x16x32_bf16 v[100:103], v[180:183], v[152:155], v[100:103]
    ds_read_b128 v[132:135], v194 offset:1024
    s_add_u32 m0, s30, 40960
    s_nop 0
    buffer_load_dwordx4 v198, s[8:11], s25 offen lds
    s_add_u32 s25, s25, 128
    v_mfma_f32_16x16x32_bf16 v[104:107], v[184:187], v[152:155], v[104:107]
    ds_read_b128 v[136:139], v194 offset:4096
    v_mfma_f32_16x16x32_bf16 v[108:111], v[188:191], v[152:155], v[108:111]
    ds_read_b128 v[140:143], v194 offset:5120
    v_mfma_f32_16x16x32_bf16 v[112:115], v[176:179], v[156:159], v[112:115]
    v_mfma_f32_16x16x32_bf16 v[116:119], v[180:183], v[156:159], v[116:119]
    v_mfma_f32_16x16x32_bf16 v[120:123], v[184:187], v[156:159], v[120:123]
    s_add_u32 m0, s30, 49152
    s_nop 0
    buffer_load_dwordx4 v198, s[8:11], s26 offen lds
    s_add_u32 s26, s26, 128
    v_mfma_f32_16x16x32_bf16 v[124:127], v[188:191], v[156:159], v[124:127]
    s_waitcnt lgkmcnt(3)
    v_mfma_f32_16x16x32_bf16 v[64:67], v[160:163], v[128:131], v[64:67]
    ds_read_b128 v[144:147], v195 offset:0
    v_mfma_f32_16x16x32_bf16 v[68:71], v[164:167], v[128:131], v[68:71]
    ds_read_b64_tr_b16 v[176:177], v196 offset:36864
    v_mfma_f32_16x16x32_bf16 v[72:75], v[168:171], v[128:131], v[72:75]
    ds_read_b64_tr_b16 v[178:179], v196 offset:37376
    v_mfma_f32_16x16x32_bf16 v[76:79], v[172:175], v[128:131], v[76:79]
    ds_read_b64_tr_b16 v[180:181], v197 offset:36864
    s_waitcnt lgkmcnt(6)
    v_mfma_f32_16x16x32_bf16 v[80:83], v[160:163], v[132:135], v[80:83]
    ds_read_b64_tr_b16 v[182:183], v197 offset:37376
    s_add_u32 m0, s30, 57344
    s_nop 0
    buffer_load_dwordx4 v198, s[8:11], s27 offen lds
    s_add_u32 s27, s27, 128
    v_mfma_f32_16x16x32_bf16 v[84:87], v[164:167], v[132:135], v[84:87]
    ds_read_b64_tr_b16 v[184:185], v196 offset:45056
    v_mfma_f32_16x16x32_bf16 v[88:91], v[168:171], v[132:135], v[88:91]
    ds_read_b64_tr_b16 v[186:187], v196 offset:45568
    v_mfma_f32_16x16x32_bf16 v[92:95], v[172:175], v[132:135], v[92:95]
    ds_read_b64_tr_b16 v[188:189], v197 offset:45056
    s_waitcnt lgkmcnt(9)
    v_mfma_f32_16x16x32_bf16 v[96:99], v[160:163], v[136:139], v[96:99]
    ds_read_b64_tr_b16 v[190:191], v197 offset:45568
    v_mfma_f32_16x16x32_bf16 v[100:103], v[164:167], v[136:139], v[100:103]
    ds_read_b128 v[148:151], v195 offset:1024
    s_add_u32 m0, s31, 114688
    s_nop 0
    buffer_load_dwordx4 v199, s[20:23], s28 offen lds
    v_mfma_f32_16x16x32_bf16 v[104:107], v[168:171], v[136:139], v[104:107]
    ds_read_b128 v[152:155], v195 offset:4096
    v_mfma_f32_16x16x32_bf16 v[108:111], v[172:175], v[136:139], v[108:111]
    ds_read_b128 v[156:159], v195 offset:5120
    s_waitcnt lgkmcnt(12)
    v_mfma_f32_16x16x32_bf16 v[112:115], v[160:163], v[140:143], v[112:115]
    v_mfma_f32_16x16x32_bf16 v[116:119], v[164:167], v[140:143], v[116:119]
    v_mfma_f32_16x16x32_bf16 v[120:123], v[168:171], v[140:143], v[120:123]
    s_add_u32 m0, s31, 115712
    s_nop 0
    buffer_load_dwordx4 v200, s[20:23], s28 offen lds
    s_add_u32 s28, s28, s29
    v_mfma_f32_16x16x32_bf16 v[124:127], v[172:175], v[140:143], v[124:127]
    s_waitcnt lgkmcnt(0)
    s_waitcnt vmcnt(6)
    s_barrier
    v_mfma_f32_16x16x32_bf16 v[64:67], v[176:179], v[144:147], v[64:67]
    ds_read_b128 v[128:131], v192 offset:0
    v_mfma_f32_16x16x32_bf16 v[68:71], v[180:183], v[144:147], v[68:71]
    ds_read_b64_tr_b16 v[160:161], v196 offset:0
    v_mfma_f32_16x16x32_bf16 v[72:75], v[184:187], v[144:147], v[72:75]
    ds_read_b64_tr_b16 v[162:163], v196 offset:512
    v_mfma_f32_16x16x32_bf16 v[76:79], v[188:191], v[144:147], v[76:79]
    ds_read_b64_tr_b16 v[164:165], v197 offset:0
    v_mfma_f32_16x16x32_bf16 v[80:83], v[176:179], v[148:151], v[80:83]
    ds_read_b64_tr_b16 v[166:167], v197 offset:512
    s_add_u32 m0, s30, 65536
    s_nop 0
    buffer_load_dwordx4 v198, s[8:11], s24 offen lds
    s_add_u32 s24, s24, 128
    v_mfma_f32_16x16x32_bf16 v[84:87], v[180:183], v[148:151], v[84:87]
    ds_read_b64_tr_b16 v[168:169], v196 offset:8192
    v_mfma_f32_16x16x32_bf16 v[88:91], v[184:187], v[148:151], v[88:91]
    ds_read_b64_tr_b16 v[170:171], v196 offset:8704
    v_mfma_f32_16x16x32_bf16 v[92:95], v[188:191], v[148:151], v[92:95]
    ds_read_b64_tr_b16 v[172:173], v197 offset:8192
    v_mfma_f32_16x16x32_bf16 v[96:99], v[176:179], v[152:155], v[96:99]
    ds_read_b64_tr_b16 v[174:175], v197 offset:8704
    v_mfma_f32_16x16x32_bf16 v[100:103], v[180:183], v[152:155], v[100:103]
    ds_read_b128 v[132:135], v192 offset:1024
    s_add_u32 m0, s30, 73728
    s_nop 0
    buffer_load_dwordx4 v198, s[8:11], s25 offen lds
    s_add_u32 s25, s25, 128
    v_mfma_f32_16x16x32_bf16 v[104:107], v[184:187], v[152:155], v[104:107]
    ds_read_b128 v[136:139], v192 offset:4096
    v_mfma_f32_16x16x32_bf16 v[108:111], v[188:191], v[152:155], v[108:111]
    ds_read_b128 v[140:143], v192 offset:5120
    v_mfma_f32_16x16x32_bf16 v[112:115], v[176:179], v[156:159], v[112:115]
    v_mfma_f32_16x16x32_bf16 v[116:119], v[180:183], v[156:159], v[116:119]
    v_mfma_f32_16x16x32_bf16 v[120:123], v[184:187], v[156:159], v[120:123]
    s_add_u32 m0, s30, 81920
    s_nop 0
    buffer_load_dwordx4 v198, s[8:11], s26 offen lds
    s_add_u32 s26, s26, 128
    v_mfma_f32_16x16x32_bf16 v[124:127], v[188:191], v[156:159], v[124:127]
    s_waitcnt lgkmcnt(3)
    v_mfma_f32_16x16x32_bf16 v[64:67], v[160:163], v[128:131], v[64:67]
    ds_read_b128 v[144:147], v193 offset:0
    v_mfma_f32_16x16x32_bf16 v[68:71], v[164:167], v[128:131], v[68:71]
    ds_read_b64_tr_b16 v[176:177], v196 offset:4096
    v_mfma_f32_16x16x32_bf16 v[72:75], v[168:171], v[128:131], v[72:75]
    ds_read_b64_tr_b16 v[178:179], v196 offset:4608
    v_mfma_f32_16x16x32_bf16 v[76:79], v[172:175], v[128:131], v[76:79]
    ds_read_b64_tr_b16 v[180:181], v197 offset:4096
    s_waitcnt lgkmcnt(6)
    v_mfma_f32_16x16x32_bf16 v[80:83], v[160:163], v[132:135], v[80:83]
    ds_read_b64_tr_b16 v[182:183], v197 offset:4608
    s_add_u32 m0, s30, 90112
    s_nop 0
    buffer_load_dwordx4 v198, s[8:11], s27 offen lds
    s_add_u32 s27, s27, 128
    v_mfma_f32_16x16x32_bf16 v[84:87], v[164:167], v[132:135], v[84:87]
    ds_read_b64_tr_b16 v[184:185], v196 offset:12288
    v_mfma_f32_16x16x32_bf16 v[88:91], v[168:171], v[132:135], v[88:91]
    ds_read_b64_tr_b16 v[186:187], v196 offset:12800
    v_mfma_f32_16x16x32_bf16 v[92:95], v[172:175], v[132:135], v[92:95]
    ds_read_b64_tr_b16 v[188:189], v197 offset:12288
    s_waitcnt lgkmcnt(9)
    v_mfma_f32_16x16x32_bf16 v[96:99], v[160:163], v[136:139], v[96:99]
    ds_read_b64_tr_b16 v[190:191], v197 offset:12800
    v_mfma_f32_16x16x32_bf16 v[100:103], v[164:167], v[136:139], v[100:103]
    ds_read_b128 v[148:151], v193 offset:1024
    s_add_u32 m0, s31, 131072
    s_nop 0
    buffer_load_dwordx4 v199, s[20:23], s28 offen lds
    v_mfma_f32_16x16x32_bf16 v[104:107], v[168:171], v[136:139], v[104:107]
    ds_read_b128 v[152:155], v193 offset:4096
    v_mfma_f32_16x16x32_bf16 v[108:111], v[172:175], v[136:139], v[108:111]
    ds_read_b128 v[156:159], v193 offset:5120
    s_waitcnt lgkmcnt(12)
    v_mfma_f32_16x16x32_bf16 v[112:115], v[160:163], v[140:143], v[112:115]
    v_mfma_f32_16x16x32_bf16 v[116:119], v[164:167], v[140:143], v[116:119]
    v_mfma_f32_16x16x32_bf16 v[120:123], v[168:171], v[140:143], v[120:123]
    s_add_u32 m0, s31, 132096
    s_nop 0
    buffer_load_dwordx4 v200, s[20:23], s28 offen lds
    s_add_u32 s28, s28, s29
    v_mfma_f32_16x16x32_bf16 v[124:127], v[172:175], v[140:143], v[124:127]
    s_waitcnt lgkmcnt(0)
    s_waitcnt vmcnt(6)
    s_barrier
    s_lshr_b32 s40, s12, 2
    s_and_b32 s41, s12, 3
    s_lshl_b32 s41, s41, 1
    s_or_b32 s40, s40, s41
    s_lshl_b32 s40, s40, 4
    s_add_u32 s40, s40, 19959808
    v_lshlrev_b32 v251, 7, v1
    v_add_u32 v251, s40, v251
    v_lshlrev_b32 v252, 4, v1
    v_add_u32 v252, 19926528, v252
    v_cmp_le_u32 vcc, 32, v1
    s_nop 1
    v_cndmask_b32 v251, v251, v252, vcc
    s_cmp_lg_u32 s3, 0
    s_cbranch_scc1 w0_7
    buffer_load_dword v252, v251, s[4:7], 0 offen sc1
w0_7:
    v_mfma_f32_16x16x32_bf16 v[64:67], v[176:179], v[144:147], v[64:67]
    ds_read_b128 v[128:131], v192 offset:32768
    v_mfma_f32_16x16x32_bf16 v[68:71], v[180:183], v[144:147], v[68:71]
    ds_read_b64_tr_b16 v[160:161], v196 offset:16384
    v_mfma_f32_16x16x32_bf16 v[72:75], v[184:187], v[144:147], v[72:75]
    ds_read_b64_tr_b16 v[162:163], v196 offset:16896
    v_mfma_f32_16x16x32_bf16 v[76:79], v[188:191], v[144:147], v[76:79]
    ds_read_b64_tr_b16 v[164:165], v197 offset:16384
    v_mfma_f32_16x16x32_bf16 v[80:83], v[176:179], v[148:151], v[80:83]
    ds_read_b64_tr_b16 v[166:167], v197 offset:16896
    s_add_u32 m0, s30, 0
    s_nop 0
    buffer_load_dwordx4 v198, s[8:11], s24 offen lds
    s_add_u32 s24, s24, 128
    v_mfma_f32_16x16x32_bf16 v[84:87], v[180:183], v[148:151], v[84:87]
    ds_read_b64_tr_b16 v[168:169], v196 offset:24576
    v_mfma_f32_16x16x32_bf16 v[88:91], v[184:187], v[148:151], v[88:91]
    ds_read_b64_tr_b16 v[170:171], v196 offset:25088
    v_mfma_f32_16x16x32_bf16 v[92:95], v[188:191], v[148:151], v[92:95]
    ds_read_b64_tr_b16 v[172:173], v197 offset:24576
    v_mfma_f32_16x16x32_bf16 v[96:99], v[176:179], v[152:155], v[96:99]
    ds_read_b64_tr_b16 v[174:175], v197 offset:25088
    v_mfma_f32_16x16x32_bf16 v[100:103], v[180:183], v[152:155], v[100:103]
    ds_read_b128 v[132:135], v192 offset:33792
    s_add_u32 m0, s30, 8192
    s_nop 0
    buffer_load_dwordx4 v198, s[8:11], s25 offen lds
    s_add_u32 s25, s25, 128
    v_mfma_f32_16x16x32_bf16 v[104:107], v[184:187], v[152:155], v[104:107]
    ds_read_b128 v[136:139], v192 offset:36864
    v_mfma_f32_16x16x32_bf16 v[108:111], v[188:191], v[152:155], v[108:111]
    ds_read_b128 v[140:143], v192 offset:37888
    v_mfma_f32_16x16x32_bf16 v[112:115], v[176:179], v[156:159], v[112:115]
    v_mfma_f32_16x16x32_bf16 v[116:119], v[180:183], v[156:159], v[116:119]
    v_mfma_f32_16x16x32_bf16 v[120:123], v[184:187], v[156:159], v[120:123]
    s_add_u32 m0, s30, 16384
    s_nop 0
    buffer_load_dwordx4 v198, s[8:11], s26 offen lds
    s_add_u32 s26, s26, 128
    v_mfma_f32_16x16x32_bf16 v[124:127], v[188:191], v[156:159], v[124:127]
    s_waitcnt lgkmcnt(3)
    v_mfma_f32_16x16x32_bf16 v[64:67], v[160:163], v[128:131], v[64:67]
    ds_read_b128 v[144:147], v193 offset:32768
    v_mfma_f32_16x16x32_bf16 v[68:71], v[164:167], v[128:131], v[68:71]
    ds_read_b64_tr_b16 v[176:177], v196 offset:20480
    v_mfma_f32_16x16x32_bf16 v[72:75], v[168:171], v[128:131], v[72:75]
    ds_read_b64_tr_b16 v[178:179], v196 offset:20992
    v_mfma_f32_16x16x32_bf16 v[76:79], v[172:175], v[128:131], v[76:79]
    ds_read_b64_tr_b16 v[180:181], v197 offset:20480
    s_waitcnt lgkmcnt(6)
    v_mfma_f32_16x16x32_bf16 v[80:83], v[160:163], v[132:135], v[80:83]
    ds_read_b64_tr_b16 v[182:183], v197 offset:20992
    s_add_u32 m0, s30, 24576
    s_nop 0
    buffer_load_dwordx4 v198, s[8:11], s27 offen lds
    s_add_u32 s27, s27, 128
    v_mfma_f32_16x16x32_bf16 v[84:87], v[164:167], v[132:135], v[84:87]
    ds_read_b64_tr_b16 v[184:185], v196 offset:28672
    v_mfma_f32_16x16x32_bf16 v[88:91], v[168:171], v[132:135], v[88:91]
    ds_read_b64_tr_b16 v[186:187], v196 offset:29184
    v_mfma_f32_16x16x32_bf16 v[92:95], v[172:175], v[132:135], v[92:95]
    ds_read_b64_tr_b16 v[188:189], v197 offset:28672
    s_waitcnt lgkmcnt(9)
    v_mfma_f32_16x16x32_bf16 v[96:99], v[160:163], v[136:139], v[96:99]
    ds_read_b64_tr_b16 v[190:191], v197 offset:29184
    v_mfma_f32_16x16x32_bf16 v[100:103], v[164:167], v[136:139], v[100:103]
    ds_read_b128 v[148:151], v193 offset:33792
    s_add_u32 m0, s31, 98304
    s_nop 0
    buffer_load_dwordx4 v199, s[20:23], s28 offen lds
    v_mfma_f32_16x16x32_bf16 v[104:107], v[168:171], v[136:139], v[104:107]
    ds_read_b128 v[152:155], v193 offset:36864
    v_mfma_f32_16x16x32_bf16 v[108:111], v[172:175], v[136:139], v[108:111]
    ds_read_b128 v[156:159], v193 offset:37888
    s_waitcnt lgkmcnt(12)
    v_mfma_f32_16x16x32_bf16 v[112:115], v[160:163], v[140:143], v[112:115]
    v_mfma_f32_16x16x32_bf16 v[116:119], v[164:167], v[140:143], v[116:119]
    v_mfma_f32_16x16x32_bf16 v[120:123], v[168:171], v[140:143], v[120:123]
    s_add_u32 m0, s31, 99328
    s_nop 0
    buffer_load_dwordx4 v200, s[20:23], s28 offen lds
    s_add_u32 s28, s28, s29
    v_mfma_f32_16x16x32_bf16 v[124:127], v[172:175], v[140:143], v[124:127]
    s_waitcnt lgkmcnt(0)
    s_waitcnt vmcnt(6)
    s_cmp_lg_u32 s3, 0
    s_cbranch_scc1 w0_8
    v_cmp_gt_u32 vcc, 59, v1
    s_and_saveexec_b64 s[52:53], vcc
    s_mov_b32 s61, 65536
pf_9_loop:
    v_cmp_ne_u32 vcc, s60, v252
    s_nop 4
    s_cmp_eq_u64 vcc, 0
    s_cbranch_scc1 pf_9_done
    s_sleep 1
    buffer_load_dword v252, v251, s[4:7], 0 offen sc1
    s_waitcnt vmcnt(0)
    s_sub_u32 s61, s61, 1
    s_cmp_lg_u32 s61, 0
    s_cbranch_scc1 pf_9_loop
pf_9_done:
    s_mov_b64 exec, s[52:53]
w0_8:
    s_barrier
    s_cmp_lt_u32 s3, 2
    s_cbranch_scc1 cst_10_cs
    s_cmp_eq_u32 s3, 2
    s_cbranch_scc1 cst_10_b1
    s_sub_u32 s40, s3, 4
    s_and_b32 s40, s40, 3
    s_lshl_b32 s40, s40, 6
    s_add_u32 s40, s40, s14
    v_add_u32 v2, s40, v1
    v_lshlrev_b32 v2, 4, v2
    buffer_load_dwordx2 v[248:249], v2, s[4:7], 0 offen offset:0 sc1
    s_branch cst_10_st
cst_10_cs:
    s_lshl_b32 s40, s15, 6
    s_lshl_b32 s41, s16, 6
    s_cmp_eq_u32 s18, 1
    s_cselect_b32 s42, 1920, 0
    s_add_u32 s41, s41, s42
    s_cmp_eq_u32 s3, 0
    s_cselect_b32 s40, s40, s41
    v_add_u32 v2, s40, v1
    v_lshlrev_b32 v2, 2, v2
    s_mov_b32 s42, 32768
    buffer_load_dword v248, v2, s[4:7], s42 offen sc1
    s_branch cst_10_st
cst_10_b1:
    s_mov_b32 s48, s74
    s_and_b32 s49, s75, 0xffff
    s_mov_b32 s50, 3072
    s_mov_b32 s51, 0x20000
    s_lshl_b32 s40, s16, 7
    v_lshlrev_b32 v3, 1, v1
    buffer_load_ushort v248, v3, s[48:51], s40 offen
cst_10_st:
    v_and_b32 v2, 3, v1
    v_and_b32 v3, 4, v1
    v_add_u32 v2, v2, v3
    v_and_b32 v3, 8, v1
    v_lshl_add_u32 v2, v3, 1, v2
    s_and_b32 s40, s3, 3
    s_lshl_b32 s40, s40, 6
    s_add_u32 s40, s40, s14
    v_add_u32 v2, s40, v2
    v_lshlrev_b32 v2, 4, v2
    buffer_load_dwordx4 v[232:235], v2, s[4:7], 0 offen offset:0 sc1
    buffer_load_dwordx4 v[236:239], v2, s[4:7], 0 offen offset:128 sc1
    buffer_load_dwordx4 v[240:243], v2, s[4:7], 0 offen offset:512 sc1
    buffer_load_dwordx4 v[244:247], v2, s[4:7], 0 offen offset:640 sc1
    v_mfma_f32_16x16x32_bf16 v[64:67], v[176:179], v[144:147], v[64:67]
    ds_read_b128 v[128:131], v194 offset:0
    v_mfma_f32_16x16x32_bf16 v[68:71], v[180:183], v[144:147], v[68:71]
    ds_read_b64_tr_b16 v[160:161], v196 offset:32768
    v_mfma_f32_16x16x32_bf16 v[72:75], v[184:187], v[144:147], v[72:75]
    ds_read_b64_tr_b16 v[162:163], v196 offset:33280
    v_mfma_f32_16x16x32_bf16 v[76:79], v[188:191], v[144:147], v[76:79]
    ds_read_b64_tr_b16 v[164:165], v197 offset:32768
    v_mfma_f32_16x16x32_bf16 v[80:83], v[176:179], v[148:151], v[80:83]
    ds_read_b64_tr_b16 v[166:167], v197 offset:33280
    v_mfma_f32_16x16x32_bf16 v[84:87], v[180:183], v[148:151], v[84:87]
    ds_read_b64_tr_b16 v[168:169], v196 offset:40960
    v_mfma_f32_16x16x32_bf16 v[88:91], v[184:187], v[148:151], v[88:91]
    ds_read_b64_tr_b16 v[170:171], v196 offset:41472
    v_mfma_f32_16x16x32_bf16 v[92:95], v[188:191], v[148:151], v[92:95]
    ds_read_b64_tr_b16 v[172:173], v197 offset:40960
    v_mfma_f32_16x16x32_bf16 v[96:99], v[176:179], v[152:155], v[96:99]
    ds_read_b64_tr_b16 v[174:175], v197 offset:41472
    v_mfma_f32_16x16x32_bf16 v[100:103], v[180:183], v[152:155], v[100:103]
    ds_read_b128 v[132:135], v194 offset:1024
    v_mfma_f32_16x16x32_bf16 v[104:107], v[184:187], v[152:155], v[104:107]
    ds_read_b128 v[136:139], v194 offset:4096
    v_mfma_f32_16x16x32_bf16 v[108:111], v[188:191], v[152:155], v[108:111]
    ds_read_b128 v[140:143], v194 offset:5120
    v_mfma_f32_16x16x32_bf16 v[112:115], v[176:179], v[156:159], v[112:115]
    v_mfma_f32_16x16x32_bf16 v[116:119], v[180:183], v[156:159], v[116:119]
    v_mfma_f32_16x16x32_bf16 v[120:123], v[184:187], v[156:159], v[120:123]
    v_mfma_f32_16x16x32_bf16 v[124:127], v[188:191], v[156:159], v[124:127]
    s_waitcnt lgkmcnt(3)
    v_mfma_f32_16x16x32_bf16 v[64:67], v[160:163], v[128:131], v[64:67]
    ds_read_b128 v[144:147], v195 offset:0
    v_mfma_f32_16x16x32_bf16 v[68:71], v[164:167], v[128:131], v[68:71]
    ds_read_b64_tr_b16 v[176:177], v196 offset:36864
    v_mfma_f32_16x16x32_bf16 v[72:75], v[168:171], v[128:131], v[72:75]
    ds_read_b64_tr_b16 v[178:179], v196 offset:37376
    v_mfma_f32_16x16x32_bf16 v[76:79], v[172:175], v[128:131], v[76:79]
    ds_read_b64_tr_b16 v[180:181], v197 offset:36864
    s_waitcnt lgkmcnt(6)
    v_mfma_f32_16x16x32_bf16 v[80:83], v[160:163], v[132:135], v[80:83]
    ds_read_b64_tr_b16 v[182:183], v197 offset:37376
    v_mfma_f32_16x16x32_bf16 v[84:87], v[164:167], v[132:135], v[84:87]
    ds_read_b64_tr_b16 v[184:185], v196 offset:45056
    v_mfma_f32_16x16x32_bf16 v[88:91], v[168:171], v[132:135], v[88:91]
    ds_read_b64_tr_b16 v[186:187], v196 offset:45568
    v_mfma_f32_16x16x32_bf16 v[92:95], v[172:175], v[132:135], v[92:95]
    ds_read_b64_tr_b16 v[188:189], v197 offset:45056
    s_waitcnt lgkmcnt(9)
    v_mfma_f32_16x16x32_bf16 v[96:99], v[160:163], v[136:139], v[96:99]
    ds_read_b64_tr_b16 v[190:191], v197 offset:45568
    v_mfma_f32_16x16x32_bf16 v[100:103], v[164:167], v[136:139], v[100:103]
    ds_read_b128 v[148:151], v195 offset:1024
    v_mfma_f32_16x16x32_bf16 v[104:107], v[168:171], v[136:139], v[104:107]
    ds_read_b128 v[152:155], v195 offset:4096
    v_mfma_f32_16x16x32_bf16 v[108:111], v[172:175], v[136:139], v[108:111]
    ds_read_b128 v[156:159], v195 offset:5120
    s_waitcnt lgkmcnt(12)
    v_mfma_f32_16x16x32_bf16 v[112:115], v[160:163], v[140:143], v[112:115]
    v_mfma_f32_16x16x32_bf16 v[116:119], v[164:167], v[140:143], v[116:119]
    v_mfma_f32_16x16x32_bf16 v[120:123], v[168:171], v[140:143], v[120:123]
    v_mfma_f32_16x16x32_bf16 v[124:127], v[172:175], v[140:143], v[124:127]
    s_waitcnt lgkmcnt(0)
    s_waitcnt vmcnt(5)
    s_barrier
    v_mfma_f32_16x16x32_bf16 v[64:67], v[176:179], v[144:147], v[64:67]
    ds_read_b128 v[128:131], v192 offset:0
    v_mfma_f32_16x16x32_bf16 v[68:71], v[180:183], v[144:147], v[68:71]
    ds_read_b64_tr_b16 v[160:161], v196 offset:0
    v_mfma_f32_16x16x32_bf16 v[72:75], v[184:187], v[144:147], v[72:75]
    ds_read_b64_tr_b16 v[162:163], v196 offset:512
    v_mfma_f32_16x16x32_bf16 v[76:79], v[188:191], v[144:147], v[76:79]
    ds_read_b64_tr_b16 v[164:165], v197 offset:0
    v_mfma_f32_16x16x32_bf16 v[80:83], v[176:179], v[148:151], v[80:83]
    ds_read_b64_tr_b16 v[166:167], v197 offset:512
    v_mfma_f32_16x16x32_bf16 v[84:87], v[180:183], v[148:151], v[84:87]
    ds_read_b64_tr_b16 v[168:169], v196 offset:8192
    v_mfma_f32_16x16x32_bf16 v[88:91], v[184:187], v[148:151], v[88:91]
    ds_read_b64_tr_b16 v[170:171], v196 offset:8704
    v_mfma_f32_16x16x32_bf16 v[92:95], v[188:191], v[148:151], v[92:95]
    ds_read_b64_tr_b16 v[172:173], v197 offset:8192
    v_mfma_f32_16x16x32_bf16 v[96:99], v[176:179], v[152:155], v[96:99]
    ds_read_b64_tr_b16 v[174:175], v197 offset:8704
    v_mfma_f32_16x16x32_bf16 v[100:103], v[180:183], v[152:155], v[100:103]
    ds_read_b128 v[132:135], v192 offset:1024
    v_mfma_f32_16x16x32_bf16 v[104:107], v[184:187], v[152:155], v[104:107]
    ds_read_b128 v[136:139], v192 offset:4096
    v_mfma_f32_16x16x32_bf16 v[108:111], v[188:191], v[152:155], v[108:111]
    ds_read_b128 v[140:143], v192 offset:5120
    v_mfma_f32_16x16x32_bf16 v[112:115], v[176:179], v[156:159], v[112:115]
    v_mfma_f32_16x16x32_bf16 v[116:119], v[180:183], v[156:159], v[116:119]
    v_mfma_f32_16x16x32_bf16 v[120:123], v[184:187], v[156:159], v[120:123]
    v_mfma_f32_16x16x32_bf16 v[124:127], v[188:191], v[156:159], v[124:127]
    s_waitcnt lgkmcnt(3)
    v_mfma_f32_16x16x32_bf16 v[64:67], v[160:163], v[128:131], v[64:67]
    ds_read_b128 v[144:147], v193 offset:0
    v_mfma_f32_16x16x32_bf16 v[68:71], v[164:167], v[128:131], v[68:71]
    ds_read_b64_tr_b16 v[176:177], v196 offset:4096
    v_mfma_f32_16x16x32_bf16 v[72:75], v[168:171], v[128:131], v[72:75]
    ds_read_b64_tr_b16 v[178:179], v196 offset:4608
    v_mfma_f32_16x16x32_bf16 v[76:79], v[172:175], v[128:131], v[76:79]
    ds_read_b64_tr_b16 v[180:181], v197 offset:4096
    s_waitcnt lgkmcnt(6)
    v_mfma_f32_16x16x32_bf16 v[80:83], v[160:163], v[132:135], v[80:83]
    ds_read_b64_tr_b16 v[182:183], v197 offset:4608
    v_mfma_f32_16x16x32_bf16 v[84:87], v[164:167], v[132:135], v[84:87]
    ds_read_b64_tr_b16 v[184:185], v196 offset:12288
    v_mfma_f32_16x16x32_bf16 v[88:91], v[168:171], v[132:135], v[88:91]
    ds_read_b64_tr_b16 v[186:187], v196 offset:12800
    v_mfma_f32_16x16x32_bf16 v[92:95], v[172:175], v[132:135], v[92:95]
    ds_read_b64_tr_b16 v[188:189], v197 offset:12288
    s_waitcnt lgkmcnt(9)
    v_mfma_f32_16x16x32_bf16 v[96:99], v[160:163], v[136:139], v[96:99]
    ds_read_b64_tr_b16 v[190:191], v197 offset:12800
    v_mfma_f32_16x16x32_bf16 v[100:103], v[164:167], v[136:139], v[100:103]
    ds_read_b128 v[148:151], v193 offset:1024
    v_mfma_f32_16x16x32_bf16 v[104:107], v[168:171], v[136:139], v[104:107]
    ds_read_b128 v[152:155], v193 offset:4096
    v_mfma_f32_16x16x32_bf16 v[108:111], v[172:175], v[136:139], v[108:111]
    ds_read_b128 v[156:159], v193 offset:5120
    s_waitcnt lgkmcnt(12)
    v_mfma_f32_16x16x32_bf16 v[112:115], v[160:163], v[140:143], v[112:115]
    v_mfma_f32_16x16x32_bf16 v[116:119], v[164:167], v[140:143], v[116:119]
    v_mfma_f32_16x16x32_bf16 v[120:123], v[168:171], v[140:143], v[120:123]
    v_mfma_f32_16x16x32_bf16 v[124:127], v[172:175], v[140:143], v[124:127]
    s_waitcnt lgkmcnt(0)
    s_waitcnt vmcnt(0)
    v_lshlrev_b32 v2, 2, v1
    s_cmp_lt_u32 s3, 2
    s_cbranch_scc1 cmt_11_cs
    s_cmp_eq_u32 s3, 2
    s_cbranch_scc1 cmt_11_b1
    s_cmp_lt_u32 s3, 4
    s_cbranch_scc1 cmt_11_e
    s_sub_u32 s40, s3, 4
    s_lshl_b32 s40, s40, 8
    s_add_u32 s40, s40, 148224
    v_add_u32 v2, s40, v2
    ds_write_b32 v2, v248
    ds_write_b32 v2, v249 offset:1024
    s_branch cmt_11_e
cmt_11_cs:
    s_lshl_b32 s40, s3, 8
    s_add_u32 s40, s40, 147456
    v_add_u32 v2, s40, v2
    ds_write_b32 v2, v248
    s_branch cmt_11_e
cmt_11_b1:
    v_add_u32 v2, 147968, v2
    v_lshlrev_b32 v248, 16, v248
    ds_write_b32 v2, v248
cmt_11_e:
    s_waitcnt lgkmcnt(0)
    s_barrier
    s_cmp_eq_u32 s17, 0
    s_cselect_b64 vcc, -1, 0
    v_cndmask_b32 v204, v233, v235, vcc
    v_mul_f32 v208, v204, v232
    v_sub_f32 v208, 0, v208
    s_cmp_eq_u32 s17, 0
    s_cselect_b64 vcc, -1, 0
    v_cndmask_b32 v205, v237, v239, vcc
    v_mul_f32 v209, v205, v236
    v_sub_f32 v209, 0, v209
    s_cmp_eq_u32 s17, 0
    s_cselect_b64 vcc, -1, 0
    v_cndmask_b32 v206, v241, v243, vcc
    v_mul_f32 v210, v206, v240
    v_sub_f32 v210, 0, v210
    s_cmp_eq_u32 s17, 0
    s_cselect_b64 vcc, -1, 0
    v_cndmask_b32 v207, v245, v247, vcc
    v_mul_f32 v211, v207, v244
    v_sub_f32 v211, 0, v211
    v_and_b32 v3, 3, v1
    v_and_b32 v2, 4, v1
    v_add_u32 v3, v3, v2
    v_and_b32 v2, 8, v1
    v_lshl_add_u32 v3, v2, 1, v3
    s_lshr_b32 s40, s3, 2
    s_and_b32 s42, s3, 3
    s_lshl_b32 s42, s42, 6
    s_add_u32 s42, s42, s14
    v_add_u32 v3, s42, v3
    v_lshlrev_b32 v3, 4, v3
    v_lshrrev_b32 v4, 4, v1
    v_and_b32 v2, 1, v4
    v_lshlrev_b32 v2, 1, v2
    v_lshrrev_b32 v6, 1, v4
    v_or_b32 v2, v2, v6
    v_lshl_add_u32 v3, v2, 15, v3
    s_lshl_b32 s41, s40, 7
    v_lshlrev_b32 v2, 4, v4
    v_add_u32 v2, s41, v2
    v_add_u32 v2, 147456, v2
    s_lshl_b32 s43, s15, 3
    s_lshl_b32 s44, s40, 2
    s_add_u32 s43, s43, s44
    s_lshl_b32 s43, s43, 15
    s_add_u32 s43, s43, 65536
    v_mfma_f32_16x16x32_bf16 v[64:67], v[176:179], v[144:147], v[64:67]
    v_mfma_f32_16x16x32_bf16 v[68:71], v[180:183], v[144:147], v[68:71]
    v_mfma_f32_16x16x32_bf16 v[72:75], v[184:187], v[144:147], v[72:75]
    v_mfma_f32_16x16x32_bf16 v[76:79], v[188:191], v[144:147], v[76:79]
    v_mfma_f32_16x16x32_bf16 v[80:83], v[176:179], v[148:151], v[80:83]
    v_mfma_f32_16x16x32_bf16 v[84:87], v[180:183], v[148:151], v[84:87]
    v_mfma_f32_16x16x32_bf16 v[88:91], v[184:187], v[148:151], v[88:91]
    v_mfma_f32_16x16x32_bf16 v[92:95], v[188:191], v[148:151], v[92:95]
    v_mfma_f32_16x16x32_bf16 v[96:99], v[176:179], v[152:155], v[96:99]
    v_mfma_f32_16x16x32_bf16 v[100:103], v[180:183], v[152:155], v[100:103]
    v_mfma_f32_16x16x32_bf16 v[104:107], v[184:187], v[152:155], v[104:107]
    v_mfma_f32_16x16x32_bf16 v[108:111], v[188:191], v[152:155], v[108:111]
    v_mfma_f32_16x16x32_bf16 v[112:115], v[176:179], v[156:159], v[112:115]
    v_mfma_f32_16x16x32_bf16 v[116:119], v[180:183], v[156:159], v[116:119]
    v_mfma_f32_16x16x32_bf16 v[120:123], v[184:187], v[156:159], v[120:123]
    v_mfma_f32_16x16x32_bf16 v[124:127], v[188:191], v[156:159], v[124:127]
    s_branch Lp1_epiT0
Lp1_vform:
    s_waitcnt vmcnt(8)
    s_barrier
    ds_read_b128 v[128:131], v192 offset:0
    ds_read_b64_tr_b16 v[160:161], v196 offset:0
    ds_read_b64_tr_b16 v[162:163], v196 offset:512
    ds_read_b64_tr_b16 v[164:165], v197 offset:0
    ds_read_b64_tr_b16 v[166:167], v197 offset:512
    ds_read_b64_tr_b16 v[168:169], v196 offset:8192
    ds_read_b64_tr_b16 v[170:171], v196 offset:8704
    ds_read_b64_tr_b16 v[172:173], v197 offset:8192
    ds_read_b64_tr_b16 v[174:175], v197 offset:8704
    ds_read_b128 v[132:135], v192 offset:1024
    ds_read_b128 v[136:139], v192 offset:4096
    ds_read_b128 v[140:143], v192 offset:5120
    s_waitcnt lgkmcnt(3)
    v_mfma_f32_16x16x32_bf16 v[64:67], v[128:131], v[160:163], 0
    ds_read_b128 v[144:147], v193 offset:0
    v_mfma_f32_16x16x32_bf16 v[68:71], v[128:131], v[164:167], 0
    ds_read_b64_tr_b16 v[176:177], v196 offset:4096
    v_mfma_f32_16x16x32_bf16 v[72:75], v[168:171], v[128:131], 0
    ds_read_b64_tr_b16 v[178:179], v196 offset:4608
    s_add_u32 m0, s30, 65536
    s_nop 0
    buffer_load_dwordx4 v198, s[8:11], s24 offen lds
    s_add_u32 s24, s24, 128
    v_mfma_f32_16x16x32_bf16 v[76:79], v[172:175], v[128:131], 0
    ds_read_b64_tr_b16 v[180:181], v197 offset:4096
    s_waitcnt lgkmcnt(6)
    v_mfma_f32_16x16x32_bf16 v[80:83], v[132:135], v[160:163], 0
    ds_read_b64_tr_b16 v[182:183], v197 offset:4608
    s_add_u32 m0, s30, 73728
    s_nop 0
    buffer_load_dwordx4 v198, s[8:11], s25 offen lds
    s_add_u32 s25, s25, 128
    v_mfma_f32_16x16x32_bf16 v[84:87], v[132:135], v[164:167], 0
    ds_read_b64_tr_b16 v[184:185], v196 offset:12288
    v_mfma_f32_16x16x32_bf16 v[88:91], v[168:171], v[132:135], 0
    ds_read_b64_tr_b16 v[186:187], v196 offset:12800
    v_mfma_f32_16x16x32_bf16 v[92:95], v[172:175], v[132:135], 0
    ds_read_b64_tr_b16 v[188:189], v197 offset:12288
    s_add_u32 m0, s30, 81920
    s_nop 0
    buffer_load_dwordx4 v198, s[8:11], s26 offen lds
    s_add_u32 s26, s26, 128
    s_waitcnt lgkmcnt(9)
    v_mfma_f32_16x16x32_bf16 v[96:99], v[136:139], v[160:163], 0
    ds_read_b64_tr_b16 v[190:191], v197 offset:12800
    v_mfma_f32_16x16x32_bf16 v[100:103], v[136:139], v[164:167], 0
    ds_read_b128 v[148:151], v193 offset:1024
    s_add_u32 m0, s30, 90112
    s_nop 0
    buffer_load_dwordx4 v198, s[8:11], s27 offen lds
    s_add_u32 s27, s27, 128
    v_mfma_f32_16x16x32_bf16 v[104:107], v[168:171], v[136:139], 0
    ds_read_b128 v[152:155], v193 offset:4096
    v_mfma_f32_16x16x32_bf16 v[108:111], v[172:175], v[136:139], 0
    ds_read_b128 v[156:159], v193 offset:5120
    s_waitcnt lgkmcnt(12)
    v_mfma_f32_16x16x32_bf16 v[112:115], v[140:143], v[160:163], 0
    s_add_u32 m0, s31, 131072
    s_nop 0
    buffer_load_dwordx4 v199, s[20:23], s28 offen lds
    v_mfma_f32_16x16x32_bf16 v[116:119], v[140:143], v[164:167], 0
    v_mfma_f32_16x16x32_bf16 v[120:123], v[168:171], v[140:143], 0
    s_add_u32 m0, s31, 132096
    s_nop 0
    buffer_load_dwordx4 v200, s[20:23], s28 offen lds
    s_add_u32 s28, s28, s29
    v_mfma_f32_16x16x32_bf16 v[124:127], v[172:175], v[140:143], 0
    s_waitcnt lgkmcnt(0)
    s_waitcnt vmcnt(6)
    v_lshlrev_b32 v216, 16, v208
    v_and_b32 v217, 0xffff0000, v208
    v_lshlrev_b32 v218, 16, v209
    v_and_b32 v219, 0xffff0000, v209
    v_lshlrev_b32 v220, 16, v210
    v_and_b32 v221, 0xffff0000, v210
    v_lshlrev_b32 v222, 16, v211
    v_and_b32 v223, 0xffff0000, v211
    v_lshlrev_b32 v224, 16, v212
    v_and_b32 v225, 0xffff0000, v212
    v_lshlrev_b32 v226, 16, v213
    v_and_b32 v227, 0xffff0000, v213
    v_lshlrev_b32 v228, 16, v214
    v_and_b32 v229, 0xffff0000, v214
    v_lshlrev_b32 v230, 16, v215
    v_and_b32 v231, 0xffff0000, v215
    v_pk_add_f32 v[6:7], v[216:217], v[218:219]
    v_pk_add_f32 v[8:9], v[220:221], v[222:223]
    v_pk_add_f32 v[10:11], v[224:225], v[226:227]
    v_pk_add_f32 v[12:13], v[228:229], v[230:231]
    v_pk_add_f32 v[6:7], v[6:7], v[8:9]
    v_pk_add_f32 v[10:11], v[10:11], v[12:13]
    v_pk_add_f32 v[6:7], v[6:7], v[10:11]
    v_add_f32 v6, v6, v7
    s_nop 1
    v_add_f32_dpp v6, v6, v6 row_ror:8 row_mask:0xf bank_mask:0xf
    s_nop 1
    v_add_f32_dpp v6, v6, v6 row_ror:4 row_mask:0xf bank_mask:0xf
    s_nop 1
    v_add_f32_dpp v6, v6, v6 row_ror:2 row_mask:0xf bank_mask:0xf
    s_nop 1
    v_add_f32_dpp v6, v6, v6 row_ror:1 row_mask:0xf bank_mask:0xf
    s_nop 0
    v_readlane_b32 s44, v6, 0
    v_readlane_b32 s45, v6, 16
    v_readlane_b32 s46, v6, 32
    v_readlane_b32 s47, v6, 48
    s_nop 1
    v_mov_b32 v6, s44
    v_add_f32 v6, s45, v6
    v_add_f32 v6, s46, v6
    v_add_f32 v6, s47, v6
    v_mul_f32 v8, 0x3acccccd, v6
    v_cmp_gt_u32 vcc, 40, v1
    v_sub_f32 v10, 0, v8
    s_nop 0
    v_cndmask_b32 v10, 0, v10, vcc
    v_mov_b32 v11, v10
    v_pk_add_f32 v[216:217], v[216:217], v[10:11]
    v_pk_add_f32 v[218:219], v[218:219], v[10:11]
    v_pk_add_f32 v[220:221], v[220:221], v[10:11]
    v_pk_add_f32 v[222:223], v[222:223], v[10:11]
    v_pk_add_f32 v[224:225], v[224:225], v[10:11]
    v_pk_add_f32 v[226:227], v[226:227], v[10:11]
    v_pk_add_f32 v[228:229], v[228:229], v[10:11]
    v_pk_add_f32 v[230:231], v[230:231], v[10:11]
    v_pk_mul_f32 v[6:7], v[216:217], v[216:217]
    v_pk_mul_f32 v[12:13], v[218:219], v[218:219]
    v_pk_fma_f32 v[6:7], v[220:221], v[220:221], v[6:7]
    v_pk_fma_f32 v[12:13], v[222:223], v[222:223], v[12:13]
    v_pk_fma_f32 v[6:7], v[224:225], v[224:225], v[6:7]
    v_pk_fma_f32 v[12:13], v[226:227], v[226:227], v[12:13]
    v_pk_fma_f32 v[6:7], v[228:229], v[228:229], v[6:7]
    v_pk_fma_f32 v[12:13], v[230:231], v[230:231], v[12:13]
    v_pk_add_f32 v[6:7], v[6:7], v[12:13]
    v_add_f32 v6, v6, v7
    s_nop 1
    v_add_f32_dpp v6, v6, v6 row_ror:8 row_mask:0xf bank_mask:0xf
    s_nop 1
    v_add_f32_dpp v6, v6, v6 row_ror:4 row_mask:0xf bank_mask:0xf
    s_nop 1
    v_add_f32_dpp v6, v6, v6 row_ror:2 row_mask:0xf bank_mask:0xf
    s_nop 1
    v_add_f32_dpp v6, v6, v6 row_ror:1 row_mask:0xf bank_mask:0xf
    s_nop 0
    v_readlane_b32 s44, v6, 0
    v_readlane_b32 s45, v6, 16
    v_readlane_b32 s46, v6, 32
    v_readlane_b32 s47, v6, 48
    s_nop 1
    v_mov_b32 v6, s44
    v_add_f32 v6, s45, v6
    v_add_f32 v6, s46, v6
    v_add_f32 v6, s47, v6
    v_mul_f32 v6, 0x3acccccd, v6
    v_add_f32 v7, 0x3727c5ac, v6
    v_rsq_f32 v9, v7
    s_nop 0
    v_mul_f32 v7, v9, v9
    v_mul_f32 v7, v7, v6
    v_add_f32 v7, 0x3727c5ac, v7
    v_rsq_f32 v7, v7
    s_nop 0
    v_mul_f32 v10, v9, v7
    v_mul_f32 v11, 0x3ea52b5c, v9
    s_and_b32 s40, s2, 1
    s_lshl_b32 s40, s40, 10
    s_lshr_b32 s41, s2, 1
    s_and_b32 s41, s41, 3
    s_lshl_b32 s41, s41, 8
    s_add_u32 s40, s40, s41
    s_lshr_b32 s41, s2, 3
    s_lshl_b32 s41, s41, 3
    s_add_u32 s40, s40, s41
    s_add_u32 s40, s40, s3
    s_lshl_b32 s40, s40, 4
    v_mov_b32 v12, 0
    s_mov_b64 exec, 1
    buffer_store_dwordx4 v[8:11], v12, s[4:7], s40 offen offset:0 sc1
    s_mov_b64 exec, -1
    s_barrier
    s_cmp_lg_u32 s3, 0
    s_cbranch_scc1 w0_12
    v_mov_b32 v250, 0
    buffer_load_dword v250, v250, s[56:59], 0 offen sc1
w0_12:
    v_mfma_f32_16x16x32_bf16 v[64:67], v[144:147], v[176:179], v[64:67]
    ds_read_b128 v[128:131], v192 offset:32768
    v_mfma_f32_16x16x32_bf16 v[68:71], v[144:147], v[180:183], v[68:71]
    ds_read_b64_tr_b16 v[160:161], v196 offset:16384
    v_mfma_f32_16x16x32_bf16 v[72:75], v[184:187], v[144:147], v[72:75]
    ds_read_b64_tr_b16 v[162:163], v196 offset:16896
    v_mfma_f32_16x16x32_bf16 v[76:79], v[188:191], v[144:147], v[76:79]
    ds_read_b64_tr_b16 v[164:165], v197 offset:16384
    v_mfma_f32_16x16x32_bf16 v[80:83], v[148:151], v[176:179], v[80:83]
    ds_read_b64_tr_b16 v[166:167], v197 offset:16896
    s_add_u32 m0, s30, 0
    s_nop 0
    buffer_load_dwordx4 v198, s[8:11], s24 offen lds
    s_add_u32 s24, s24, 128
    v_mfma_f32_16x16x32_bf16 v[84:87], v[148:151], v[180:183], v[84:87]
    ds_read_b64_tr_b16 v[168:169], v196 offset:24576
    v_mfma_f32_16x16x32_bf16 v[88:91], v[184:187], v[148:151], v[88:91]
    ds_read_b64_tr_b16 v[170:171], v196 offset:25088
    v_mfma_f32_16x16x32_bf16 v[92:95], v[188:191], v[148:151], v[92:95]
    ds_read_b64_tr_b16 v[172:173], v197 offset:24576
    v_mfma_f32_16x16x32_bf16 v[96:99], v[152:155], v[176:179], v[96:99]
    ds_read_b64_tr_b16 v[174:175], v197 offset:25088
    v_mfma_f32_16x16x32_bf16 v[100:103], v[152:155], v[180:183], v[100:103]
    ds_read_b128 v[132:135], v192 offset:33792
    s_add_u32 m0, s30, 8192
    s_nop 0
    buffer_load_dwordx4 v198, s[8:11], s25 offen lds
    s_add_u32 s25, s25, 128
    v_mfma_f32_16x16x32_bf16 v[104:107], v[184:187], v[152:155], v[104:107]
    ds_read_b128 v[136:139], v192 offset:36864
    v_mfma_f32_16x16x32_bf16 v[108:111], v[188:191], v[152:155], v[108:111]
    ds_read_b128 v[140:143], v192 offset:37888
    v_mfma_f32_16x16x32_bf16 v[112:115], v[156:159], v[176:179], v[112:115]
    v_mfma_f32_16x16x32_bf16 v[116:119], v[156:159], v[180:183], v[116:119]
    v_mfma_f32_16x16x32_bf16 v[120:123], v[184:187], v[156:159], v[120:123]
    s_add_u32 m0, s30, 16384
    s_nop 0
    buffer_load_dwordx4 v198, s[8:11], s26 offen lds
    s_add_u32 s26, s26, 128
    v_mfma_f32_16x16x32_bf16 v[124:127], v[188:191], v[156:159], v[124:127]
    s_waitcnt lgkmcnt(3)
    v_mfma_f32_16x16x32_bf16 v[64:67], v[128:131], v[160:163], v[64:67]
    ds_read_b128 v[144:147], v193 offset:32768
    v_mfma_f32_16x16x32_bf16 v[68:71], v[128:131], v[164:167], v[68:71]
    ds_read_b64_tr_b16 v[176:177], v196 offset:20480
    v_mfma_f32_16x16x32_bf16 v[72:75], v[168:171], v[128:131], v[72:75]
    ds_read_b64_tr_b16 v[178:179], v196 offset:20992
    v_mfma_f32_16x16x32_bf16 v[76:79], v[172:175], v[128:131], v[76:79]
    ds_read_b64_tr_b16 v[180:181], v197 offset:20480
    s_waitcnt lgkmcnt(6)
    v_mfma_f32_16x16x32_bf16 v[80:83], v[132:135], v[160:163], v[80:83]
    ds_read_b64_tr_b16 v[182:183], v197 offset:20992
    s_add_u32 m0, s30, 24576
    s_nop 0
    buffer_load_dwordx4 v198, s[8:11], s27 offen lds
    s_add_u32 s27, s27, 128
    v_mfma_f32_16x16x32_bf16 v[84:87], v[132:135], v[164:167], v[84:87]
    ds_read_b64_tr_b16 v[184:185], v196 offset:28672
    v_mfma_f32_16x16x32_bf16 v[88:91], v[168:171], v[132:135], v[88:91]
    ds_read_b64_tr_b16 v[186:187], v196 offset:29184
    v_mfma_f32_16x16x32_bf16 v[92:95], v[172:175], v[132:135], v[92:95]
    ds_read_b64_tr_b16 v[188:189], v197 offset:28672
    s_waitcnt lgkmcnt(9)
    v_mfma_f32_16x16x32_bf16 v[96:99], v[136:139], v[160:163], v[96:99]
    ds_read_b64_tr_b16 v[190:191], v197 offset:29184
    v_mfma_f32_16x16x32_bf16 v[100:103], v[136:139], v[164:167], v[100:103]
    ds_read_b128 v[148:151], v193 offset:33792
    s_add_u32 m0, s31, 98304
    s_nop 0
    buffer_load_dwordx4 v199, s[20:23], s28 offen lds
    v_mfma_f32_16x16x32_bf16 v[104:107], v[168:171], v[136:139], v[104:107]
    ds_read_b128 v[152:155], v193 offset:36864
    v_mfma_f32_16x16x32_bf16 v[108:111], v[172:175], v[136:139], v[108:111]
    ds_read_b128 v[156:159], v193 offset:37888
    s_waitcnt lgkmcnt(12)
    v_mfma_f32_16x16x32_bf16 v[112:115], v[140:143], v[160:163], v[112:115]
    v_mfma_f32_16x16x32_bf16 v[116:119], v[140:143], v[164:167], v[116:119]
    v_mfma_f32_16x16x32_bf16 v[120:123], v[168:171], v[140:143], v[120:123]
    s_add_u32 m0, s31, 99328
    s_nop 0
    buffer_load_dwordx4 v200, s[20:23], s28 offen lds
    s_add_u32 s28, s28, s29
    v_mfma_f32_16x16x32_bf16 v[124:127], v[172:175], v[140:143], v[124:127]
    s_waitcnt lgkmcnt(0)
    s_waitcnt vmcnt(6)
    s_cmp_lg_u32 s3, 0
    s_cbranch_scc1 w0_13
    s_cmp_lg_u32 s60, 0
    s_cbranch_scc1 tf_14
    v_readfirstlane_b32 s60, v250
    s_nop 3
tf_14:
    s_cmp_lg_u32 s60, 0
    s_cbranch_scc1 tag_15_ok
    s_mov_b32 s61, 65536
    v_mov_b32 v2, 0
tag_15_loop:
    buffer_load_dword v3, v2, s[56:59], 0 offen sc1
    s_waitcnt vmcnt(0)
    v_readfirstlane_b32 s60, v3
    s_nop 3
    s_cmp_lg_u32 s60, 0
    s_cbranch_scc1 tag_15_ok
    s_sleep 2
    s_sub_u32 s61, s61, 1
    s_cmp_lg_u32 s61, 0
    s_cbranch_scc1 tag_15_loop
tag_15_ok:
w0_13:
    s_barrier
    s_cmp_lg_u32 s3, 0
    s_cbranch_scc1 w0_16
    s_lshl_b32 s62, s2, 4
    s_add_u32 s62, s62, 19959808
    v_mov_b32 v4, 0
    v_mov_b32 v5, s60
    s_mov_b64 s[52:53], exec
    s_mov_b64 exec, 1
    buffer_store_dword v5, v4, s[4:7], s62 offen sc1
    s_mov_b64 exec, s[52:53]
w0_16:
    v_mfma_f32_16x16x32_bf16 v[64:67], v[144:147], v[176:179], v[64:67]
    ds_read_b128 v[128:131], v194 offset:0
    v_mfma_f32_16x16x32_bf16 v[68:71], v[144:147], v[180:183], v[68:71]
    ds_read_b64_tr_b16 v[160:161], v196 offset:32768
    v_mfma_f32_16x16x32_bf16 v[72:75], v[184:187], v[144:147], v[72:75]
    ds_read_b64_tr_b16 v[162:163], v196 offset:33280
    v_mfma_f32_16x16x32_bf16 v[76:79], v[188:191], v[144:147], v[76:79]
    ds_read_b64_tr_b16 v[164:165], v197 offset:32768
    v_mfma_f32_16x16x32_bf16 v[80:83], v[148:151], v[176:179], v[80:83]
    ds_read_b64_tr_b16 v[166:167], v197 offset:33280
    s_add_u32 m0, s30, 32768
    s_nop 0
    buffer_load_dwordx4 v198, s[8:11], s24 offen lds
    s_add_u32 s24, s24, 128
    v_mfma_f32_16x16x32_bf16 v[84:87], v[148:151], v[180:183], v[84:87]
    ds_read_b64_tr_b16 v[168:169], v196 offset:40960
    v_mfma_f32_16x16x32_bf16 v[88:91], v[184:187], v[148:151], v[88:91]
    ds_read_b64_tr_b16 v[170:171], v196 offset:41472
    v_mfma_f32_16x16x32_bf16 v[92:95], v[188:191], v[148:151], v[92:95]
    ds_read_b64_tr_b16 v[172:173], v197 offset:40960
    v_mfma_f32_16x16x32_bf16 v[96:99], v[152:155], v[176:179], v[96:99]
    ds_read_b64_tr_b16 v[174:175], v197 offset:41472
    v_mfma_f32_16x16x32_bf16 v[100:103], v[152:155], v[180:183], v[100:103]
    ds_read_b128 v[132:135], v194 offset:1024
    s_add_u32 m0, s30, 40960
    s_nop 0
    buffer_load_dwordx4 v198, s[8:11], s25 offen lds
    s_add_u32 s25, s25, 128
    v_mfma_f32_16x16x32_bf16 v[104:107], v[184:187], v[152:155], v[104:107]
    ds_read_b128 v[136:139], v194 offset:4096
    v_mfma_f32_16x16x32_bf16 v[108:111], v[188:191], v[152:155], v[108:111]
    ds_read_b128 v[140:143], v194 offset:5120
    v_mfma_f32_16x16x32_bf16 v[112:115], v[156:159], v[176:179], v[112:115]
    v_mfma_f32_16x16x32_bf16 v[116:119], v[156:159], v[180:183], v[116:119]
    v_mfma_f32_16x16x32_bf16 v[120:123], v[184:187], v[156:159], v[120:123]
    s_add_u32 m0, s30, 49152
    s_nop 0
    buffer_load_dwordx4 v198, s[8:11], s26 offen lds
    s_add_u32 s26, s26, 128
    v_mfma_f32_16x16x32_bf16 v[124:127], v[188:191], v[156:159], v[124:127]
    s_waitcnt lgkmcnt(3)
    v_mfma_f32_16x16x32_bf16 v[64:67], v[128:131], v[160:163], v[64:67]
    ds_read_b128 v[144:147], v195 offset:0
    v_mfma_f32_16x16x32_bf16 v[68:71], v[128:131], v[164:167], v[68:71]
    ds_read_b64_tr_b16 v[176:177], v196 offset:36864
    v_mfma_f32_16x16x32_bf16 v[72:75], v[168:171], v[128:131], v[72:75]
    ds_read_b64_tr_b16 v[178:179], v196 offset:37376
    v_mfma_f32_16x16x32_bf16 v[76:79], v[172:175], v[128:131], v[76:79]
    ds_read_b64_tr_b16 v[180:181], v197 offset:36864
    s_waitcnt lgkmcnt(6)
    v_mfma_f32_16x16x32_bf16 v[80:83], v[132:135], v[160:163], v[80:83]
    ds_read_b64_tr_b16 v[182:183], v197 offset:37376
    s_add_u32 m0, s30, 57344
    s_nop 0
    buffer_load_dwordx4 v198, s[8:11], s27 offen lds
    s_add_u32 s27, s27, 128
    v_mfma_f32_16x16x32_bf16 v[84:87], v[132:135], v[164:167], v[84:87]
    ds_read_b64_tr_b16 v[184:185], v196 offset:45056
    v_mfma_f32_16x16x32_bf16 v[88:91], v[168:171], v[132:135], v[88:91]
    ds_read_b64_tr_b16 v[186:187], v196 offset:45568
    v_mfma_f32_16x16x32_bf16 v[92:95], v[172:175], v[132:135], v[92:95]
    ds_read_b64_tr_b16 v[188:189], v197 offset:45056
    s_waitcnt lgkmcnt(9)
    v_mfma_f32_16x16x32_bf16 v[96:99], v[136:139], v[160:163], v[96:99]
    ds_read_b64_tr_b16 v[190:191], v197 offset:45568
    v_mfma_f32_16x16x32_bf16 v[100:103], v[136:139], v[164:167], v[100:103]
    ds_read_b128 v[148:151], v195 offset:1024
    s_add_u32 m0, s31, 114688
    s_nop 0
    buffer_load_dwordx4 v199, s[20:23], s28 offen lds
    v_mfma_f32_16x16x32_bf16 v[104:107], v[168:171], v[136:139], v[104:107]
    ds_read_b128 v[152:155], v195 offset:4096
    v_mfma_f32_16x16x32_bf16 v[108:111], v[172:175], v[136:139], v[108:111]
    ds_read_b128 v[156:159], v195 offset:5120
    s_waitcnt lgkmcnt(12)
    v_mfma_f32_16x16x32_bf16 v[112:115], v[140:143], v[160:163], v[112:115]
    v_mfma_f32_16x16x32_bf16 v[116:119], v[140:143], v[164:167], v[116:119]
    v_mfma_f32_16x16x32_bf16 v[120:123], v[168:171], v[140:143], v[120:123]
    s_add_u32 m0, s31, 115712
    s_nop 0
    buffer_load_dwordx4 v200, s[20:23], s28 offen lds
    s_add_u32 s28, s28, s29
    v_mfma_f32_16x16x32_bf16 v[124:127], v[172:175], v[140:143], v[124:127]
    s_waitcnt lgkmcnt(0)
    s_waitcnt vmcnt(6)
    s_barrier
    v_mfma_f32_16x16x32_bf16 v[64:67], v[144:147], v[176:179], v[64:67]
    ds_read_b128 v[128:131], v192 offset:0
    v_mfma_f32_16x16x32_bf16 v[68:71], v[144:147], v[180:183], v[68:71]
    ds_read_b64_tr_b16 v[160:161], v196 offset:0
    v_mfma_f32_16x16x32_bf16 v[72:75], v[184:187], v[144:147], v[72:75]
    ds_read_b64_tr_b16 v[162:163], v196 offset:512
    v_mfma_f32_16x16x32_bf16 v[76:79], v[188:191], v[144:147], v[76:79]
    ds_read_b64_tr_b16 v[164:165], v197 offset:0
    v_mfma_f32_16x16x32_bf16 v[80:83], v[148:151], v[176:179], v[80:83]
    ds_read_b64_tr_b16 v[166:167], v197 offset:512
    s_add_u32 m0, s30, 65536
    s_nop 0
    buffer_load_dwordx4 v198, s[8:11], s24 offen lds
    s_add_u32 s24, s24, 128
    v_mfma_f32_16x16x32_bf16 v[84:87], v[148:151], v[180:183], v[84:87]
    ds_read_b64_tr_b16 v[168:169], v196 offset:8192
    v_mfma_f32_16x16x32_bf16 v[88:91], v[184:187], v[148:151], v[88:91]
    ds_read_b64_tr_b16 v[170:171], v196 offset:8704
    v_mfma_f32_16x16x32_bf16 v[92:95], v[188:191], v[148:151], v[92:95]
    ds_read_b64_tr_b16 v[172:173], v197 offset:8192
    v_mfma_f32_16x16x32_bf16 v[96:99], v[152:155], v[176:179], v[96:99]
    ds_read_b64_tr_b16 v[174:175], v197 offset:8704
    v_mfma_f32_16x16x32_bf16 v[100:103], v[152:155], v[180:183], v[100:103]
    ds_read_b128 v[132:135], v192 offset:1024
    s_add_u32 m0, s30, 73728
    s_nop 0
    buffer_load_dwordx4 v198, s[8:11], s25 offen lds
    s_add_u32 s25, s25, 128
    v_mfma_f32_16x16x32_bf16 v[104:107], v[184:187], v[152:155], v[104:107]
    ds_read_b128 v[136:139], v192 offset:4096
    v_mfma_f32_16x16x32_bf16 v[108:111], v[188:191], v[152:155], v[108:111]
    ds_read_b128 v[140:143], v192 offset:5120
    v_mfma_f32_16x16x32_bf16 v[112:115], v[156:159], v[176:179], v[112:115]
    v_mfma_f32_16x16x32_bf16 v[116:119], v[156:159], v[180:183], v[116:119]
    v_mfma_f32_16x16x32_bf16 v[120:123], v[184:187], v[156:159], v[120:123]
    s_add_u32 m0, s30, 81920
    s_nop 0
    buffer_load_dwordx4 v198, s[8:11], s26 offen lds
    s_add_u32 s26, s26, 128
    v_mfma_f32_16x16x32_bf16 v[124:127], v[188:191], v[156:159], v[124:127]
    s_waitcnt lgkmcnt(3)
    v_mfma_f32_16x16x32_bf16 v[64:67], v[128:131], v[160:163], v[64:67]
    ds_read_b128 v[144:147], v193 offset:0
    v_mfma_f32_16x16x32_bf16 v[68:71], v[128:131], v[164:167], v[68:71]
    ds_read_b64_tr_b16 v[176:177], v196 offset:4096
    v_mfma_f32_16x16x32_bf16 v[72:75], v[168:171], v[128:131], v[72:75]
    ds_read_b64_tr_b16 v[178:179], v196 offset:4608
    v_mfma_f32_16x16x32_bf16 v[76:79], v[172:175], v[128:131], v[76:79]
    ds_read_b64_tr_b16 v[180:181], v197 offset:4096
    s_waitcnt lgkmcnt(6)
    v_mfma_f32_16x16x32_bf16 v[80:83], v[132:135], v[160:163], v[80:83]
    ds_read_b64_tr_b16 v[182:183], v197 offset:4608
    s_add_u32 m0, s30, 90112
    s_nop 0
    buffer_load_dwordx4 v198, s[8:11], s27 offen lds
    s_add_u32 s27, s27, 128
    v_mfma_f32_16x16x32_bf16 v[84:87], v[132:135], v[164:167], v[84:87]
    ds_read_b64_tr_b16 v[184:185], v196 offset:12288
    v_mfma_f32_16x16x32_bf16 v[88:91], v[168:171], v[132:135], v[88:91]
    ds_read_b64_tr_b16 v[186:187], v196 offset:12800
    v_mfma_f32_16x16x32_bf16 v[92:95], v[172:175], v[132:135], v[92:95]
    ds_read_b64_tr_b16 v[188:189], v197 offset:12288
    s_waitcnt lgkmcnt(9)
    v_mfma_f32_16x16x32_bf16 v[96:99], v[136:139], v[160:163], v[96:99]
    ds_read_b64_tr_b16 v[190:191], v197 offset:12800
    v_mfma_f32_16x16x32_bf16 v[100:103], v[136:139], v[164:167], v[100:103]
    ds_read_b128 v[148:151], v193 offset:1024
    s_add_u32 m0, s31, 131072
    s_nop 0
    buffer_load_dwordx4 v199, s[20:23], s28 offen lds
    v_mfma_f32_16x16x32_bf16 v[104:107], v[168:171], v[136:139], v[104:107]
    ds_read_b128 v[152:155], v193 offset:4096
    v_mfma_f32_16x16x32_bf16 v[108:111], v[172:175], v[136:139], v[108:111]
    ds_read_b128 v[156:159], v193 offset:5120
    s_waitcnt lgkmcnt(12)
    v_mfma_f32_16x16x32_bf16 v[112:115], v[140:143], v[160:163], v[112:115]
    v_mfma_f32_16x16x32_bf16 v[116:119], v[140:143], v[164:167], v[116:119]
    v_mfma_f32_16x16x32_bf16 v[120:123], v[168:171], v[140:143], v[120:123]
    s_add_u32 m0, s31, 132096
    s_nop 0
    buffer_load_dwordx4 v200, s[20:23], s28 offen lds
    s_add_u32 s28, s28, s29
    v_mfma_f32_16x16x32_bf16 v[124:127], v[172:175], v[140:143], v[124:127]
    s_waitcnt lgkmcnt(0)
    s_waitcnt vmcnt(6)
    s_barrier
    v_mfma_f32_16x16x32_bf16 v[64:67], v[144:147], v[176:179], v[64:67]
    ds_read_b128 v[128:131], v192 offset:32768
    v_mfma_f32_16x16x32_bf16 v[68:71], v[144:147], v[180:183], v[68:71]
    ds_read_b64_tr_b16 v[160:161], v196 offset:16384
    v_mfma_f32_16x16x32_bf16 v[72:75], v[184:187], v[144:147], v[72:75]
    ds_read_b64_tr_b16 v[162:163], v196 offset:16896
    v_mfma_f32_16x16x32_bf16 v[76:79], v[188:191], v[144:147], v[76:79]
    ds_read_b64_tr_b16 v[164:165], v197 offset:16384
    v_mfma_f32_16x16x32_bf16 v[80:83], v[148:151], v[176:179], v[80:83]
    ds_read_b64_tr_b16 v[166:167], v197 offset:16896
    s_add_u32 m0, s30, 0
    s_nop 0
    buffer_load_dwordx4 v198, s[8:11], s24 offen lds
    s_add_u32 s24, s24, 128
    v_mfma_f32_16x16x32_bf16 v[84:87], v[148:151], v[180:183], v[84:87]
    ds_read_b64_tr_b16 v[168:169], v196 offset:24576
    v_mfma_f32_16x16x32_bf16 v[88:91], v[184:187], v[148:151], v[88:91]
    ds_read_b64_tr_b16 v[170:171], v196 offset:25088
    v_mfma_f32_16x16x32_bf16 v[92:95], v[188:191], v[148:151], v[92:95]
    ds_read_b64_tr_b16 v[172:173], v197 offset:24576
    v_mfma_f32_16x16x32_bf16 v[96:99], v[152:155], v[176:179], v[96:99]
    ds_read_b64_tr_b16 v[174:175], v197 offset:25088
    v_mfma_f32_16x16x32_bf16 v[100:103], v[152:155], v[180:183], v[100:103]
    ds_read_b128 v[132:135], v192 offset:33792
    s_add_u32 m0, s30, 8192
    s_nop 0
    buffer_load_dwordx4 v198, s[8:11], s25 offen lds
    s_add_u32 s25, s25, 128
    v_mfma_f32_16x16x32_bf16 v[104:107], v[184:187], v[152:155], v[104:107]
    ds_read_b128 v[136:139], v192 offset:36864
    v_mfma_f32_16x16x32_bf16 v[108:111], v[188:191], v[152:155], v[108:111]
    ds_read_b128 v[140:143], v192 offset:37888
    v_mfma_f32_16x16x32_bf16 v[112:115], v[156:159], v[176:179], v[112:115]
    v_mfma_f32_16x16x32_bf16 v[116:119], v[156:159], v[180:183], v[116:119]
    v_mfma_f32_16x16x32_bf16 v[120:123], v[184:187], v[156:159], v[120:123]
    s_add_u32 m0, s30, 16384
    s_nop 0
    buffer_load_dwordx4 v198, s[8:11], s26 offen lds
    s_add_u32 s26, s26, 128
    v_mfma_f32_16x16x32_bf16 v[124:127], v[188:191], v[156:159], v[124:127]
    s_waitcnt lgkmcnt(3)
    v_mfma_f32_16x16x32_bf16 v[64:67], v[128:131], v[160:163], v[64:67]
    ds_read_b128 v[144:147], v193 offset:32768
    v_mfma_f32_16x16x32_bf16 v[68:71], v[128:131], v[164:167], v[68:71]
    ds_read_b64_tr_b16 v[176:177], v196 offset:20480
    v_mfma_f32_16x16x32_bf16 v[72:75], v[168:171], v[128:131], v[72:75]
    ds_read_b64_tr_b16 v[178:179], v196 offset:20992
    v_mfma_f32_16x16x32_bf16 v[76:79], v[172:175], v[128:131], v[76:79]
    ds_read_b64_tr_b16 v[180:181], v197 offset:20480
    s_waitcnt lgkmcnt(6)
    v_mfma_f32_16x16x32_bf16 v[80:83], v[132:135], v[160:163], v[80:83]
    ds_read_b64_tr_b16 v[182:183], v197 offset:20992
    s_add_u32 m0, s30, 24576
    s_nop 0
    buffer_load_dwordx4 v198, s[8:11], s27 offen lds
    s_add_u32 s27, s27, 128
    v_mfma_f32_16x16x32_bf16 v[84:87], v[132:135], v[164:167], v[84:87]
    ds_read_b64_tr_b16 v[184:185], v196 offset:28672
    v_mfma_f32_16x16x32_bf16 v[88:91], v[168:171], v[132:135], v[88:91]
    ds_read_b64_tr_b16 v[186:187], v196 offset:29184
    v_mfma_f32_16x16x32_bf16 v[92:95], v[172:175], v[132:135], v[92:95]
    ds_read_b64_tr_b16 v[188:189], v197 offset:28672
    s_waitcnt lgkmcnt(9)
    v_mfma_f32_16x16x32_bf16 v[96:99], v[136:139], v[160:163], v[96:99]
    ds_read_b64_tr_b16 v[190:191], v197 offset:29184
    v_mfma_f32_16x16x32_bf16 v[100:103], v[136:139], v[164:167], v[100:103]
    ds_read_b128 v[148:151], v193 offset:33792
    s_add_u32 m0, s31, 98304
    s_nop 0
    buffer_load_dwordx4 v199, s[20:23], s28 offen lds
    v_mfma_f32_16x16x32_bf16 v[104:107], v[168:171], v[136:139], v[104:107]
    ds_read_b128 v[152:155], v193 offset:36864
    v_mfma_f32_16x16x32_bf16 v[108:111], v[172:175], v[136:139], v[108:111]
    ds_read_b128 v[156:159], v193 offset:37888
    s_waitcnt lgkmcnt(12)
    v_mfma_f32_16x16x32_bf16 v[112:115], v[140:143], v[160:163], v[112:115]
    v_mfma_f32_16x16x32_bf16 v[116:119], v[140:143], v[164:167], v[116:119]
    v_mfma_f32_16x16x32_bf16 v[120:123], v[168:171], v[140:143], v[120:123]
    s_add_u32 m0, s31, 99328
    s_nop 0
    buffer_load_dwordx4 v200, s[20:23], s28 offen lds
    s_add_u32 s28, s28, s29
    v_mfma_f32_16x16x32_bf16 v[124:127], v[172:175], v[140:143], v[124:127]
    s_waitcnt lgkmcnt(0)
    s_waitcnt vmcnt(6)
    s_barrier
    v_mfma_f32_16x16x32_bf16 v[64:67], v[144:147], v[176:179], v[64:67]
    ds_read_b128 v[128:131], v194 offset:0
    v_mfma_f32_16x16x32_bf16 v[68:71], v[144:147], v[180:183], v[68:71]
    ds_read_b64_tr_b16 v[160:161], v196 offset:32768
    v_mfma_f32_16x16x32_bf16 v[72:75], v[184:187], v[144:147], v[72:75]
    ds_read_b64_tr_b16 v[162:163], v196 offset:33280
    v_mfma_f32_16x16x32_bf16 v[76:79], v[188:191], v[144:147], v[76:79]
    ds_read_b64_tr_b16 v[164:165], v197 offset:32768
    v_mfma_f32_16x16x32_bf16 v[80:83], v[148:151], v[176:179], v[80:83]
    ds_read_b64_tr_b16 v[166:167], v197 offset:33280
    s_add_u32 m0, s30, 32768
    s_nop 0
    buffer_load_dwordx4 v198, s[8:11], s24 offen lds
    s_add_u32 s24, s24, 128
    v_mfma_f32_16x16x32_bf16 v[84:87], v[148:151], v[180:183], v[84:87]
    ds_read_b64_tr_b16 v[168:169], v196 offset:40960
    v_mfma_f32_16x16x32_bf16 v[88:91], v[184:187], v[148:151], v[88:91]
    ds_read_b64_tr_b16 v[170:171], v196 offset:41472
    v_mfma_f32_16x16x32_bf16 v[92:95], v[188:191], v[148:151], v[92:95]
    ds_read_b64_tr_b16 v[172:173], v197 offset:40960
    v_mfma_f32_16x16x32_bf16 v[96:99], v[152:155], v[176:179], v[96:99]
    ds_read_b64_tr_b16 v[174:175], v197 offset:41472
    v_mfma_f32_16x16x32_bf16 v[100:103], v[152:155], v[180:183], v[100:103]
    ds_read_b128 v[132:135], v194 offset:1024
    s_add_u32 m0, s30, 40960
    s_nop 0
    buffer_load_dwordx4 v198, s[8:11], s25 offen lds
    s_add_u32 s25, s25, 128
    v_mfma_f32_16x16x32_bf16 v[104:107], v[184:187], v[152:155], v[104:107]
    ds_read_b128 v[136:139], v194 offset:4096
    v_mfma_f32_16x16x32_bf16 v[108:111], v[188:191], v[152:155], v[108:111]
    ds_read_b128 v[140:143], v194 offset:5120
    v_mfma_f32_16x16x32_bf16 v[112:115], v[156:159], v[176:179], v[112:115]
    v_mfma_f32_16x16x32_bf16 v[116:119], v[156:159], v[180:183], v[116:119]
    v_mfma_f32_16x16x32_bf16 v[120:123], v[184:187], v[156:159], v[120:123]
    s_add_u32 m0, s30, 49152
    s_nop 0
    buffer_load_dwordx4 v198, s[8:11], s26 offen lds
    s_add_u32 s26, s26, 128
    v_mfma_f32_16x16x32_bf16 v[124:127], v[188:191], v[156:159], v[124:127]
    s_waitcnt lgkmcnt(3)
    v_mfma_f32_16x16x32_bf16 v[64:67], v[128:131], v[160:163], v[64:67]
    ds_read_b128 v[144:147], v195 offset:0
    v_mfma_f32_16x16x32_bf16 v[68:71], v[128:131], v[164:167], v[68:71]
    ds_read_b64_tr_b16 v[176:177], v196 offset:36864
    v_mfma_f32_16x16x32_bf16 v[72:75], v[168:171], v[128:131], v[72:75]
    ds_read_b64_tr_b16 v[178:179], v196 offset:37376
    v_mfma_f32_16x16x32_bf16 v[76:79], v[172:175], v[128:131], v[76:79]
    ds_read_b64_tr_b16 v[180:181], v197 offset:36864
    s_waitcnt lgkmcnt(6)
    v_mfma_f32_16x16x32_bf16 v[80:83], v[132:135], v[160:163], v[80:83]
    ds_read_b64_tr_b16 v[182:183], v197 offset:37376
    s_add_u32 m0, s30, 57344
    s_nop 0
    buffer_load_dwordx4 v198, s[8:11], s27 offen lds
    s_add_u32 s27, s27, 128
    v_mfma_f32_16x16x32_bf16 v[84:87], v[132:135], v[164:167], v[84:87]
    ds_read_b64_tr_b16 v[184:185], v196 offset:45056
    v_mfma_f32_16x16x32_bf16 v[88:91], v[168:171], v[132:135], v[88:91]
    ds_read_b64_tr_b16 v[186:187], v196 offset:45568
    v_mfma_f32_16x16x32_bf16 v[92:95], v[172:175], v[132:135], v[92:95]
    ds_read_b64_tr_b16 v[188:189], v197 offset:45056
    s_waitcnt lgkmcnt(9)
    v_mfma_f32_16x16x32_bf16 v[96:99], v[136:139], v[160:163], v[96:99]
    ds_read_b64_tr_b16 v[190:191], v197 offset:45568
    v_mfma_f32_16x16x32_bf16 v[100:103], v[136:139], v[164:167], v[100:103]
    ds_read_b128 v[148:151], v195 offset:1024
    s_add_u32 m0, s31, 114688
    s_nop 0
    buffer_load_dwordx4 v199, s[20:23], s28 offen lds
    v_mfma_f32_16x16x32_bf16 v[104:107], v[168:171], v[136:139], v[104:107]
    ds_read_b128 v[152:155], v195 offset:4096
    v_mfma_f32_16x16x32_bf16 v[108:111], v[172:175], v[136:139], v[108:111]
    ds_read_b128 v[156:159], v195 offset:5120
    s_waitcnt lgkmcnt(12)
    v_mfma_f32_16x16x32_bf16 v[112:115], v[140:143], v[160:163], v[112:115]
    v_mfma_f32_16x16x32_bf16 v[116:119], v[140:143], v[164:167], v[116:119]
    v_mfma_f32_16x16x32_bf16 v[120:123], v[168:171], v[140:143], v[120:123]
    s_add_u32 m0, s31, 115712
    s_nop 0
    buffer_load_dwordx4 v200, s[20:23], s28 offen lds
    s_add_u32 s28, s28, s29
    v_mfma_f32_16x16x32_bf16 v[124:127], v[172:175], v[140:143], v[124:127]
    s_waitcnt lgkmcnt(0)
    s_waitcnt vmcnt(6)
    s_barrier
    v_mfma_f32_16x16x32_bf16 v[64:67], v[144:147], v[176:179], v[64:67]
    ds_read_b128 v[128:131], v192 offset:0
    v_mfma_f32_16x16x32_bf16 v[68:71], v[144:147], v[180:183], v[68:71]
    ds_read_b64_tr_b16 v[160:161], v196 offset:0
    v_mfma_f32_16x16x32_bf16 v[72:75], v[184:187], v[144:147], v[72:75]
    ds_read_b64_tr_b16 v[162:163], v196 offset:512
    v_mfma_f32_16x16x32_bf16 v[76:79], v[188:191], v[144:147], v[76:79]
    ds_read_b64_tr_b16 v[164:165], v197 offset:0
    v_mfma_f32_16x16x32_bf16 v[80:83], v[148:151], v[176:179], v[80:83]
    ds_read_b64_tr_b16 v[166:167], v197 offset:512
    s_add_u32 m0, s30, 65536
    s_nop 0
    buffer_load_dwordx4 v198, s[8:11], s24 offen lds
    s_add_u32 s24, s24, 128
    v_mfma_f32_16x16x32_bf16 v[84:87], v[148:151], v[180:183], v[84:87]
    ds_read_b64_tr_b16 v[168:169], v196 offset:8192
    v_mfma_f32_16x16x32_bf16 v[88:91], v[184:187], v[148:151], v[88:91]
    ds_read_b64_tr_b16 v[170:171], v196 offset:8704
    v_mfma_f32_16x16x32_bf16 v[92:95], v[188:191], v[148:151], v[92:95]
    ds_read_b64_tr_b16 v[172:173], v197 offset:8192
    v_mfma_f32_16x16x32_bf16 v[96:99], v[152:155], v[176:179], v[96:99]
    ds_read_b64_tr_b16 v[174:175], v197 offset:8704
    v_mfma_f32_16x16x32_bf16 v[100:103], v[152:155], v[180:183], v[100:103]
    ds_read_b128 v[132:135], v192 offset:1024
    s_add_u32 m0, s30, 73728
    s_nop 0
    buffer_load_dwordx4 v198, s[8:11], s25 offen lds
    s_add_u32 s25, s25, 128
    v_mfma_f32_16x16x32_bf16 v[104:107], v[184:187], v[152:155], v[104:107]
    ds_read_b128 v[136:139], v192 offset:4096
    v_mfma_f32_16x16x32_bf16 v[108:111], v[188:191], v[152:155], v[108:111]
    ds_read_b128 v[140:143], v192 offset:5120
    v_mfma_f32_16x16x32_bf16 v[112:115], v[156:159], v[176:179], v[112:115]
    v_mfma_f32_16x16x32_bf16 v[116:119], v[156:159], v[180:183], v[116:119]
    v_mfma_f32_16x16x32_bf16 v[120:123], v[184:187], v[156:159], v[120:123]
    s_add_u32 m0, s30, 81920
    s_nop 0
    buffer_load_dwordx4 v198, s[8:11], s26 offen lds
    s_add_u32 s26, s26, 128
    v_mfma_f32_16x16x32_bf16 v[124:127], v[188:191], v[156:159], v[124:127]
    s_waitcnt lgkmcnt(3)
    v_mfma_f32_16x16x32_bf16 v[64:67], v[128:131], v[160:163], v[64:67]
    ds_read_b128 v[144:147], v193 offset:0
    v_mfma_f32_16x16x32_bf16 v[68:71], v[128:131], v[164:167], v[68:71]
    ds_read_b64_tr_b16 v[176:177], v196 offset:4096
    v_mfma_f32_16x16x32_bf16 v[72:75], v[168:171], v[128:131], v[72:75]
    ds_read_b64_tr_b16 v[178:179], v196 offset:4608
    v_mfma_f32_16x16x32_bf16 v[76:79], v[172:175], v[128:131], v[76:79]
    ds_read_b64_tr_b16 v[180:181], v197 offset:4096
    s_waitcnt lgkmcnt(6)
    v_mfma_f32_16x16x32_bf16 v[80:83], v[132:135], v[160:163], v[80:83]
    ds_read_b64_tr_b16 v[182:183], v197 offset:4608
    s_add_u32 m0, s30, 90112
    s_nop 0
    buffer_load_dwordx4 v198, s[8:11], s27 offen lds
    s_add_u32 s27, s27, 128
    v_mfma_f32_16x16x32_bf16 v[84:87], v[132:135], v[164:167], v[84:87]
    ds_read_b64_tr_b16 v[184:185], v196 offset:12288
    v_mfma_f32_16x16x32_bf16 v[88:91], v[168:171], v[132:135], v[88:91]
    ds_read_b64_tr_b16 v[186:187], v196 offset:12800
    v_mfma_f32_16x16x32_bf16 v[92:95], v[172:175], v[132:135], v[92:95]
    ds_read_b64_tr_b16 v[188:189], v197 offset:12288
    s_waitcnt lgkmcnt(9)
    v_mfma_f32_16x16x32_bf16 v[96:99], v[136:139], v[160:163], v[96:99]
    ds_read_b64_tr_b16 v[190:191], v197 offset:12800
    v_mfma_f32_16x16x32_bf16 v[100:103], v[136:139], v[164:167], v[100:103]
    ds_read_b128 v[148:151], v193 offset:1024
    s_add_u32 m0, s31, 131072
    s_nop 0
    buffer_load_dwordx4 v199, s[20:23], s28 offen lds
    v_mfma_f32_16x16x32_bf16 v[104:107], v[168:171], v[136:139], v[104:107]
    ds_read_b128 v[152:155], v193 offset:4096
    v_mfma_f32_16x16x32_bf16 v[108:111], v[172:175], v[136:139], v[108:111]
    ds_read_b128 v[156:159], v193 offset:5120
    s_waitcnt lgkmcnt(12)
    v_mfma_f32_16x16x32_bf16 v[112:115], v[140:143], v[160:163], v[112:115]
    v_mfma_f32_16x16x32_bf16 v[116:119], v[140:143], v[164:167], v[116:119]
    v_mfma_f32_16x16x32_bf16 v[120:123], v[168:171], v[140:143], v[120:123]
    s_add_u32 m0, s31, 132096
    s_nop 0
    buffer_load_dwordx4 v200, s[20:23], s28 offen lds
    s_add_u32 s28, s28, s29
    v_mfma_f32_16x16x32_bf16 v[124:127], v[172:175], v[140:143], v[124:127]
    s_waitcnt lgkmcnt(0)
    s_waitcnt vmcnt(6)
    s_barrier
    s_lshr_b32 s40, s12, 2
    s_and_b32 s41, s12, 3
    s_lshl_b32 s41, s41, 1
    s_or_b32 s40, s40, s41
    s_lshl_b32 s40, s40, 4
    s_add_u32 s40, s40, 19959808
    v_lshlrev_b32 v251, 7, v1
    v_add_u32 v251, s40, v251
    v_lshlrev_b32 v252, 4, v1
    v_add_u32 v252, 19926528, v252
    v_cmp_le_u32 vcc, 32, v1
    s_nop 1
    v_cndmask_b32 v251, v251, v252, vcc
    s_cmp_lg_u32 s3, 0
    s_cbranch_scc1 w0_17
    buffer_load_dword v252, v251, s[4:7], 0 offen sc1
w0_17:
    v_mfma_f32_16x16x32_bf16 v[64:67], v[144:147], v[176:179], v[64:67]
    ds_read_b128 v[128:131], v192 offset:32768
    v_mfma_f32_16x16x32_bf16 v[68:71], v[144:147], v[180:183], v[68:71]
    ds_read_b64_tr_b16 v[160:161], v196 offset:16384
    v_mfma_f32_16x16x32_bf16 v[72:75], v[184:187], v[144:147], v[72:75]
    ds_read_b64_tr_b16 v[162:163], v196 offset:16896
    v_mfma_f32_16x16x32_bf16 v[76:79], v[188:191], v[144:147], v[76:79]
    ds_read_b64_tr_b16 v[164:165], v197 offset:16384
    v_mfma_f32_16x16x32_bf16 v[80:83], v[148:151], v[176:179], v[80:83]
    ds_read_b64_tr_b16 v[166:167], v197 offset:16896
    s_add_u32 m0, s30, 0
    s_nop 0
    buffer_load_dwordx4 v198, s[8:11], s24 offen lds
    s_add_u32 s24, s24, 128
    v_mfma_f32_16x16x32_bf16 v[84:87], v[148:151], v[180:183], v[84:87]
    ds_read_b64_tr_b16 v[168:169], v196 offset:24576
    v_mfma_f32_16x16x32_bf16 v[88:91], v[184:187], v[148:151], v[88:91]
    ds_read_b64_tr_b16 v[170:171], v196 offset:25088
    v_mfma_f32_16x16x32_bf16 v[92:95], v[188:191], v[148:151], v[92:95]
    ds_read_b64_tr_b16 v[172:173], v197 offset:24576
    v_mfma_f32_16x16x32_bf16 v[96:99], v[152:155], v[176:179], v[96:99]
    ds_read_b64_tr_b16 v[174:175], v197 offset:25088
    v_mfma_f32_16x16x32_bf16 v[100:103], v[152:155], v[180:183], v[100:103]
    ds_read_b128 v[132:135], v192 offset:33792
    s_add_u32 m0, s30, 8192
    s_nop 0
    buffer_load_dwordx4 v198, s[8:11], s25 offen lds
    s_add_u32 s25, s25, 128
    v_mfma_f32_16x16x32_bf16 v[104:107], v[184:187], v[152:155], v[104:107]
    ds_read_b128 v[136:139], v192 offset:36864
    v_mfma_f32_16x16x32_bf16 v[108:111], v[188:191], v[152:155], v[108:111]
    ds_read_b128 v[140:143], v192 offset:37888
    v_mfma_f32_16x16x32_bf16 v[112:115], v[156:159], v[176:179], v[112:115]
    v_mfma_f32_16x16x32_bf16 v[116:119], v[156:159], v[180:183], v[116:119]
    v_mfma_f32_16x16x32_bf16 v[120:123], v[184:187], v[156:159], v[120:123]
    s_add_u32 m0, s30, 16384
    s_nop 0
    buffer_load_dwordx4 v198, s[8:11], s26 offen lds
    s_add_u32 s26, s26, 128
    v_mfma_f32_16x16x32_bf16 v[124:127], v[188:191], v[156:159], v[124:127]
    s_waitcnt lgkmcnt(3)
    v_mfma_f32_16x16x32_bf16 v[64:67], v[128:131], v[160:163], v[64:67]
    ds_read_b128 v[144:147], v193 offset:32768
    v_mfma_f32_16x16x32_bf16 v[68:71], v[128:131], v[164:167], v[68:71]
    ds_read_b64_tr_b16 v[176:177], v196 offset:20480
    v_mfma_f32_16x16x32_bf16 v[72:75], v[168:171], v[128:131], v[72:75]
    ds_read_b64_tr_b16 v[178:179], v196 offset:20992
    v_mfma_f32_16x16x32_bf16 v[76:79], v[172:175], v[128:131], v[76:79]
    ds_read_b64_tr_b16 v[180:181], v197 offset:20480
    s_waitcnt lgkmcnt(6)
    v_mfma_f32_16x16x32_bf16 v[80:83], v[132:135], v[160:163], v[80:83]
    ds_read_b64_tr_b16 v[182:183], v197 offset:20992
    s_add_u32 m0, s30, 24576
    s_nop 0
    buffer_load_dwordx4 v198, s[8:11], s27 offen lds
    s_add_u32 s27, s27, 128
    v_mfma_f32_16x16x32_bf16 v[84:87], v[132:135], v[164:167], v[84:87]
    ds_read_b64_tr_b16 v[184:185], v196 offset:28672
    v_mfma_f32_16x16x32_bf16 v[88:91], v[168:171], v[132:135], v[88:91]
    ds_read_b64_tr_b16 v[186:187], v196 offset:29184
    v_mfma_f32_16x16x32_bf16 v[92:95], v[172:175], v[132:135], v[92:95]
    ds_read_b64_tr_b16 v[188:189], v197 offset:28672
    s_waitcnt lgkmcnt(9)
    v_mfma_f32_16x16x32_bf16 v[96:99], v[136:139], v[160:163], v[96:99]
    ds_read_b64_tr_b16 v[190:191], v197 offset:29184
    v_mfma_f32_16x16x32_bf16 v[100:103], v[136:139], v[164:167], v[100:103]
    ds_read_b128 v[148:151], v193 offset:33792
    s_add_u32 m0, s31, 98304
    s_nop 0
    buffer_load_dwordx4 v199, s[20:23], s28 offen lds
    v_mfma_f32_16x16x32_bf16 v[104:107], v[168:171], v[136:139], v[104:107]
    ds_read_b128 v[152:155], v193 offset:36864
    v_mfma_f32_16x16x32_bf16 v[108:111], v[172:175], v[136:139], v[108:111]
    ds_read_b128 v[156:159], v193 offset:37888
    s_waitcnt lgkmcnt(12)
    v_mfma_f32_16x16x32_bf16 v[112:115], v[140:143], v[160:163], v[112:115]
    v_mfma_f32_16x16x32_bf16 v[116:119], v[140:143], v[164:167], v[116:119]
    v_mfma_f32_16x16x32_bf16 v[120:123], v[168:171], v[140:143], v[120:123]
    s_add_u32 m0, s31, 99328
    s_nop 0
    buffer_load_dwordx4 v200, s[20:23], s28 offen lds
    s_add_u32 s28, s28, s29
    v_mfma_f32_16x16x32_bf16 v[124:127], v[172:175], v[140:143], v[124:127]
    s_waitcnt lgkmcnt(0)
    s_waitcnt vmcnt(6)
    s_cmp_lg_u32 s3, 0
    s_cbranch_scc1 w0_18
    v_cmp_gt_u32 vcc, 59, v1
    s_and_saveexec_b64 s[52:53], vcc
    s_mov_b32 s61, 65536
pf_19_loop:
    v_cmp_ne_u32 vcc, s60, v252
    s_nop 4
    s_cmp_eq_u64 vcc, 0
    s_cbranch_scc1 pf_19_done
    s_sleep 1
    buffer_load_dword v252, v251, s[4:7], 0 offen sc1
    s_waitcnt vmcnt(0)
    s_sub_u32 s61, s61, 1
    s_cmp_lg_u32 s61, 0
    s_cbranch_scc1 pf_19_loop
pf_19_done:
    s_mov_b64 exec, s[52:53]
w0_18:
    s_barrier
    s_cmp_lt_u32 s3, 2
    s_cbranch_scc1 cst_20_cs
    s_cmp_eq_u32 s3, 2
    s_cbranch_scc1 cst_20_b1
    s_sub_u32 s40, s3, 4
    s_and_b32 s40, s40, 3
    s_lshl_b32 s40, s40, 6
    s_add_u32 s40, s40, s14
    v_add_u32 v2, s40, v1
    v_lshlrev_b32 v2, 4, v2
    buffer_load_dwordx2 v[248:249], v2, s[4:7], 0 offen offset:0 sc1
    s_branch cst_20_st
cst_20_cs:
    s_lshl_b32 s40, s15, 6
    s_lshl_b32 s41, s16, 6
    s_cmp_eq_u32 s18, 1
    s_cselect_b32 s42, 1920, 0
    s_add_u32 s41, s41, s42
    s_cmp_eq_u32 s3, 0
    s_cselect_b32 s40, s40, s41
    v_add_u32 v2, s40, v1
    v_lshlrev_b32 v2, 2, v2
    s_mov_b32 s42, 32768
    buffer_load_dword v248, v2, s[4:7], s42 offen sc1
    s_branch cst_20_st
cst_20_b1:
    s_mov_b32 s48, s74
    s_and_b32 s49, s75, 0xffff
    s_mov_b32 s50, 3072
    s_mov_b32 s51, 0x20000
    s_lshl_b32 s40, s16, 7
    v_lshlrev_b32 v3, 1, v1
    buffer_load_ushort v248, v3, s[48:51], s40 offen
cst_20_st:
    v_and_b32 v2, 3, v1
    v_and_b32 v3, 4, v1
    v_add_u32 v2, v2, v3
    v_and_b32 v3, 8, v1
    v_lshl_add_u32 v2, v3, 1, v2
    s_and_b32 s40, s3, 3
    s_lshl_b32 s40, s40, 6
    s_add_u32 s40, s40, s14
    v_add_u32 v2, s40, v2
    v_lshlrev_b32 v2, 4, v2
    buffer_load_dwordx4 v[232:235], v2, s[4:7], 0 offen offset:0 sc1
    buffer_load_dwordx4 v[236:239], v2, s[4:7], 0 offen offset:128 sc1
    buffer_load_dwordx4 v[240:243], v2, s[4:7], 0 offen offset:512 sc1
    buffer_load_dwordx4 v[244:247], v2, s[4:7], 0 offen offset:640 sc1
    v_mfma_f32_16x16x32_bf16 v[64:67], v[144:147], v[176:179], v[64:67]
    ds_read_b128 v[128:131], v194 offset:0
    v_mfma_f32_16x16x32_bf16 v[68:71], v[144:147], v[180:183], v[68:71]
    ds_read_b64_tr_b16 v[160:161], v196 offset:32768
    v_mfma_f32_16x16x32_bf16 v[72:75], v[184:187], v[144:147], v[72:75]
    ds_read_b64_tr_b16 v[162:163], v196 offset:33280
    v_mfma_f32_16x16x32_bf16 v[76:79], v[188:191], v[144:147], v[76:79]
    ds_read_b64_tr_b16 v[164:165], v197 offset:32768
    v_mfma_f32_16x16x32_bf16 v[80:83], v[148:151], v[176:179], v[80:83]
    ds_read_b64_tr_b16 v[166:167], v197 offset:33280
    v_mfma_f32_16x16x32_bf16 v[84:87], v[148:151], v[180:183], v[84:87]
    ds_read_b64_tr_b16 v[168:169], v196 offset:40960
    v_mfma_f32_16x16x32_bf16 v[88:91], v[184:187], v[148:151], v[88:91]
    ds_read_b64_tr_b16 v[170:171], v196 offset:41472
    v_mfma_f32_16x16x32_bf16 v[92:95], v[188:191], v[148:151], v[92:95]
    ds_read_b64_tr_b16 v[172:173], v197 offset:40960
    v_mfma_f32_16x16x32_bf16 v[96:99], v[152:155], v[176:179], v[96:99]
    ds_read_b64_tr_b16 v[174:175], v197 offset:41472
    v_mfma_f32_16x16x32_bf16 v[100:103], v[152:155], v[180:183], v[100:103]
    ds_read_b128 v[132:135], v194 offset:1024
    v_mfma_f32_16x16x32_bf16 v[104:107], v[184:187], v[152:155], v[104:107]
    ds_read_b128 v[136:139], v194 offset:4096
    v_mfma_f32_16x16x32_bf16 v[108:111], v[188:191], v[152:155], v[108:111]
    ds_read_b128 v[140:143], v194 offset:5120
    v_mfma_f32_16x16x32_bf16 v[112:115], v[156:159], v[176:179], v[112:115]
    v_mfma_f32_16x16x32_bf16 v[116:119], v[156:159], v[180:183], v[116:119]
    v_mfma_f32_16x16x32_bf16 v[120:123], v[184:187], v[156:159], v[120:123]
    v_mfma_f32_16x16x32_bf16 v[124:127], v[188:191], v[156:159], v[124:127]
    s_waitcnt lgkmcnt(3)
    v_mfma_f32_16x16x32_bf16 v[64:67], v[128:131], v[160:163], v[64:67]
    ds_read_b128 v[144:147], v195 offset:0
    v_mfma_f32_16x16x32_bf16 v[68:71], v[128:131], v[164:167], v[68:71]
    ds_read_b64_tr_b16 v[176:177], v196 offset:36864
    v_mfma_f32_16x16x32_bf16 v[72:75], v[168:171], v[128:131], v[72:75]
    ds_read_b64_tr_b16 v[178:179], v196 offset:37376
    v_mfma_f32_16x16x32_bf16 v[76:79], v[172:175], v[128:131], v[76:79]
    ds_read_b64_tr_b16 v[180:181], v197 offset:36864
    s_waitcnt lgkmcnt(6)
    v_mfma_f32_16x16x32_bf16 v[80:83], v[132:135], v[160:163], v[80:83]
    ds_read_b64_tr_b16 v[182:183], v197 offset:37376
    v_mfma_f32_16x16x32_bf16 v[84:87], v[132:135], v[164:167], v[84:87]
    ds_read_b64_tr_b16 v[184:185], v196 offset:45056
    v_mfma_f32_16x16x32_bf16 v[88:91], v[168:171], v[132:135], v[88:91]
    ds_read_b64_tr_b16 v[186:187], v196 offset:45568
    v_mfma_f32_16x16x32_bf16 v[92:95], v[172:175], v[132:135], v[92:95]
    ds_read_b64_tr_b16 v[188:189], v197 offset:45056
    s_waitcnt lgkmcnt(9)
    v_mfma_f32_16x16x32_bf16 v[96:99], v[136:139], v[160:163], v[96:99]
    ds_read_b64_tr_b16 v[190:191], v197 offset:45568
    v_mfma_f32_16x16x32_bf16 v[100:103], v[136:139], v[164:167], v[100:103]
    ds_read_b128 v[148:151], v195 offset:1024
    v_mfma_f32_16x16x32_bf16 v[104:107], v[168:171], v[136:139], v[104:107]
    ds_read_b128 v[152:155], v195 offset:4096
    v_mfma_f32_16x16x32_bf16 v[108:111], v[172:175], v[136:139], v[108:111]
    ds_read_b128 v[156:159], v195 offset:5120
    s_waitcnt lgkmcnt(12)
    v_mfma_f32_16x16x32_bf16 v[112:115], v[140:143], v[160:163], v[112:115]
    v_mfma_f32_16x16x32_bf16 v[116:119], v[140:143], v[164:167], v[116:119]
    v_mfma_f32_16x16x32_bf16 v[120:123], v[168:171], v[140:143], v[120:123]
    v_mfma_f32_16x16x32_bf16 v[124:127], v[172:175], v[140:143], v[124:127]
    s_waitcnt lgkmcnt(0)
    s_waitcnt vmcnt(5)
    s_barrier
    v_mfma_f32_16x16x32_bf16 v[64:67], v[144:147], v[176:179], v[64:67]
    ds_read_b128 v[128:131], v192 offset:0
    v_mfma_f32_16x16x32_bf16 v[68:71], v[144:147], v[180:183], v[68:71]
    ds_read_b64_tr_b16 v[160:161], v196 offset:0
    v_mfma_f32_16x16x32_bf16 v[72:75], v[184:187], v[144:147], v[72:75]
    ds_read_b64_tr_b16 v[162:163], v196 offset:512
    v_mfma_f32_16x16x32_bf16 v[76:79], v[188:191], v[144:147], v[76:79]
    ds_read_b64_tr_b16 v[164:165], v197 offset:0
    v_mfma_f32_16x16x32_bf16 v[80:83], v[148:151], v[176:179], v[80:83]
    ds_read_b64_tr_b16 v[166:167], v197 offset:512
    v_mfma_f32_16x16x32_bf16 v[84:87], v[148:151], v[180:183], v[84:87]
    ds_read_b64_tr_b16 v[168:169], v196 offset:8192
    v_mfma_f32_16x16x32_bf16 v[88:91], v[184:187], v[148:151], v[88:91]
    ds_read_b64_tr_b16 v[170:171], v196 offset:8704
    v_mfma_f32_16x16x32_bf16 v[92:95], v[188:191], v[148:151], v[92:95]
    ds_read_b64_tr_b16 v[172:173], v197 offset:8192
    v_mfma_f32_16x16x32_bf16 v[96:99], v[152:155], v[176:179], v[96:99]
    ds_read_b64_tr_b16 v[174:175], v197 offset:8704
    v_mfma_f32_16x16x32_bf16 v[100:103], v[152:155], v[180:183], v[100:103]
    ds_read_b128 v[132:135], v192 offset:1024
    v_mfma_f32_16x16x32_bf16 v[104:107], v[184:187], v[152:155], v[104:107]
    ds_read_b128 v[136:139], v192 offset:4096
    v_mfma_f32_16x16x32_bf16 v[108:111], v[188:191], v[152:155], v[108:111]
    ds_read_b128 v[140:143], v192 offset:5120
    v_mfma_f32_16x16x32_bf16 v[112:115], v[156:159], v[176:179], v[112:115]
    v_mfma_f32_16x16x32_bf16 v[116:119], v[156:159], v[180:183], v[116:119]
    v_mfma_f32_16x16x32_bf16 v[120:123], v[184:187], v[156:159], v[120:123]
    v_mfma_f32_16x16x32_bf16 v[124:127], v[188:191], v[156:159], v[124:127]
    s_waitcnt lgkmcnt(3)
    v_mfma_f32_16x16x32_bf16 v[64:67], v[128:131], v[160:163], v[64:67]
    ds_read_b128 v[144:147], v193 offset:0
    v_mfma_f32_16x16x32_bf16 v[68:71], v[128:131], v[164:167], v[68:71]
    ds_read_b64_tr_b16 v[176:177], v196 offset:4096
    v_mfma_f32_16x16x32_bf16 v[72:75], v[168:171], v[128:131], v[72:75]
    ds_read_b64_tr_b16 v[178:179], v196 offset:4608
    v_mfma_f32_16x16x32_bf16 v[76:79], v[172:175], v[128:131], v[76:79]
    ds_read_b64_tr_b16 v[180:181], v197 offset:4096
    s_waitcnt lgkmcnt(6)
    v_mfma_f32_16x16x32_bf16 v[80:83], v[132:135], v[160:163], v[80:83]
    ds_read_b64_tr_b16 v[182:183], v197 offset:4608
    v_mfma_f32_16x16x32_bf16 v[84:87], v[132:135], v[164:167], v[84:87]
    ds_read_b64_tr_b16 v[184:185], v196 offset:12288
    v_mfma_f32_16x16x32_bf16 v[88:91], v[168:171], v[132:135], v[88:91]
    ds_read_b64_tr_b16 v[186:187], v196 offset:12800
    v_mfma_f32_16x16x32_bf16 v[92:95], v[172:175], v[132:135], v[92:95]
    ds_read_b64_tr_b16 v[188:189], v197 offset:12288
    s_waitcnt lgkmcnt(9)
    v_mfma_f32_16x16x32_bf16 v[96:99], v[136:139], v[160:163], v[96:99]
    ds_read_b64_tr_b16 v[190:191], v197 offset:12800
    v_mfma_f32_16x16x32_bf16 v[100:103], v[136:139], v[164:167], v[100:103]
    ds_read_b128 v[148:151], v193 offset:1024
    v_mfma_f32_16x16x32_bf16 v[104:107], v[168:171], v[136:139], v[104:107]
    ds_read_b128 v[152:155], v193 offset:4096
    v_mfma_f32_16x16x32_bf16 v[108:111], v[172:175], v[136:139], v[108:111]
    ds_read_b128 v[156:159], v193 offset:5120
    s_waitcnt lgkmcnt(12)
    v_mfma_f32_16x16x32_bf16 v[112:115], v[140:143], v[160:163], v[112:115]
    v_mfma_f32_16x16x32_bf16 v[116:119], v[140:143], v[164:167], v[116:119]
    v_mfma_f32_16x16x32_bf16 v[120:123], v[168:171], v[140:143], v[120:123]
    v_mfma_f32_16x16x32_bf16 v[124:127], v[172:175], v[140:143], v[124:127]
    s_waitcnt lgkmcnt(0)
    s_waitcnt vmcnt(0)
    v_lshlrev_b32 v2, 2, v1
    s_cmp_lt_u32 s3, 2
    s_cbranch_scc1 cmt_21_cs
    s_cmp_eq_u32 s3, 2
    s_cbranch_scc1 cmt_21_b1
    s_cmp_lt_u32 s3, 4
    s_cbranch_scc1 cmt_21_e
    s_sub_u32 s40, s3, 4
    s_lshl_b32 s40, s40, 8
    s_add_u32 s40, s40, 148224
    v_add_u32 v2, s40, v2
    ds_write_b32 v2, v248
    ds_write_b32 v2, v249 offset:1024
    s_branch cmt_21_e
cmt_21_cs:
    s_lshl_b32 s40, s3, 8
    s_add_u32 s40, s40, 147456
    v_add_u32 v2, s40, v2
    ds_write_b32 v2, v248
    s_branch cmt_21_e
cmt_21_b1:
    v_add_u32 v2, 147968, v2
    v_lshlrev_b32 v248, 16, v248
    ds_write_b32 v2, v248
cmt_21_e:
    s_waitcnt lgkmcnt(0)
    s_barrier
    s_lshr_b32 s40, s3, 2
    s_lshl_b32 s41, s40, 5
    v_and_b32 v3, 15, v1
    v_add_u32 v3, s41, v3
    v_lshlrev_b32 v5, 2, v3
    v_add_u32 v5, 147456, v5
    s_sub_u32 s42, s15, 20
    s_lshl_b32 s42, s42, 6
    v_add_u32 v3, s42, v3
    v_lshlrev_b32 v3, 5, v3
    v_lshrrev_b32 v4, 4, v1
    v_and_b32 v2, 1, v4
    v_lshl_add_u32 v3, v2, 4, v3
    v_lshrrev_b32 v6, 1, v4
    v_mul_u32_u24 v7, 20480, v6
    v_add_u32 v3, v3, v7
    s_and_b32 s42, s3, 3
    s_lshl_b32 s42, s42, 6
    s_add_u32 s43, s42, s14
    s_lshr_b32 s43, s43, 4
    s_mul_i32 s43, s43, 20480
    s_add_u32 s43, s43, 5308416
    v_lshlrev_b32 v6, 4, v6
    v_lshl_add_u32 v4, v2, 2, v6
    v_add_u32 v4, s42, v4
    v_lshlrev_b32 v4, 2, v4
    v_add_u32 v4, 148224, v4
    v_mfma_f32_16x16x32_bf16 v[64:67], v[144:147], v[176:179], v[64:67]
    v_mfma_f32_16x16x32_bf16 v[68:71], v[144:147], v[180:183], v[68:71]
    v_mfma_f32_16x16x32_bf16 v[72:75], v[184:187], v[144:147], v[72:75]
    v_mfma_f32_16x16x32_bf16 v[76:79], v[188:191], v[144:147], v[76:79]
    v_mfma_f32_16x16x32_bf16 v[80:83], v[148:151], v[176:179], v[80:83]
    v_mfma_f32_16x16x32_bf16 v[84:87], v[148:151], v[180:183], v[84:87]
    v_mfma_f32_16x16x32_bf16 v[88:91], v[184:187], v[148:151], v[88:91]
    v_mfma_f32_16x16x32_bf16 v[92:95], v[188:191], v[148:151], v[92:95]
    v_mfma_f32_16x16x32_bf16 v[96:99], v[152:155], v[176:179], v[96:99]
    v_mfma_f32_16x16x32_bf16 v[100:103], v[152:155], v[180:183], v[100:103]
    v_mfma_f32_16x16x32_bf16 v[104:107], v[184:187], v[152:155], v[104:107]
    v_mfma_f32_16x16x32_bf16 v[108:111], v[188:191], v[152:155], v[108:111]
    v_mfma_f32_16x16x32_bf16 v[112:115], v[156:159], v[176:179], v[112:115]
    v_mfma_f32_16x16x32_bf16 v[116:119], v[156:159], v[180:183], v[116:119]
    v_mfma_f32_16x16x32_bf16 v[120:123], v[184:187], v[156:159], v[120:123]
    v_mfma_f32_16x16x32_bf16 v[124:127], v[188:191], v[156:159], v[124:127]
    s_nop 7
    ds_read_b32 v128, v5
    ds_read_b32 v130, v5 offset:64
    s_waitcnt lgkmcnt(0)
    v_sub_f32 v128, 0, v128
    v_sub_f32 v130, 0, v130
    ds_read_b128 v[136:139], v4 offset:0
    ds_read_b128 v[140:143], v4 offset:32
    ds_read_b128 v[144:147], v4 offset:1024
    ds_read_b128 v[148:151], v4 offset:1056
    s_waitcnt lgkmcnt(0)
    v_pk_fma_f32 v[64:65], v[136:137], v[128:129], v[64:65] op_sel_hi:[1,0,1]
    v_pk_fma_f32 v[66:67], v[138:139], v[128:129], v[66:67] op_sel_hi:[1,0,1]
    v_pk_mul_f32 v[64:65], v[64:65], v[144:145]
    v_pk_mul_f32 v[66:67], v[66:67], v[146:147]
    v_cvt_pk_bf16_f32 v156, v64, v65
    v_cvt_pk_bf16_f32 v157, v66, v67
    v_pk_fma_f32 v[80:81], v[140:141], v[128:129], v[80:81] op_sel_hi:[1,0,1]
    v_pk_fma_f32 v[82:83], v[142:143], v[128:129], v[82:83] op_sel_hi:[1,0,1]
    v_pk_mul_f32 v[80:81], v[80:81], v[148:149]
    v_pk_mul_f32 v[82:83], v[82:83], v[150:151]
    v_cvt_pk_bf16_f32 v158, v80, v81
    v_cvt_pk_bf16_f32 v159, v82, v83
    s_add_u32 s44, s43, 0
    buffer_store_dwordx4 v[156:159], v3, s[4:7], s44 offen offset:0 sc1
    v_pk_fma_f32 v[68:69], v[136:137], v[130:131], v[68:69] op_sel_hi:[1,0,1]
    v_pk_fma_f32 v[70:71], v[138:139], v[130:131], v[70:71] op_sel_hi:[1,0,1]
    v_pk_mul_f32 v[68:69], v[68:69], v[144:145]
    v_pk_mul_f32 v[70:71], v[70:71], v[146:147]
    v_cvt_pk_bf16_f32 v160, v68, v69
    v_cvt_pk_bf16_f32 v161, v70, v71
    v_pk_fma_f32 v[84:85], v[140:141], v[130:131], v[84:85] op_sel_hi:[1,0,1]
    v_pk_fma_f32 v[86:87], v[142:143], v[130:131], v[86:87] op_sel_hi:[1,0,1]
    v_pk_mul_f32 v[84:85], v[84:85], v[148:149]
    v_pk_mul_f32 v[86:87], v[86:87], v[150:151]
    v_cvt_pk_bf16_f32 v162, v84, v85
    v_cvt_pk_bf16_f32 v163, v86, v87
    s_add_u32 s44, s43, 0
    buffer_store_dwordx4 v[160:163], v3, s[4:7], s44 offen offset:512 sc1
    ds_read_b128 v[136:139], v4 offset:128
    ds_read_b128 v[140:143], v4 offset:160
    ds_read_b128 v[144:147], v4 offset:1152
    ds_read_b128 v[148:151], v4 offset:1184
    s_waitcnt lgkmcnt(0)
    v_pk_fma_f32 v[96:97], v[136:137], v[128:129], v[96:97] op_sel_hi:[1,0,1]
    v_pk_fma_f32 v[98:99], v[138:139], v[128:129], v[98:99] op_sel_hi:[1,0,1]
    v_pk_mul_f32 v[96:97], v[96:97], v[144:145]
    v_pk_mul_f32 v[98:99], v[98:99], v[146:147]
    v_cvt_pk_bf16_f32 v156, v96, v97
    v_cvt_pk_bf16_f32 v157, v98, v99
    v_pk_fma_f32 v[112:113], v[140:141], v[128:129], v[112:113] op_sel_hi:[1,0,1]
    v_pk_fma_f32 v[114:115], v[142:143], v[128:129], v[114:115] op_sel_hi:[1,0,1]
    v_pk_mul_f32 v[112:113], v[112:113], v[148:149]
    v_pk_mul_f32 v[114:115], v[114:115], v[150:151]
    v_cvt_pk_bf16_f32 v158, v112, v113
    v_cvt_pk_bf16_f32 v159, v114, v115
    s_add_u32 s44, s43, 40960
    buffer_store_dwordx4 v[156:159], v3, s[4:7], s44 offen offset:0 sc1
    v_pk_fma_f32 v[100:101], v[136:137], v[130:131], v[100:101] op_sel_hi:[1,0,1]
    v_pk_fma_f32 v[102:103], v[138:139], v[130:131], v[102:103] op_sel_hi:[1,0,1]
    v_pk_mul_f32 v[100:101], v[100:101], v[144:145]
    v_pk_mul_f32 v[102:103], v[102:103], v[146:147]
    v_cvt_pk_bf16_f32 v160, v100, v101
    v_cvt_pk_bf16_f32 v161, v102, v103
    v_pk_fma_f32 v[116:117], v[140:141], v[130:131], v[116:117] op_sel_hi:[1,0,1]
    v_pk_fma_f32 v[118:119], v[142:143], v[130:131], v[118:119] op_sel_hi:[1,0,1]
    v_pk_mul_f32 v[116:117], v[116:117], v[148:149]
    v_pk_mul_f32 v[118:119], v[118:119], v[150:151]
    v_cvt_pk_bf16_f32 v162, v116, v117
    v_cvt_pk_bf16_f32 v163, v118, v119
    s_add_u32 s44, s43, 40960
    buffer_store_dwordx4 v[160:163], v3, s[4:7], s44 offen offset:512 sc1
    s_branch Lp1_epiB
Lp1_epiT0:
    s_nop 7
    ds_read_b128 v[128:131], v2 offset:0
    ds_read_b128 v[132:135], v2 offset:64
    s_waitcnt lgkmcnt(0)
    v_pk_mul_f32 v[144:145], v[208:209], v[128:129] op_sel:[0,0] op_sel_hi:[0,1]
    v_pk_mul_f32 v[146:147], v[208:209], v[130:131] op_sel:[0,0] op_sel_hi:[0,1]
    v_pk_mul_f32 v[148:149], v[208:209], v[132:133] op_sel:[0,0] op_sel_hi:[0,1]
    v_pk_mul_f32 v[150:151], v[208:209], v[134:135] op_sel:[0,0] op_sel_hi:[0,1]
    v_pk_fma_f32 v[64:65], v[204:205], v[64:65], v[144:145] op_sel:[0,0,0] op_sel_hi:[0,1,1]
    v_pk_fma_f32 v[66:67], v[204:205], v[66:67], v[146:147] op_sel:[0,0,0] op_sel_hi:[0,1,1]
    v_pk_fma_f32 v[68:69], v[204:205], v[68:69], v[148:149] op_sel:[0,0,0] op_sel_hi:[0,1,1]
    v_pk_fma_f32 v[70:71], v[204:205], v[70:71], v[150:151] op_sel:[0,0,0] op_sel_hi:[0,1,1]
    v_cvt_pk_bf16_f32 v156, v64, v65
    v_cvt_pk_bf16_f32 v157, v66, v67
    v_cvt_pk_bf16_f32 v158, v68, v69
    v_cvt_pk_bf16_f32 v159, v70, v71
    s_nop 1
    v_permlane16_swap_b32 v156, v158
    v_permlane16_swap_b32 v157, v159
    buffer_store_dwordx4 v[156:159], v3, s[4:7], s43 offen offset:0 sc1
    v_pk_mul_f32 v[144:145], v[208:209], v[128:129] op_sel:[1,0] op_sel_hi:[1,1]
    v_pk_mul_f32 v[146:147], v[208:209], v[130:131] op_sel:[1,0] op_sel_hi:[1,1]
    v_pk_mul_f32 v[148:149], v[208:209], v[132:133] op_sel:[1,0] op_sel_hi:[1,1]
    v_pk_mul_f32 v[150:151], v[208:209], v[134:135] op_sel:[1,0] op_sel_hi:[1,1]
    v_pk_fma_f32 v[80:81], v[204:205], v[80:81], v[144:145] op_sel:[1,0,0] op_sel_hi:[1,1,1]
    v_pk_fma_f32 v[82:83], v[204:205], v[82:83], v[146:147] op_sel:[1,0,0] op_sel_hi:[1,1,1]
    v_pk_fma_f32 v[84:85], v[204:205], v[84:85], v[148:149] op_sel:[1,0,0] op_sel_hi:[1,1,1]
    v_pk_fma_f32 v[86:87], v[204:205], v[86:87], v[150:151] op_sel:[1,0,0] op_sel_hi:[1,1,1]
    v_cvt_pk_bf16_f32 v160, v80, v81
    v_cvt_pk_bf16_f32 v161, v82, v83
    v_cvt_pk_bf16_f32 v162, v84, v85
    v_cvt_pk_bf16_f32 v163, v86, v87
    s_nop 1
    v_permlane16_swap_b32 v160, v162
    v_permlane16_swap_b32 v161, v163
    buffer_store_dwordx4 v[160:163], v3, s[4:7], s43 offen offset:128 sc1
    v_pk_mul_f32 v[144:145], v[210:211], v[128:129] op_sel:[0,0] op_sel_hi:[0,1]
    v_pk_mul_f32 v[146:147], v[210:211], v[130:131] op_sel:[0,0] op_sel_hi:[0,1]
    v_pk_mul_f32 v[148:149], v[210:211], v[132:133] op_sel:[0,0] op_sel_hi:[0,1]
    v_pk_mul_f32 v[150:151], v[210:211], v[134:135] op_sel:[0,0] op_sel_hi:[0,1]
    v_pk_fma_f32 v[96:97], v[206:207], v[96:97], v[144:145] op_sel:[0,0,0] op_sel_hi:[0,1,1]
    v_pk_fma_f32 v[98:99], v[206:207], v[98:99], v[146:147] op_sel:[0,0,0] op_sel_hi:[0,1,1]
    v_pk_fma_f32 v[100:101], v[206:207], v[100:101], v[148:149] op_sel:[0,0,0] op_sel_hi:[0,1,1]
    v_pk_fma_f32 v[102:103], v[206:207], v[102:103], v[150:151] op_sel:[0,0,0] op_sel_hi:[0,1,1]
    v_cvt_pk_bf16_f32 v156, v96, v97
    v_cvt_pk_bf16_f32 v157, v98, v99
    v_cvt_pk_bf16_f32 v158, v100, v101
    v_cvt_pk_bf16_f32 v159, v102, v103
    s_nop 1
    v_permlane16_swap_b32 v156, v158
    v_permlane16_swap_b32 v157, v159
    buffer_store_dwordx4 v[156:159], v3, s[4:7], s43 offen offset:512 sc1
    v_pk_mul_f32 v[144:145], v[210:211], v[128:129] op_sel:[1,0] op_sel_hi:[1,1]
    v_pk_mul_f32 v[146:147], v[210:211], v[130:131] op_sel:[1,0] op_sel_hi:[1,1]
    v_pk_mul_f32 v[148:149], v[210:211], v[132:133] op_sel:[1,0] op_sel_hi:[1,1]
    v_pk_mul_f32 v[150:151], v[210:211], v[134:135] op_sel:[1,0] op_sel_hi:[1,1]
    v_pk_fma_f32 v[112:113], v[206:207], v[112:113], v[144:145] op_sel:[1,0,0] op_sel_hi:[1,1,1]
    v_pk_fma_f32 v[114:115], v[206:207], v[114:115], v[146:147] op_sel:[1,0,0] op_sel_hi:[1,1,1]
    v_pk_fma_f32 v[116:117], v[206:207], v[116:117], v[148:149] op_sel:[1,0,0] op_sel_hi:[1,1,1]
    v_pk_fma_f32 v[118:119], v[206:207], v[118:119], v[150:151] op_sel:[1,0,0] op_sel_hi:[1,1,1]
    v_cvt_pk_bf16_f32 v160, v112, v113
    v_cvt_pk_bf16_f32 v161, v114, v115
    v_cvt_pk_bf16_f32 v162, v116, v117
    v_cvt_pk_bf16_f32 v163, v118, v119
    s_nop 1
    v_permlane16_swap_b32 v160, v162
    v_permlane16_swap_b32 v161, v163
    buffer_store_dwordx4 v[160:163], v3, s[4:7], s43 offen offset:640 sc1
Lp1_epiB:
    s_cmp_eq_u32 s18, 1
    s_cbranch_scc1 Lp1_epiH
    v_mov_b32 v204, v233
    v_mul_f32 v208, v204, v232
    v_sub_f32 v208, 0, v208
    v_mov_b32 v205, v237
    v_mul_f32 v209, v205, v236
    v_sub_f32 v209, 0, v209
    v_mov_b32 v206, v241
    v_mul_f32 v210, v206, v240
    v_sub_f32 v210, 0, v210
    v_mov_b32 v207, v245
    v_mul_f32 v211, v207, v244
    v_sub_f32 v211, 0, v211
    v_and_b32 v3, 3, v1
    v_and_b32 v2, 4, v1
    v_add_u32 v3, v3, v2
    v_and_b32 v2, 8, v1
    v_lshl_add_u32 v3, v2, 1, v3
    s_lshr_b32 s40, s3, 2
    s_and_b32 s42, s3, 3
    s_lshl_b32 s42, s42, 6
    s_add_u32 s42, s42, s14
    v_add_u32 v3, s42, v3
    v_lshlrev_b32 v3, 4, v3
    v_lshrrev_b32 v4, 4, v1
    v_and_b32 v2, 1, v4
    v_lshlrev_b32 v2, 1, v2
    v_lshrrev_b32 v6, 1, v4
    v_or_b32 v2, v2, v6
    v_lshl_add_u32 v3, v2, 15, v3
    s_lshl_b32 s41, s40, 7
    v_lshlrev_b32 v2, 4, v4
    v_add_u32 v2, s41, v2
    v_add_u32 v2, 147456, v2
    s_lshl_b32 s43, s16, 3
    s_lshl_b32 s44, s40, 2
    s_add_u32 s43, s43, s44
    s_lshl_b32 s43, s43, 15
    s_add_u32 s43, s43, 65536
    ds_read_b128 v[128:131], v2 offset:256
    ds_read_b128 v[132:135], v2 offset:320
    s_waitcnt lgkmcnt(0)
    v_pk_mul_f32 v[144:145], v[208:209], v[128:129] op_sel:[0,0] op_sel_hi:[0,1]
    v_pk_mul_f32 v[146:147], v[208:209], v[130:131] op_sel:[0,0] op_sel_hi:[0,1]
    v_pk_mul_f32 v[148:149], v[208:209], v[132:133] op_sel:[0,0] op_sel_hi:[0,1]
    v_pk_mul_f32 v[150:151], v[208:209], v[134:135] op_sel:[0,0] op_sel_hi:[0,1]
    v_pk_fma_f32 v[72:73], v[204:205], v[72:73], v[144:145] op_sel:[0,0,0] op_sel_hi:[0,1,1]
    v_pk_fma_f32 v[74:75], v[204:205], v[74:75], v[146:147] op_sel:[0,0,0] op_sel_hi:[0,1,1]
    v_pk_fma_f32 v[76:77], v[204:205], v[76:77], v[148:149] op_sel:[0,0,0] op_sel_hi:[0,1,1]
    v_pk_fma_f32 v[78:79], v[204:205], v[78:79], v[150:151] op_sel:[0,0,0] op_sel_hi:[0,1,1]
    v_cvt_pk_bf16_f32 v156, v72, v73
    v_cvt_pk_bf16_f32 v157, v74, v75
    v_cvt_pk_bf16_f32 v158, v76, v77
    v_cvt_pk_bf16_f32 v159, v78, v79
    s_nop 1
    v_permlane16_swap_b32 v156, v158
    v_permlane16_swap_b32 v157, v159
    buffer_store_dwordx4 v[156:159], v3, s[4:7], s43 offen offset:0 sc1
    v_pk_mul_f32 v[144:145], v[208:209], v[128:129] op_sel:[1,0] op_sel_hi:[1,1]
    v_pk_mul_f32 v[146:147], v[208:209], v[130:131] op_sel:[1,0] op_sel_hi:[1,1]
    v_pk_mul_f32 v[148:149], v[208:209], v[132:133] op_sel:[1,0] op_sel_hi:[1,1]
    v_pk_mul_f32 v[150:151], v[208:209], v[134:135] op_sel:[1,0] op_sel_hi:[1,1]
    v_pk_fma_f32 v[88:89], v[204:205], v[88:89], v[144:145] op_sel:[1,0,0] op_sel_hi:[1,1,1]
    v_pk_fma_f32 v[90:91], v[204:205], v[90:91], v[146:147] op_sel:[1,0,0] op_sel_hi:[1,1,1]
    v_pk_fma_f32 v[92:93], v[204:205], v[92:93], v[148:149] op_sel:[1,0,0] op_sel_hi:[1,1,1]
    v_pk_fma_f32 v[94:95], v[204:205], v[94:95], v[150:151] op_sel:[1,0,0] op_sel_hi:[1,1,1]
    v_cvt_pk_bf16_f32 v160, v88, v89
    v_cvt_pk_bf16_f32 v161, v90, v91
    v_cvt_pk_bf16_f32 v162, v92, v93
    v_cvt_pk_bf16_f32 v163, v94, v95
    s_nop 1
    v_permlane16_swap_b32 v160, v162
    v_permlane16_swap_b32 v161, v163
    buffer_store_dwordx4 v[160:163], v3, s[4:7], s43 offen offset:128 sc1
    v_pk_mul_f32 v[144:145], v[210:211], v[128:129] op_sel:[0,0] op_sel_hi:[0,1]
    v_pk_mul_f32 v[146:147], v[210:211], v[130:131] op_sel:[0,0] op_sel_hi:[0,1]
    v_pk_mul_f32 v[148:149], v[210:211], v[132:133] op_sel:[0,0] op_sel_hi:[0,1]
    v_pk_mul_f32 v[150:151], v[210:211], v[134:135] op_sel:[0,0] op_sel_hi:[0,1]
    v_pk_fma_f32 v[104:105], v[206:207], v[104:105], v[144:145] op_sel:[0,0,0] op_sel_hi:[0,1,1]
    v_pk_fma_f32 v[106:107], v[206:207], v[106:107], v[146:147] op_sel:[0,0,0] op_sel_hi:[0,1,1]
    v_pk_fma_f32 v[108:109], v[206:207], v[108:109], v[148:149] op_sel:[0,0,0] op_sel_hi:[0,1,1]
    v_pk_fma_f32 v[110:111], v[206:207], v[110:111], v[150:151] op_sel:[0,0,0] op_sel_hi:[0,1,1]
    v_cvt_pk_bf16_f32 v156, v104, v105
    v_cvt_pk_bf16_f32 v157, v106, v107
    v_cvt_pk_bf16_f32 v158, v108, v109
    v_cvt_pk_bf16_f32 v159, v110, v111
    s_nop 1
    v_permlane16_swap_b32 v156, v158
    v_permlane16_swap_b32 v157, v159
    buffer_store_dwordx4 v[156:159], v3, s[4:7], s43 offen offset:512 sc1
    v_pk_mul_f32 v[144:145], v[210:211], v[128:129] op_sel:[1,0] op_sel_hi:[1,1]
    v_pk_mul_f32 v[146:147], v[210:211], v[130:131] op_sel:[1,0] op_sel_hi:[1,1]
    v_pk_mul_f32 v[148:149], v[210:211], v[132:133] op_sel:[1,0] op_sel_hi:[1,1]
    v_pk_mul_f32 v[150:151], v[210:211], v[134:135] op_sel:[1,0] op_sel_hi:[1,1]
    v_pk_fma_f32 v[120:121], v[206:207], v[120:121], v[144:145] op_sel:[1,0,0] op_sel_hi:[1,1,1]
    v_pk_fma_f32 v[122:123], v[206:207], v[122:123], v[146:147] op_sel:[1,0,0] op_sel_hi:[1,1,1]
    v_pk_fma_f32 v[124:125], v[206:207], v[124:125], v[148:149] op_sel:[1,0,0] op_sel_hi:[1,1,1]
    v_pk_fma_f32 v[126:127], v[206:207], v[126:127], v[150:151] op_sel:[1,0,0] op_sel_hi:[1,1,1]
    v_cvt_pk_bf16_f32 v160, v120, v121
    v_cvt_pk_bf16_f32 v161, v122, v123
    v_cvt_pk_bf16_f32 v162, v124, v125
    v_cvt_pk_bf16_f32 v163, v126, v127
    s_nop 1
    v_permlane16_swap_b32 v160, v162
    v_permlane16_swap_b32 v161, v163
    buffer_store_dwordx4 v[160:163], v3, s[4:7], s43 offen offset:640 sc1
    s_waitcnt vmcnt(0)
    s_barrier
    s_cmp_lg_u32 s3, 0
    s_cbranch_scc1 w0_22
    s_lshl_b32 s62, s12, 5
    s_add_u32 s62, s62, s13
    s_lshl_b32 s62, s62, 4
    s_add_u32 s63, s62, 19943424
    s_add_u32 s62, s62, 19935232
    v_mov_b32 v4, 0
    v_mov_b32 v5, s60
    s_mov_b64 s[52:53], exec
    s_mov_b64 exec, 1
    buffer_store_dword v5, v4, s[4:7], s62 offen sc1
    s_mov_b64 exec, s[52:53]
    s_cmp_eq_u32 s18, 1
    s_cselect_b32 s86, s63, 0
w0_22:
    s_mov_b32 s87, s18
    s_and_b32 s40, s2, 7
    s_lshr_b32 s41, s2, 3
    s_and_b32 s42, s41, 3
    s_lshl_b32 s12, s40, 2
    s_add_u32 s12, s12, s42
    s_lshr_b32 s13, s41, 2
    s_and_b32 s14, s12, 1
    s_lshr_b32 s40, s12, 1
    s_mul_i32 s40, s40, 5
    s_mul_i32 s41, s14, 3
    s_add_u32 s16, s41, s40
    s_add_u32 s17, s16, 1
    s_add_u32 s18, s40, 2
    s_lshl_b32 s19, s13, 8
    s_lshl_b32 s15, s13, 3
    s_add_u32 s15, s15, s3
    s_sub_u32 s15, s15, 8
    s_lshr_b32 s54, s12, 1
    s_mul_i32 s54, s54, 40
    s_lshl_b32 s55, s14, 4
    s_add_u32 s55, s54, s55
    s_add_u32 s62, s55, 23
    s_lshr_b32 s55, s55, 6
    s_lshr_b32 s62, s62, 6
    s_mul_i32 s54, s12, 20
    s_add_u32 s63, s54, 19
    s_lshr_b32 s54, s54, 6
    s_lshr_b32 s63, s63, 6
    v_and_b32 v12, 1, v1
    v_lshrrev_b32 v13, 1, v1
    v_cmp_eq_u32 vcc, 1, v12
    v_mov_b32 v14, s55
    v_mov_b32 v60, s62
    s_nop 0
    v_cndmask_b32 v14, v14, v60, vcc
    v_mov_b32 v12, s54
    v_mov_b32 v60, s63
    v_cndmask_b32 v12, v12, v60, vcc
    v_cmp_ne_u32 vcc, 0, v13
    v_add_u32 v60, 10, v14
    s_nop 0
    v_cndmask_b32 v14, v14, v60, vcc
    v_subrev_u32 v60, 14, v14
    v_lshrrev_b32 v60, 1, v60
    v_add_u32 v60, 24, v60
    v_cmp_gt_u32 vcc, 14, v14
    v_add_u32 v14, 10, v14
    s_nop 0
    v_cndmask_b32 v14, v60, v14, vcc
    v_cmp_le_u32 vcc, 3, v13
    s_nop 1
    v_cndmask_b32 v14, v14, v12, vcc
    s_cmp_eq_u32 s13, 0
    s_cselect_b32 s54, 0, 1
    v_cmp_eq_u32 vcc, 2, v13
    v_mov_b32 v12, s13
    v_subrev_u32 v60, s54, v12
    s_nop 0
    v_cndmask_b32 v12, v12, v60, vcc
    v_cmp_eq_u32 vcc, 4, v13
    s_nop 1
    v_cndmask_b32 v12, v12, v60, vcc
    v_lshl_add_u32 v12, v12, 5, v14
    v_lshlrev_b32 v59, 4, v12
    v_add_u32 v59, 19935232, v59
    v_lshlrev_b32 v61, 4, v1
    v_add_u32 v61, 19931136, v61
    s_cmp_lg_u32 s3, 0
    s_cbranch_scc1 w0_23
    buffer_load_dword v60, v59, s[4:7], 0 offen sc1
    buffer_load_dword v62, v61, s[4:7], 0 offen sc1
w0_23:
    s_branch Lp1_done
Lp1_epiH:
    v_mov_b32 v204, v234
    v_mul_f32 v208, v204, v232
    v_sub_f32 v208, 0, v208
    v_mov_b32 v205, v238
    v_mul_f32 v209, v205, v236
    v_sub_f32 v209, 0, v209
    v_mov_b32 v206, v242
    v_mul_f32 v210, v206, v240
    v_sub_f32 v210, 0, v210
    v_mov_b32 v207, v246
    v_mul_f32 v211, v207, v244
    v_sub_f32 v211, 0, v211
    v_and_b32 v3, 3, v1
    v_and_b32 v2, 4, v1
    v_add_u32 v3, v3, v2
    v_and_b32 v2, 8, v1
    v_lshl_add_u32 v3, v2, 1, v3
    s_lshr_b32 s40, s3, 2
    s_and_b32 s42, s3, 3
    s_lshl_b32 s42, s42, 6
    s_add_u32 s42, s42, s14
    v_add_u32 v3, s42, v3
    v_lshlrev_b32 v3, 4, v3
    v_lshrrev_b32 v4, 4, v1
    v_and_b32 v2, 1, v4
    v_lshlrev_b32 v2, 1, v2
    v_lshrrev_b32 v6, 1, v4
    v_or_b32 v2, v2, v6
    v_lshl_add_u32 v3, v2, 15, v3
    s_lshl_b32 s41, s40, 7
    v_lshlrev_b32 v2, 4, v4
    v_add_u32 v2, s41, v2
    v_add_u32 v2, 147456, v2
    s_lshl_b32 s43, s16, 3
    s_lshl_b32 s44, s40, 2
    s_add_u32 s43, s43, s44
    s_lshl_b32 s43, s43, 15
    s_add_u32 s43, s43, 7929856
    ds_read_b128 v[128:131], v2 offset:256
    ds_read_b128 v[132:135], v2 offset:320
    ds_read_b128 v[136:139], v2 offset:512
    ds_read_b128 v[140:143], v2 offset:576
    s_mov_b32 s46, 0xbdd2d3e8
    s_mov_b32 s47, 0xbdd2d3e8
    v_mov_b32 v152, 0xc0135761
    v_mov_b32 v153, 0xc0135761
    s_waitcnt lgkmcnt(0)
    v_pk_fma_f32 v[144:145], v[208:209], v[128:129], v[136:137] op_sel:[0,0,0] op_sel_hi:[0,1,1]
    v_pk_fma_f32 v[146:147], v[208:209], v[130:131], v[138:139] op_sel:[0,0,0] op_sel_hi:[0,1,1]
    v_pk_fma_f32 v[148:149], v[208:209], v[132:133], v[140:141] op_sel:[0,0,0] op_sel_hi:[0,1,1]
    v_pk_fma_f32 v[150:151], v[208:209], v[134:135], v[142:143] op_sel:[0,0,0] op_sel_hi:[0,1,1]
    v_pk_fma_f32 v[72:73], v[204:205], v[72:73], v[144:145] op_sel:[0,0,0] op_sel_hi:[0,1,1]
    v_pk_fma_f32 v[74:75], v[204:205], v[74:75], v[146:147] op_sel:[0,0,0] op_sel_hi:[0,1,1]
    v_pk_fma_f32 v[76:77], v[204:205], v[76:77], v[148:149] op_sel:[0,0,0] op_sel_hi:[0,1,1]
    v_pk_fma_f32 v[78:79], v[204:205], v[78:79], v[150:151] op_sel:[0,0,0] op_sel_hi:[0,1,1]
    v_pk_mul_f32 v[144:145], v[72:73], v[72:73]
    v_pk_mul_f32 v[146:147], v[74:75], v[74:75]
    v_pk_mul_f32 v[148:149], v[76:77], v[76:77]
    v_pk_mul_f32 v[150:151], v[78:79], v[78:79]
    v_pk_fma_f32 v[144:145], v[144:145], s[46:47], v[152:153]
    v_pk_fma_f32 v[146:147], v[146:147], s[46:47], v[152:153]
    v_pk_fma_f32 v[148:149], v[148:149], s[46:47], v[152:153]
    v_pk_fma_f32 v[150:151], v[150:151], s[46:47], v[152:153]
    v_pk_mul_f32 v[144:145], v[144:145], v[72:73]
    v_pk_mul_f32 v[146:147], v[146:147], v[74:75]
    v_pk_mul_f32 v[148:149], v[148:149], v[76:77]
    v_pk_mul_f32 v[150:151], v[150:151], v[78:79]
    v_exp_f32 v144, v144
    v_exp_f32 v145, v145
    v_exp_f32 v146, v146
    v_exp_f32 v147, v147
    v_exp_f32 v148, v148
    v_exp_f32 v149, v149
    v_exp_f32 v150, v150
    v_exp_f32 v151, v151
    v_pk_add_f32 v[144:145], v[144:145], 1.0 op_sel_hi:[1,0]
    v_pk_add_f32 v[146:147], v[146:147], 1.0 op_sel_hi:[1,0]
    v_pk_add_f32 v[148:149], v[148:149], 1.0 op_sel_hi:[1,0]
    v_pk_add_f32 v[150:151], v[150:151], 1.0 op_sel_hi:[1,0]
    v_rcp_f32 v144, v144
    v_rcp_f32 v145, v145
    v_rcp_f32 v146, v146
    v_rcp_f32 v147, v147
    v_rcp_f32 v148, v148
    v_rcp_f32 v149, v149
    v_rcp_f32 v150, v150
    v_rcp_f32 v151, v151
    v_pk_mul_f32 v[72:73], v[72:73], v[144:145]
    v_pk_mul_f32 v[74:75], v[74:75], v[146:147]
    v_pk_mul_f32 v[76:77], v[76:77], v[148:149]
    v_pk_mul_f32 v[78:79], v[78:79], v[150:151]
    v_cvt_pk_bf16_f32 v164, v72, v73
    v_cvt_pk_bf16_f32 v165, v74, v75
    v_cvt_pk_bf16_f32 v166, v76, v77
    v_cvt_pk_bf16_f32 v167, v78, v79
    s_nop 1
    v_permlane16_swap_b32 v164, v166
    v_permlane16_swap_b32 v165, v167
    v_pk_fma_f32 v[144:145], v[208:209], v[128:129], v[136:137] op_sel:[1,0,0] op_sel_hi:[1,1,1]
    v_pk_fma_f32 v[146:147], v[208:209], v[130:131], v[138:139] op_sel:[1,0,0] op_sel_hi:[1,1,1]
    v_pk_fma_f32 v[148:149], v[208:209], v[132:133], v[140:141] op_sel:[1,0,0] op_sel_hi:[1,1,1]
    v_pk_fma_f32 v[150:151], v[208:209], v[134:135], v[142:143] op_sel:[1,0,0] op_sel_hi:[1,1,1]
    v_pk_fma_f32 v[88:89], v[204:205], v[88:89], v[144:145] op_sel:[1,0,0] op_sel_hi:[1,1,1]
    v_pk_fma_f32 v[90:91], v[204:205], v[90:91], v[146:147] op_sel:[1,0,0] op_sel_hi:[1,1,1]
    v_pk_fma_f32 v[92:93], v[204:205], v[92:93], v[148:149] op_sel:[1,0,0] op_sel_hi:[1,1,1]
    v_pk_fma_f32 v[94:95], v[204:205], v[94:95], v[150:151] op_sel:[1,0,0] op_sel_hi:[1,1,1]
    v_pk_mul_f32 v[144:145], v[88:89], v[88:89]
    v_pk_mul_f32 v[146:147], v[90:91], v[90:91]
    v_pk_mul_f32 v[148:149], v[92:93], v[92:93]
    v_pk_mul_f32 v[150:151], v[94:95], v[94:95]
    v_pk_fma_f32 v[144:145], v[144:145], s[46:47], v[152:153]
    v_pk_fma_f32 v[146:147], v[146:147], s[46:47], v[152:153]
    v_pk_fma_f32 v[148:149], v[148:149], s[46:47], v[152:153]
    v_pk_fma_f32 v[150:151], v[150:151], s[46:47], v[152:153]
    v_pk_mul_f32 v[144:145], v[144:145], v[88:89]
    v_pk_mul_f32 v[146:147], v[146:147], v[90:91]
    v_pk_mul_f32 v[148:149], v[148:149], v[92:93]
    v_pk_mul_f32 v[150:151], v[150:151], v[94:95]
    v_exp_f32 v144, v144
    v_exp_f32 v145, v145
    v_exp_f32 v146, v146
    v_exp_f32 v147, v147
    v_exp_f32 v148, v148
    v_exp_f32 v149, v149
    v_exp_f32 v150, v150
    v_exp_f32 v151, v151
    v_pk_add_f32 v[144:145], v[144:145], 1.0 op_sel_hi:[1,0]
    v_pk_add_f32 v[146:147], v[146:147], 1.0 op_sel_hi:[1,0]
    v_pk_add_f32 v[148:149], v[148:149], 1.0 op_sel_hi:[1,0]
    v_pk_add_f32 v[150:151], v[150:151], 1.0 op_sel_hi:[1,0]
    v_rcp_f32 v144, v144
    v_rcp_f32 v145, v145
    v_rcp_f32 v146, v146
    v_rcp_f32 v147, v147
    v_rcp_f32 v148, v148
    v_rcp_f32 v149, v149
    v_rcp_f32 v150, v150
    v_rcp_f32 v151, v151
    v_pk_mul_f32 v[88:89], v[88:89], v[144:145]
    v_pk_mul_f32 v[90:91], v[90:91], v[146:147]
    v_pk_mul_f32 v[92:93], v[92:93], v[148:149]
    v_pk_mul_f32 v[94:95], v[94:95], v[150:151]
    v_cvt_pk_bf16_f32 v168, v88, v89
    v_cvt_pk_bf16_f32 v169, v90, v91
    v_cvt_pk_bf16_f32 v170, v92, v93
    v_cvt_pk_bf16_f32 v171, v94, v95
    s_nop 1
    v_permlane16_swap_b32 v168, v170
    v_permlane16_swap_b32 v169, v171
    s_waitcnt vmcnt(0)
    s_barrier
    s_cmp_lg_u32 s3, 0
    s_cbranch_scc1 w0_24
    s_lshl_b32 s62, s12, 5
    s_add_u32 s62, s62, s13
    s_lshl_b32 s62, s62, 4
    s_add_u32 s63, s62, 19943424
    s_add_u32 s62, s62, 19935232
    v_mov_b32 v4, 0
    v_mov_b32 v5, s60
    s_mov_b64 s[52:53], exec
    s_mov_b64 exec, 1
    buffer_store_dword v5, v4, s[4:7], s62 offen sc1
    s_mov_b64 exec, s[52:53]
    s_cmp_eq_u32 s18, 1
    s_cselect_b32 s86, s63, 0
w0_24:
    s_mov_b32 s87, s18
    s_and_b32 s40, s2, 7
    s_lshr_b32 s41, s2, 3
    s_and_b32 s42, s41, 3
    s_lshl_b32 s12, s40, 2
    s_add_u32 s12, s12, s42
    s_lshr_b32 s13, s41, 2
    s_and_b32 s14, s12, 1
    s_lshr_b32 s40, s12, 1
    s_mul_i32 s40, s40, 5
    s_mul_i32 s41, s14, 3
    s_add_u32 s16, s41, s40
    s_add_u32 s17, s16, 1
    s_add_u32 s18, s40, 2
    s_lshl_b32 s19, s13, 8
    s_lshl_b32 s15, s13, 3
    s_add_u32 s15, s15, s3
    s_sub_u32 s15, s15, 8
    s_lshr_b32 s54, s12, 1
    s_mul_i32 s54, s54, 40
    s_lshl_b32 s55, s14, 4
    s_add_u32 s55, s54, s55
    s_add_u32 s62, s55, 23
    s_lshr_b32 s55, s55, 6
    s_lshr_b32 s62, s62, 6
    s_mul_i32 s54, s12, 20
    s_add_u32 s63, s54, 19
    s_lshr_b32 s54, s54, 6
    s_lshr_b32 s63, s63, 6
    v_and_b32 v12, 1, v1
    v_lshrrev_b32 v13, 1, v1
    v_cmp_eq_u32 vcc, 1, v12
    v_mov_b32 v14, s55
    v_mov_b32 v60, s62
    s_nop 0
    v_cndmask_b32 v14, v14, v60, vcc
    v_mov_b32 v12, s54
    v_mov_b32 v60, s63
    v_cndmask_b32 v12, v12, v60, vcc
    v_cmp_ne_u32 vcc, 0, v13
    v_add_u32 v60, 10, v14
    s_nop 0
    v_cndmask_b32 v14, v14, v60, vcc
    v_subrev_u32 v60, 14, v14
    v_lshrrev_b32 v60, 1, v60
    v_add_u32 v60, 24, v60
    v_cmp_gt_u32 vcc, 14, v14
    v_add_u32 v14, 10, v14
    s_nop 0
    v_cndmask_b32 v14, v60, v14, vcc
    v_cmp_le_u32 vcc, 3, v13
    s_nop 1
    v_cndmask_b32 v14, v14, v12, vcc
    s_cmp_eq_u32 s13, 0
    s_cselect_b32 s54, 0, 1
    v_cmp_eq_u32 vcc, 2, v13
    v_mov_b32 v12, s13
    v_subrev_u32 v60, s54, v12
    s_nop 0
    v_cndmask_b32 v12, v12, v60, vcc
    v_cmp_eq_u32 vcc, 4, v13
    s_nop 1
    v_cndmask_b32 v12, v12, v60, vcc
    v_lshl_add_u32 v12, v12, 5, v14
    v_lshlrev_b32 v59, 4, v12
    v_add_u32 v59, 19935232, v59
    v_lshlrev_b32 v61, 4, v1
    v_add_u32 v61, 19931136, v61
    buffer_store_dwordx4 v[164:167], v3, s[4:7], s43 offen offset:0 sc1
    buffer_store_dwordx4 v[168:171], v3, s[4:7], s43 offen offset:128 sc1
    v_pk_fma_f32 v[144:145], v[210:211], v[128:129], v[136:137] op_sel:[0,0,0] op_sel_hi:[0,1,1]
    v_pk_fma_f32 v[146:147], v[210:211], v[130:131], v[138:139] op_sel:[0,0,0] op_sel_hi:[0,1,1]
    v_pk_fma_f32 v[148:149], v[210:211], v[132:133], v[140:141] op_sel:[0,0,0] op_sel_hi:[0,1,1]
    v_pk_fma_f32 v[150:151], v[210:211], v[134:135], v[142:143] op_sel:[0,0,0] op_sel_hi:[0,1,1]
    v_pk_fma_f32 v[104:105], v[206:207], v[104:105], v[144:145] op_sel:[0,0,0] op_sel_hi:[0,1,1]
    v_pk_fma_f32 v[106:107], v[206:207], v[106:107], v[146:147] op_sel:[0,0,0] op_sel_hi:[0,1,1]
    v_pk_fma_f32 v[108:109], v[206:207], v[108:109], v[148:149] op_sel:[0,0,0] op_sel_hi:[0,1,1]
    v_pk_fma_f32 v[110:111], v[206:207], v[110:111], v[150:151] op_sel:[0,0,0] op_sel_hi:[0,1,1]
    v_pk_mul_f32 v[144:145], v[104:105], v[104:105]
    v_pk_mul_f32 v[146:147], v[106:107], v[106:107]
    v_pk_mul_f32 v[148:149], v[108:109], v[108:109]
    v_pk_mul_f32 v[150:151], v[110:111], v[110:111]
    v_pk_fma_f32 v[144:145], v[144:145], s[46:47], v[152:153]
    v_pk_fma_f32 v[146:147], v[146:147], s[46:47], v[152:153]
    v_pk_fma_f32 v[148:149], v[148:149], s[46:47], v[152:153]
    v_pk_fma_f32 v[150:151], v[150:151], s[46:47], v[152:153]
    v_pk_mul_f32 v[144:145], v[144:145], v[104:105]
    v_pk_mul_f32 v[146:147], v[146:147], v[106:107]
    v_pk_mul_f32 v[148:149], v[148:149], v[108:109]
    v_pk_mul_f32 v[150:151], v[150:151], v[110:111]
    v_exp_f32 v144, v144
    v_exp_f32 v145, v145
    v_exp_f32 v146, v146
    v_exp_f32 v147, v147
    v_exp_f32 v148, v148
    v_exp_f32 v149, v149
    v_exp_f32 v150, v150
    v_exp_f32 v151, v151
    v_pk_add_f32 v[144:145], v[144:145], 1.0 op_sel_hi:[1,0]
    v_pk_add_f32 v[146:147], v[146:147], 1.0 op_sel_hi:[1,0]
    v_pk_add_f32 v[148:149], v[148:149], 1.0 op_sel_hi:[1,0]
    v_pk_add_f32 v[150:151], v[150:151], 1.0 op_sel_hi:[1,0]
    v_rcp_f32 v144, v144
    v_rcp_f32 v145, v145
    v_rcp_f32 v146, v146
    v_rcp_f32 v147, v147
    v_rcp_f32 v148, v148
    v_rcp_f32 v149, v149
    v_rcp_f32 v150, v150
    v_rcp_f32 v151, v151
    v_pk_mul_f32 v[104:105], v[104:105], v[144:145]
    v_pk_mul_f32 v[106:107], v[106:107], v[146:147]
    v_pk_mul_f32 v[108:109], v[108:109], v[148:149]
    v_pk_mul_f32 v[110:111], v[110:111], v[150:151]
    v_cvt_pk_bf16_f32 v172, v104, v105
    v_cvt_pk_bf16_f32 v173, v106, v107
    v_cvt_pk_bf16_f32 v174, v108, v109
    v_cvt_pk_bf16_f32 v175, v110, v111
    s_nop 1
    v_permlane16_swap_b32 v172, v174
    v_permlane16_swap_b32 v173, v175
    buffer_store_dwordx4 v[172:175], v3, s[4:7], s43 offen offset:512 sc1
    v_pk_fma_f32 v[144:145], v[210:211], v[128:129], v[136:137] op_sel:[1,0,0] op_sel_hi:[1,1,1]
    v_pk_fma_f32 v[146:147], v[210:211], v[130:131], v[138:139] op_sel:[1,0,0] op_sel_hi:[1,1,1]
    v_pk_fma_f32 v[148:149], v[210:211], v[132:133], v[140:141] op_sel:[1,0,0] op_sel_hi:[1,1,1]
    v_pk_fma_f32 v[150:151], v[210:211], v[134:135], v[142:143] op_sel:[1,0,0] op_sel_hi:[1,1,1]
    v_pk_fma_f32 v[120:121], v[206:207], v[120:121], v[144:145] op_sel:[1,0,0] op_sel_hi:[1,1,1]
    v_pk_fma_f32 v[122:123], v[206:207], v[122:123], v[146:147] op_sel:[1,0,0] op_sel_hi:[1,1,1]
    v_pk_fma_f32 v[124:125], v[206:207], v[124:125], v[148:149] op_sel:[1,0,0] op_sel_hi:[1,1,1]
    v_pk_fma_f32 v[126:127], v[206:207], v[126:127], v[150:151] op_sel:[1,0,0] op_sel_hi:[1,1,1]
    v_pk_mul_f32 v[144:145], v[120:121], v[120:121]
    v_pk_mul_f32 v[146:147], v[122:123], v[122:123]
    v_pk_mul_f32 v[148:149], v[124:125], v[124:125]
    v_pk_mul_f32 v[150:151], v[126:127], v[126:127]
    v_pk_fma_f32 v[144:145], v[144:145], s[46:47], v[152:153]
    v_pk_fma_f32 v[146:147], v[146:147], s[46:47], v[152:153]
    v_pk_fma_f32 v[148:149], v[148:149], s[46:47], v[152:153]
    v_pk_fma_f32 v[150:151], v[150:151], s[46:47], v[152:153]
    v_pk_mul_f32 v[144:145], v[144:145], v[120:121]
    v_pk_mul_f32 v[146:147], v[146:147], v[122:123]
    v_pk_mul_f32 v[148:149], v[148:149], v[124:125]
    v_pk_mul_f32 v[150:151], v[150:151], v[126:127]
    v_exp_f32 v144, v144
    v_exp_f32 v145, v145
    v_exp_f32 v146, v146
    v_exp_f32 v147, v147
    v_exp_f32 v148, v148
    v_exp_f32 v149, v149
    v_exp_f32 v150, v150
    v_exp_f32 v151, v151
    v_pk_add_f32 v[144:145], v[144:145], 1.0 op_sel_hi:[1,0]
    v_pk_add_f32 v[146:147], v[146:147], 1.0 op_sel_hi:[1,0]
    v_pk_add_f32 v[148:149], v[148:149], 1.0 op_sel_hi:[1,0]
    v_pk_add_f32 v[150:151], v[150:151], 1.0 op_sel_hi:[1,0]
    v_rcp_f32 v144, v144
    v_rcp_f32 v145, v145
    v_rcp_f32 v146, v146
    v_rcp_f32 v147, v147
    v_rcp_f32 v148, v148
    v_rcp_f32 v149, v149
    v_rcp_f32 v150, v150
    v_rcp_f32 v151, v151
    v_pk_mul_f32 v[120:121], v[120:121], v[144:145]
    v_pk_mul_f32 v[122:123], v[122:123], v[146:147]
    v_pk_mul_f32 v[124:125], v[124:125], v[148:149]
    v_pk_mul_f32 v[126:127], v[126:127], v[150:151]
    v_cvt_pk_bf16_f32 v176, v120, v121
    v_cvt_pk_bf16_f32 v177, v122, v123
    v_cvt_pk_bf16_f32 v178, v124, v125
    v_cvt_pk_bf16_f32 v179, v126, v127
    s_nop 1
    v_permlane16_swap_b32 v176, v178
    v_permlane16_swap_b32 v177, v179
    s_cmp_lg_u32 s3, 0
    s_cbranch_scc1 w0_25
    buffer_load_dword v60, v59, s[4:7], 0 offen sc1
    buffer_load_dword v62, v61, s[4:7], 0 offen sc1
w0_25:
    buffer_store_dwordx4 v[176:179], v3, s[4:7], s43 offen offset:640 sc1
Lp1_done:
    s_branch Lp2
Lside:
    s_waitcnt lgkmcnt(0)
    s_mov_b32 s4, s84
    s_and_b32 s5, s85, 0xffff
    s_mov_b32 s6, 20971520
    s_mov_b32 s7, 0x20000
    s_mov_b32 s8, s64
    s_and_b32 s9, s65, 0xffff
    s_mov_b32 s10, 2621440
    s_mov_b32 s11, 0x20000
    s_and_b32 s40, s2, 1
    s_lshl_b32 s40, s40, 10
    s_lshr_b32 s41, s2, 1
    s_and_b32 s41, s41, 3
    s_lshl_b32 s41, s41, 8
    s_add_u32 s40, s40, s41
    s_lshr_b32 s41, s2, 3
    s_lshl_b32 s41, s41, 3
    s_add_u32 s40, s40, s41
    s_add_u32 s40, s40, s3
    s_mul_i32 s41, s40, 1280
    v_lshlrev_b32 v2, 5, v1
    v_mov_b32 v208, 0
    v_mov_b32 v209, 0
    v_mov_b32 v210, 0
    v_mov_b32 v211, 0
    v_mov_b32 v212, 0
    v_mov_b32 v213, 0
    v_mov_b32 v214, 0
    v_mov_b32 v215, 0
    s_mov_b32 s42, -1
    s_mov_b32 s43, 0xff
    s_mov_b64 exec, s[42:43]
    buffer_load_dwordx4 v[208:211], v2, s[8:11], s41 offen
    buffer_load_dwordx4 v[212:215], v2, s[8:11], s41 offen offset:16
    s_mov_b64 exec, -1
    s_mov_b32 s56, s82
    s_and_b32 s57, s83, 0xffff
    s_mov_b32 s58, 256
    s_mov_b32 s59, 0x20000
    v_lshrrev_b32 v2, 4, v1
    v_and_b32 v3, 15, v1
    s_cmp_ge_u32 s12, 27
    s_cbranch_scc1 sl_26_nocs
    s_cmp_lt_u32 s12, 15
    s_cselect_b32 s20, s66, s72
    s_cselect_b32 s21, s67, s73
    s_mov_b32 s22, 1966080
    s_cselect_b32 s22, 2457600, s22
    s_movk_i32 s14, 3072
    s_cselect_b32 s14, 3840, s14
    s_cselect_b32 s15, 0, 15
    s_and_b32 s21, s21, 0xffff
    s_mov_b32 s23, 0x20000
    s_sub_u32 s15, s12, s15
    s_lshl_b32 s15, s15, 8
    s_lshl_b32 s16, s3, 2
    s_mul_i32 s16, s16, s14
    s_add_u32 s16, s16, s15
    v_mul_lo_u32 v4, v2, s14
    v_lshl_add_u32 v4, v3, 4, v4
    v_add_u32 v4, s16, v4
    s_lshl_b32 s17, s14, 5
    s_mov_b32 s18, 0
    buffer_load_dwordx4 v[128:131], v4, s[20:23], s18 offen
    s_add_u32 s18, s18, s17
    buffer_load_dwordx4 v[132:135], v4, s[20:23], s18 offen
    s_add_u32 s18, s18, s17
    buffer_load_dwordx4 v[136:139], v4, s[20:23], s18 offen
    s_add_u32 s18, s18, s17
    buffer_load_dwordx4 v[140:143], v4, s[20:23], s18 offen
    s_add_u32 s18, s18, s17
    buffer_load_dwordx4 v[144:147], v4, s[20:23], s18 offen
    s_add_u32 s18, s18, s17
    buffer_load_dwordx4 v[148:151], v4, s[20:23], s18 offen
    s_add_u32 s18, s18, s17
    buffer_load_dwordx4 v[152:155], v4, s[20:23], s18 offen
    s_add_u32 s18, s18, s17
    buffer_load_dwordx4 v[156:159], v4, s[20:23], s18 offen
    s_add_u32 s18, s18, s17
    buffer_load_dwordx4 v[160:163], v4, s[20:23], s18 offen
    s_add_u32 s18, s18, s17
    buffer_load_dwordx4 v[164:167], v4, s[20:23], s18 offen
    s_add_u32 s18, s18, s17
    buffer_load_dwordx4 v[168:171], v4, s[20:23], s18 offen
    s_add_u32 s18, s18, s17
    buffer_load_dwordx4 v[172:175], v4, s[20:23], s18 offen
    s_add_u32 s18, s18, s17
    buffer_load_dwordx4 v[176:179], v4, s[20:23], s18 offen
    s_add_u32 s18, s18, s17
    buffer_load_dwordx4 v[180:183], v4, s[20:23], s18 offen
    s_add_u32 s18, s18, s17
    buffer_load_dwordx4 v[184:187], v4, s[20:23], s18 offen
    s_add_u32 s18, s18, s17
    buffer_load_dwordx4 v[188:191], v4, s[20:23], s18 offen
    s_add_u32 s18, s18, s17
    buffer_load_dwordx4 v[192:195], v4, s[20:23], s18 offen
    s_add_u32 s18, s18, s17
    buffer_load_dwordx4 v[196:199], v4, s[20:23], s18 offen
    s_add_u32 s18, s18, s17
    buffer_load_dwordx4 v[200:203], v4, s[20:23], s18 offen
    s_add_u32 s18, s18, s17
    buffer_load_dwordx4 v[204:207], v4, s[20:23], s18 offen
    s_add_u32 s18, s18, s17
sl_26_nocs:
    s_cmp_lg_u32 s3, 0
    s_cbranch_scc1 boot_27_end
    v_mov_b32 v8, 0
    s_cmp_lg_u32 s2, 255
    s_cbranch_scc1 boot_27_end
    s_mov_b32 s40, 19922944
    buffer_load_dword v9, v8, s[4:7], s40 offen sc1
    s_waitcnt vmcnt(0)
    v_add_u32 v9, 0x9e3779b8, v9
    v_or_b32 v9, 1, v9
    buffer_store_dword v9, v8, s[56:59], 0 offen sc1
    buffer_store_dword v9, v8, s[4:7], s40 offen sc1
    s_nop 0
    v_readfirstlane_b32 s60, v9
boot_27_end:
    s_cmp_ge_u32 s12, 27
    s_cbranch_scc1 sw_28_0
    s_waitcnt vmcnt(20)
    s_branch sw_28_1
sw_28_0:
    s_waitcnt vmcnt(0)
sw_28_1:
    v_mov_b32 v14, v2
    v_mov_b32 v15, v3
    v_lshlrev_b32 v216, 16, v208
    v_and_b32 v217, 0xffff0000, v208
    v_lshlrev_b32 v218, 16, v209
    v_and_b32 v219, 0xffff0000, v209
    v_lshlrev_b32 v220, 16, v210
    v_and_b32 v221, 0xffff0000, v210
    v_lshlrev_b32 v222, 16, v211
    v_and_b32 v223, 0xffff0000, v211
    v_lshlrev_b32 v224, 16, v212
    v_and_b32 v225, 0xffff0000, v212
    v_lshlrev_b32 v226, 16, v213
    v_and_b32 v227, 0xffff0000, v213
    v_lshlrev_b32 v228, 16, v214
    v_and_b32 v229, 0xffff0000, v214
    v_lshlrev_b32 v230, 16, v215
    v_and_b32 v231, 0xffff0000, v215
    v_pk_add_f32 v[6:7], v[216:217], v[218:219]
    v_pk_add_f32 v[8:9], v[220:221], v[222:223]
    v_pk_add_f32 v[10:11], v[224:225], v[226:227]
    v_pk_add_f32 v[12:13], v[228:229], v[230:231]
    v_pk_add_f32 v[6:7], v[6:7], v[8:9]
    v_pk_add_f32 v[10:11], v[10:11], v[12:13]
    v_pk_add_f32 v[6:7], v[6:7], v[10:11]
    v_add_f32 v6, v6, v7
    s_nop 1
    v_add_f32_dpp v6, v6, v6 row_ror:8 row_mask:0xf bank_mask:0xf
    s_nop 1
    v_add_f32_dpp v6, v6, v6 row_ror:4 row_mask:0xf bank_mask:0xf
    s_nop 1
    v_add_f32_dpp v6, v6, v6 row_ror:2 row_mask:0xf bank_mask:0xf
    s_nop 1
    v_add_f32_dpp v6, v6, v6 row_ror:1 row_mask:0xf bank_mask:0xf
    s_nop 0
    v_readlane_b32 s44, v6, 0
    v_readlane_b32 s45, v6, 16
    v_readlane_b32 s46, v6, 32
    v_readlane_b32 s47, v6, 48
    s_nop 1
    v_mov_b32 v6, s44
    v_add_f32 v6, s45, v6
    v_add_f32 v6, s46, v6
    v_add_f32 v6, s47, v6
    v_mul_f32 v8, 0x3acccccd, v6
    v_cmp_gt_u32 vcc, 40, v1
    v_sub_f32 v10, 0, v8
    s_nop 0
    v_cndmask_b32 v10, 0, v10, vcc
    v_mov_b32 v11, v10
    v_pk_add_f32 v[216:217], v[216:217], v[10:11]
    v_pk_add_f32 v[218:219], v[218:219], v[10:11]
    v_pk_add_f32 v[220:221], v[220:221], v[10:11]
    v_pk_add_f32 v[222:223], v[222:223], v[10:11]
    v_pk_add_f32 v[224:225], v[224:225], v[10:11]
    v_pk_add_f32 v[226:227], v[226:227], v[10:11]
    v_pk_add_f32 v[228:229], v[228:229], v[10:11]
    v_pk_add_f32 v[230:231], v[230:231], v[10:11]
    v_pk_mul_f32 v[6:7], v[216:217], v[216:217]
    v_pk_mul_f32 v[12:13], v[218:219], v[218:219]
    v_pk_fma_f32 v[6:7], v[220:221], v[220:221], v[6:7]
    v_pk_fma_f32 v[12:13], v[222:223], v[222:223], v[12:13]
    v_pk_fma_f32 v[6:7], v[224:225], v[224:225], v[6:7]
    v_pk_fma_f32 v[12:13], v[226:227], v[226:227], v[12:13]
    v_pk_fma_f32 v[6:7], v[228:229], v[228:229], v[6:7]
    v_pk_fma_f32 v[12:13], v[230:231], v[230:231], v[12:13]
    v_pk_add_f32 v[6:7], v[6:7], v[12:13]
    v_add_f32 v6, v6, v7
    s_nop 1
    v_add_f32_dpp v6, v6, v6 row_ror:8 row_mask:0xf bank_mask:0xf
    s_nop 1
    v_add_f32_dpp v6, v6, v6 row_ror:4 row_mask:0xf bank_mask:0xf
    s_nop 1
    v_add_f32_dpp v6, v6, v6 row_ror:2 row_mask:0xf bank_mask:0xf
    s_nop 1
    v_add_f32_dpp v6, v6, v6 row_ror:1 row_mask:0xf bank_mask:0xf
    s_nop 0
    v_readlane_b32 s44, v6, 0
    v_readlane_b32 s45, v6, 16
    v_readlane_b32 s46, v6, 32
    v_readlane_b32 s47, v6, 48
    s_nop 1
    v_mov_b32 v6, s44
    v_add_f32 v6, s45, v6
    v_add_f32 v6, s46, v6
    v_add_f32 v6, s47, v6
    v_mul_f32 v6, 0x3acccccd, v6
    v_add_f32 v7, 0x3727c5ac, v6
    v_rsq_f32 v9, v7
    s_nop 0
    v_mul_f32 v7, v9, v9
    v_mul_f32 v7, v7, v6
    v_add_f32 v7, 0x3727c5ac, v7
    v_rsq_f32 v7, v7
    s_nop 0
    v_mul_f32 v10, v9, v7
    v_mul_f32 v11, 0x3ea52b5c, v9
    s_and_b32 s40, s2, 1
    s_lshl_b32 s40, s40, 10
    s_lshr_b32 s41, s2, 1
    s_and_b32 s41, s41, 3
    s_lshl_b32 s41, s41, 8
    s_add_u32 s40, s40, s41
    s_lshr_b32 s41, s2, 3
    s_lshl_b32 s41, s41, 3
    s_add_u32 s40, s40, s41
    s_add_u32 s40, s40, s3
    s_lshl_b32 s40, s40, 4
    v_mov_b32 v12, 0
    s_mov_b64 exec, 1
    buffer_store_dwordx4 v[8:11], v12, s[4:7], s40 offen offset:0 sc1
    s_mov_b64 exec, -1
    v_mov_b32 v2, v14
    v_mov_b32 v3, v15
    s_cmp_lt_u32 s12, 27
    s_cbranch_scc1 Lsd_cs
    s_sub_u32 s30, s12, 27
    s_add_u32 s31, s30, 13
    s_add_u32 s32, s30, 26
    s_branch Lsd_e
Lsd_cs:
    s_add_u32 s30, s12, 39
    s_add_u32 s31, s12, 66
    s_mov_b32 s32, 99
Lsd_e:
    s_cmp_ge_u32 s12, 27
    s_cbranch_scc1 cs2_29
    v_mov_b32 v100, 0
    v_mov_b32 v101, 0
    v_mov_b32 v102, 0
    v_mov_b32 v103, 0
    v_mov_b32 v104, 0
    v_mov_b32 v105, 0
    v_mov_b32 v106, 0
    v_mov_b32 v107, 0
    s_waitcnt vmcnt(0)
    v_lshlrev_b32 v6, 16, v128
    v_and_b32 v7, 0xffff0000, v128
    v_pk_add_f32 v[100:101], v[100:101], v[6:7]
    v_lshlrev_b32 v6, 16, v129
    v_and_b32 v7, 0xffff0000, v129
    v_pk_add_f32 v[102:103], v[102:103], v[6:7]
    v_lshlrev_b32 v6, 16, v130
    v_and_b32 v7, 0xffff0000, v130
    v_pk_add_f32 v[104:105], v[104:105], v[6:7]
    v_lshlrev_b32 v6, 16, v131
    v_and_b32 v7, 0xffff0000, v131
    v_pk_add_f32 v[106:107], v[106:107], v[6:7]
    v_lshlrev_b32 v6, 16, v132
    v_and_b32 v7, 0xffff0000, v132
    v_pk_add_f32 v[100:101], v[100:101], v[6:7]
    v_lshlrev_b32 v6, 16, v133
    v_and_b32 v7, 0xffff0000, v133
    v_pk_add_f32 v[102:103], v[102:103], v[6:7]
    v_lshlrev_b32 v6, 16, v134
    v_and_b32 v7, 0xffff0000, v134
    v_pk_add_f32 v[104:105], v[104:105], v[6:7]
    v_lshlrev_b32 v6, 16, v135
    v_and_b32 v7, 0xffff0000, v135
    v_pk_add_f32 v[106:107], v[106:107], v[6:7]
    v_lshlrev_b32 v6, 16, v136
    v_and_b32 v7, 0xffff0000, v136
    v_pk_add_f32 v[100:101], v[100:101], v[6:7]
    v_lshlrev_b32 v6, 16, v137
    v_and_b32 v7, 0xffff0000, v137
    v_pk_add_f32 v[102:103], v[102:103], v[6:7]
    v_lshlrev_b32 v6, 16, v138
    v_and_b32 v7, 0xffff0000, v138
    v_pk_add_f32 v[104:105], v[104:105], v[6:7]
    v_lshlrev_b32 v6, 16, v139
    v_and_b32 v7, 0xffff0000, v139
    v_pk_add_f32 v[106:107], v[106:107], v[6:7]
    v_lshlrev_b32 v6, 16, v140
    v_and_b32 v7, 0xffff0000, v140
    v_pk_add_f32 v[100:101], v[100:101], v[6:7]
    v_lshlrev_b32 v6, 16, v141
    v_and_b32 v7, 0xffff0000, v141
    v_pk_add_f32 v[102:103], v[102:103], v[6:7]
    v_lshlrev_b32 v6, 16, v142
    v_and_b32 v7, 0xffff0000, v142
    v_pk_add_f32 v[104:105], v[104:105], v[6:7]
    v_lshlrev_b32 v6, 16, v143
    v_and_b32 v7, 0xffff0000, v143
    v_pk_add_f32 v[106:107], v[106:107], v[6:7]
    v_lshlrev_b32 v6, 16, v144
    v_and_b32 v7, 0xffff0000, v144
    v_pk_add_f32 v[100:101], v[100:101], v[6:7]
    v_lshlrev_b32 v6, 16, v145
    v_and_b32 v7, 0xffff0000, v145
    v_pk_add_f32 v[102:103], v[102:103], v[6:7]
    v_lshlrev_b32 v6, 16, v146
    v_and_b32 v7, 0xffff0000, v146
    v_pk_add_f32 v[104:105], v[104:105], v[6:7]
    v_lshlrev_b32 v6, 16, v147
    v_and_b32 v7, 0xffff0000, v147
    v_pk_add_f32 v[106:107], v[106:107], v[6:7]
    v_lshlrev_b32 v6, 16, v148
    v_and_b32 v7, 0xffff0000, v148
    v_pk_add_f32 v[100:101], v[100:101], v[6:7]
    v_lshlrev_b32 v6, 16, v149
    v_and_b32 v7, 0xffff0000, v149
    v_pk_add_f32 v[102:103], v[102:103], v[6:7]
    v_lshlrev_b32 v6, 16, v150
    v_and_b32 v7, 0xffff0000, v150
    v_pk_add_f32 v[104:105], v[104:105], v[6:7]
    v_lshlrev_b32 v6, 16, v151
    v_and_b32 v7, 0xffff0000, v151
    v_pk_add_f32 v[106:107], v[106:107], v[6:7]
    v_lshlrev_b32 v6, 16, v152
    v_and_b32 v7, 0xffff0000, v152
    v_pk_add_f32 v[100:101], v[100:101], v[6:7]
    v_lshlrev_b32 v6, 16, v153
    v_and_b32 v7, 0xffff0000, v153
    v_pk_add_f32 v[102:103], v[102:103], v[6:7]
    v_lshlrev_b32 v6, 16, v154
    v_and_b32 v7, 0xffff0000, v154
    v_pk_add_f32 v[104:105], v[104:105], v[6:7]
    v_lshlrev_b32 v6, 16, v155
    v_and_b32 v7, 0xffff0000, v155
    v_pk_add_f32 v[106:107], v[106:107], v[6:7]
    v_lshlrev_b32 v6, 16, v156
    v_and_b32 v7, 0xffff0000, v156
    v_pk_add_f32 v[100:101], v[100:101], v[6:7]
    v_lshlrev_b32 v6, 16, v157
    v_and_b32 v7, 0xffff0000, v157
    v_pk_add_f32 v[102:103], v[102:103], v[6:7]
    v_lshlrev_b32 v6, 16, v158
    v_and_b32 v7, 0xffff0000, v158
    v_pk_add_f32 v[104:105], v[104:105], v[6:7]
    v_lshlrev_b32 v6, 16, v159
    v_and_b32 v7, 0xffff0000, v159
    v_pk_add_f32 v[106:107], v[106:107], v[6:7]
    v_lshlrev_b32 v6, 16, v160
    v_and_b32 v7, 0xffff0000, v160
    v_pk_add_f32 v[100:101], v[100:101], v[6:7]
    v_lshlrev_b32 v6, 16, v161
    v_and_b32 v7, 0xffff0000, v161
    v_pk_add_f32 v[102:103], v[102:103], v[6:7]
    v_lshlrev_b32 v6, 16, v162
    v_and_b32 v7, 0xffff0000, v162
    v_pk_add_f32 v[104:105], v[104:105], v[6:7]
    v_lshlrev_b32 v6, 16, v163
    v_and_b32 v7, 0xffff0000, v163
    v_pk_add_f32 v[106:107], v[106:107], v[6:7]
    v_lshlrev_b32 v6, 16, v164
    v_and_b32 v7, 0xffff0000, v164
    v_pk_add_f32 v[100:101], v[100:101], v[6:7]
    v_lshlrev_b32 v6, 16, v165
    v_and_b32 v7, 0xffff0000, v165
    v_pk_add_f32 v[102:103], v[102:103], v[6:7]
    v_lshlrev_b32 v6, 16, v166
    v_and_b32 v7, 0xffff0000, v166
    v_pk_add_f32 v[104:105], v[104:105], v[6:7]
    v_lshlrev_b32 v6, 16, v167
    v_and_b32 v7, 0xffff0000, v167
    v_pk_add_f32 v[106:107], v[106:107], v[6:7]
    v_lshlrev_b32 v6, 16, v168
    v_and_b32 v7, 0xffff0000, v168
    v_pk_add_f32 v[100:101], v[100:101], v[6:7]
    v_lshlrev_b32 v6, 16, v169
    v_and_b32 v7, 0xffff0000, v169
    v_pk_add_f32 v[102:103], v[102:103], v[6:7]
    v_lshlrev_b32 v6, 16, v170
    v_and_b32 v7, 0xffff0000, v170
    v_pk_add_f32 v[104:105], v[104:105], v[6:7]
    v_lshlrev_b32 v6, 16, v171
    v_and_b32 v7, 0xffff0000, v171
    v_pk_add_f32 v[106:107], v[106:107], v[6:7]
    v_lshlrev_b32 v6, 16, v172
    v_and_b32 v7, 0xffff0000, v172
    v_pk_add_f32 v[100:101], v[100:101], v[6:7]
    v_lshlrev_b32 v6, 16, v173
    v_and_b32 v7, 0xffff0000, v173
    v_pk_add_f32 v[102:103], v[102:103], v[6:7]
    v_lshlrev_b32 v6, 16, v174
    v_and_b32 v7, 0xffff0000, v174
    v_pk_add_f32 v[104:105], v[104:105], v[6:7]
    v_lshlrev_b32 v6, 16, v175
    v_and_b32 v7, 0xffff0000, v175
    v_pk_add_f32 v[106:107], v[106:107], v[6:7]
    v_lshlrev_b32 v6, 16, v176
    v_and_b32 v7, 0xffff0000, v176
    v_pk_add_f32 v[100:101], v[100:101], v[6:7]
    v_lshlrev_b32 v6, 16, v177
    v_and_b32 v7, 0xffff0000, v177
    v_pk_add_f32 v[102:103], v[102:103], v[6:7]
    v_lshlrev_b32 v6, 16, v178
    v_and_b32 v7, 0xffff0000, v178
    v_pk_add_f32 v[104:105], v[104:105], v[6:7]
    v_lshlrev_b32 v6, 16, v179
    v_and_b32 v7, 0xffff0000, v179
    v_pk_add_f32 v[106:107], v[106:107], v[6:7]
    v_lshlrev_b32 v6, 16, v180
    v_and_b32 v7, 0xffff0000, v180
    v_pk_add_f32 v[100:101], v[100:101], v[6:7]
    v_lshlrev_b32 v6, 16, v181
    v_and_b32 v7, 0xffff0000, v181
    v_pk_add_f32 v[102:103], v[102:103], v[6:7]
    v_lshlrev_b32 v6, 16, v182
    v_and_b32 v7, 0xffff0000, v182
    v_pk_add_f32 v[104:105], v[104:105], v[6:7]
    v_lshlrev_b32 v6, 16, v183
    v_and_b32 v7, 0xffff0000, v183
    v_pk_add_f32 v[106:107], v[106:107], v[6:7]
    v_lshlrev_b32 v6, 16, v184
    v_and_b32 v7, 0xffff0000, v184
    v_pk_add_f32 v[100:101], v[100:101], v[6:7]
    v_lshlrev_b32 v6, 16, v185
    v_and_b32 v7, 0xffff0000, v185
    v_pk_add_f32 v[102:103], v[102:103], v[6:7]
    v_lshlrev_b32 v6, 16, v186
    v_and_b32 v7, 0xffff0000, v186
    v_pk_add_f32 v[104:105], v[104:105], v[6:7]
    v_lshlrev_b32 v6, 16, v187
    v_and_b32 v7, 0xffff0000, v187
    v_pk_add_f32 v[106:107], v[106:107], v[6:7]
    v_lshlrev_b32 v6, 16, v188
    v_and_b32 v7, 0xffff0000, v188
    v_pk_add_f32 v[100:101], v[100:101], v[6:7]
    v_lshlrev_b32 v6, 16, v189
    v_and_b32 v7, 0xffff0000, v189
    v_pk_add_f32 v[102:103], v[102:103], v[6:7]
    v_lshlrev_b32 v6, 16, v190
    v_and_b32 v7, 0xffff0000, v190
    v_pk_add_f32 v[104:105], v[104:105], v[6:7]
    v_lshlrev_b32 v6, 16, v191
    v_and_b32 v7, 0xffff0000, v191
    v_pk_add_f32 v[106:107], v[106:107], v[6:7]
    v_lshlrev_b32 v6, 16, v192
    v_and_b32 v7, 0xffff0000, v192
    v_pk_add_f32 v[100:101], v[100:101], v[6:7]
    v_lshlrev_b32 v6, 16, v193
    v_and_b32 v7, 0xffff0000, v193
    v_pk_add_f32 v[102:103], v[102:103], v[6:7]
    v_lshlrev_b32 v6, 16, v194
    v_and_b32 v7, 0xffff0000, v194
    v_pk_add_f32 v[104:105], v[104:105], v[6:7]
    v_lshlrev_b32 v6, 16, v195
    v_and_b32 v7, 0xffff0000, v195
    v_pk_add_f32 v[106:107], v[106:107], v[6:7]
    v_lshlrev_b32 v6, 16, v196
    v_and_b32 v7, 0xffff0000, v196
    v_pk_add_f32 v[100:101], v[100:101], v[6:7]
    v_lshlrev_b32 v6, 16, v197
    v_and_b32 v7, 0xffff0000, v197
    v_pk_add_f32 v[102:103], v[102:103], v[6:7]
    v_lshlrev_b32 v6, 16, v198
    v_and_b32 v7, 0xffff0000, v198
    v_pk_add_f32 v[104:105], v[104:105], v[6:7]
    v_lshlrev_b32 v6, 16, v199
    v_and_b32 v7, 0xffff0000, v199
    v_pk_add_f32 v[106:107], v[106:107], v[6:7]
    v_lshlrev_b32 v6, 16, v200
    v_and_b32 v7, 0xffff0000, v200
    v_pk_add_f32 v[100:101], v[100:101], v[6:7]
    v_lshlrev_b32 v6, 16, v201
    v_and_b32 v7, 0xffff0000, v201
    v_pk_add_f32 v[102:103], v[102:103], v[6:7]
    v_lshlrev_b32 v6, 16, v202
    v_and_b32 v7, 0xffff0000, v202
    v_pk_add_f32 v[104:105], v[104:105], v[6:7]
    v_lshlrev_b32 v6, 16, v203
    v_and_b32 v7, 0xffff0000, v203
    v_pk_add_f32 v[106:107], v[106:107], v[6:7]
    v_lshlrev_b32 v6, 16, v204
    v_and_b32 v7, 0xffff0000, v204
    v_pk_add_f32 v[100:101], v[100:101], v[6:7]
    v_lshlrev_b32 v6, 16, v205
    v_and_b32 v7, 0xffff0000, v205
    v_pk_add_f32 v[102:103], v[102:103], v[6:7]
    v_lshlrev_b32 v6, 16, v206
    v_and_b32 v7, 0xffff0000, v206
    v_pk_add_f32 v[104:105], v[104:105], v[6:7]
    v_lshlrev_b32 v6, 16, v207
    v_and_b32 v7, 0xffff0000, v207
    v_pk_add_f32 v[106:107], v[106:107], v[6:7]
    s_lshl_b32 s16, s3, 2
    v_add_u32 v5, s16, v2
    v_lshlrev_b32 v5, 9, v5
    v_lshl_add_u32 v5, v3, 5, v5
    ds_write_b128 v5, v[100:103]
    ds_write_b128 v5, v[104:107] offset:16
    s_waitcnt lgkmcnt(0)
    s_barrier
    s_cmp_ge_u32 s3, 2
    s_cbranch_scc1 cs2_29_skip
    v_lshlrev_b32 v5, 2, v0
    ds_read_b32 v16, v5 offset:0
    ds_read_b32 v17, v5 offset:512
    ds_read_b32 v18, v5 offset:1024
    ds_read_b32 v19, v5 offset:1536
    ds_read_b32 v20, v5 offset:2048
    ds_read_b32 v21, v5 offset:2560
    ds_read_b32 v22, v5 offset:3072
    ds_read_b32 v23, v5 offset:3584
    ds_read_b32 v24, v5 offset:4096
    ds_read_b32 v25, v5 offset:4608
    ds_read_b32 v26, v5 offset:5120
    ds_read_b32 v27, v5 offset:5632
    ds_read_b32 v28, v5 offset:6144
    ds_read_b32 v29, v5 offset:6656
    ds_read_b32 v30, v5 offset:7168
    ds_read_b32 v31, v5 offset:7680
    ds_read_b32 v32, v5 offset:8192
    ds_read_b32 v33, v5 offset:8704
    ds_read_b32 v34, v5 offset:9216
    ds_read_b32 v35, v5 offset:9728
    ds_read_b32 v36, v5 offset:10240
    ds_read_b32 v37, v5 offset:10752
    ds_read_b32 v38, v5 offset:11264
    ds_read_b32 v39, v5 offset:11776
    ds_read_b32 v40, v5 offset:12288
    ds_read_b32 v41, v5 offset:12800
    ds_read_b32 v42, v5 offset:13312
    ds_read_b32 v43, v5 offset:13824
    ds_read_b32 v44, v5 offset:14336
    ds_read_b32 v45, v5 offset:14848
    ds_read_b32 v46, v5 offset:15360
    ds_read_b32 v47, v5 offset:15872
    s_waitcnt lgkmcnt(0)
    v_add_f32 v16, v16, v17
    v_add_f32 v16, v16, v18
    v_add_f32 v16, v16, v19
    v_add_f32 v16, v16, v20
    v_add_f32 v16, v16, v21
    v_add_f32 v16, v16, v22
    v_add_f32 v16, v16, v23
    v_add_f32 v16, v16, v24
    v_add_f32 v16, v16, v25
    v_add_f32 v16, v16, v26
    v_add_f32 v16, v16, v27
    v_add_f32 v16, v16, v28
    v_add_f32 v16, v16, v29
    v_add_f32 v16, v16, v30
    v_add_f32 v16, v16, v31
    v_add_f32 v16, v16, v32
    v_add_f32 v16, v16, v33
    v_add_f32 v16, v16, v34
    v_add_f32 v16, v16, v35
    v_add_f32 v16, v16, v36
    v_add_f32 v16, v16, v37
    v_add_f32 v16, v16, v38
    v_add_f32 v16, v16, v39
    v_add_f32 v16, v16, v40
    v_add_f32 v16, v16, v41
    v_add_f32 v16, v16, v42
    v_add_f32 v16, v16, v43
    v_add_f32 v16, v16, v44
    v_add_f32 v16, v16, v45
    v_add_f32 v16, v16, v46
    v_add_f32 v16, v16, v47
    s_lshl_b32 s16, s12, 9
    v_add_u32 v5, s16, v5
    s_mov_b32 s16, 32768
    buffer_store_dword v16, v5, s[4:7], s16 offen sc1
cs2_29_skip:
    s_barrier
cs2_29:
    s_waitcnt vmcnt(0)
    s_barrier
    s_cmp_lg_u32 s3, 0
    s_cbranch_scc1 w0_30
    s_cmp_lg_u32 s60, 0
    s_cbranch_scc1 tag_31_ok
    s_mov_b32 s61, 65536
    v_mov_b32 v2, 0
tag_31_loop:
    buffer_load_dword v3, v2, s[56:59], 0 offen sc1
    s_waitcnt vmcnt(0)
    v_readfirstlane_b32 s60, v3
    s_nop 3
    s_cmp_lg_u32 s60, 0
    s_cbranch_scc1 tag_31_ok
    s_sleep 2
    s_sub_u32 s61, s61, 1
    s_cmp_lg_u32 s61, 0
    s_cbranch_scc1 tag_31_loop
tag_31_ok:
    s_lshl_b32 s62, s2, 4
    s_add_u32 s62, s62, 19959808
    v_mov_b32 v2, 0
    v_mov_b32 v3, s60
    s_mov_b64 s[52:53], exec
    s_mov_b64 exec, 1
    buffer_store_dword v3, v2, s[4:7], s62 offen sc1
    s_mov_b64 exec, s[52:53]
    s_lshl_b32 s62, s12, 4
    s_add_u32 s62, s62, 19927040
    v_mov_b32 v2, 0
    v_mov_b32 v3, s60
    s_mov_b64 s[52:53], exec
    s_mov_b64 exec, 1
    buffer_store_dword v3, v2, s[4:7], s62 offen sc1
    s_mov_b64 exec, s[52:53]
w0_30:
Lw3_round:
    s_cmp_ge_u32 s30, 68
    s_cbranch_scc1 w3l_32
    s_cmp_lt_u32 s30, 48
    s_cselect_b32 s20, s76, s68
    s_cselect_b32 s21, s77, s69
    s_mov_b32 s22, 819200
    s_cselect_b32 s22, 1966080, s22
    s_and_b32 s21, s21, 0xffff
    s_mov_b32 s23, 0x20000
    s_mul_i32 s14, s3, 320
    s_add_u32 s14, s14, 0
    v_add_u32 v2, s14, v1
    v_mul_u32_u24 v3, 52429, v2
    v_lshrrev_b32 v3, 22, v3
    v_mul_u32_u24 v4, 80, v3
    v_sub_u32 v4, v2, v4
    v_and_b32 v5, 3, v3
    v_lshrrev_b32 v6, 3, v3
    v_and_b32 v7, 1, v6
    v_lshl_or_b32 v5, v7, 2, v5
    v_lshlrev_b32 v5, 1, v5
    v_xor_b32 v4, v4, v5
    v_and_b32 v8, 7, v3
    s_cmp_lt_u32 s30, 48
    s_cbranch_scc1 w3_33_a0
    s_cmp_lt_u32 s30, 64
    s_cbranch_scc1 w3_33_b0
    s_sub_u32 s15, s30, 64
    s_lshl_b32 s15, s15, 3
    v_lshrrev_b32 v9, 2, v8
    v_lshl_add_u32 v9, v6, 1, v9
    v_add_u32 v9, s15, v9
    v_and_b32 v10, 3, v8
    v_add_u32 v10, 16, v10
    v_mul_u32_u24 v9, 20, v9
    v_add_u32 v9, v9, v10
    s_branch w3_33_c0
w3_33_b0:
    s_sub_u32 s15, s30, 48
    s_lshl_b32 s15, s15, 1
    v_lshrrev_b32 v9, 1, v6
    v_add_u32 v9, s15, v9
    v_and_b32 v10, 3, v8
    v_lshl_add_u32 v10, v7, 2, v10
    v_lshrrev_b32 v11, 2, v8
    v_lshl_add_u32 v10, v11, 3, v10
    v_mul_u32_u24 v9, 20, v9
    v_add_u32 v9, v9, v10
    s_branch w3_33_c0
w3_33_a0:
    s_lshl_b32 s15, s30, 5
    v_add_u32 v9, s15, v3
w3_33_c0:
    v_mul_u32_u24 v9, 1280, v9
    v_lshl_add_u32 v9, v4, 4, v9
    s_lshl_b32 s14, s14, 4
    s_add_u32 m0, s14, 16384
    s_nop 0
    buffer_load_dwordx4 v9, s[20:23], 0 offen nt lds
    s_mul_i32 s14, s3, 320
    s_add_u32 s14, s14, 64
    v_add_u32 v2, s14, v1
    v_mul_u32_u24 v3, 52429, v2
    v_lshrrev_b32 v3, 22, v3
    v_mul_u32_u24 v4, 80, v3
    v_sub_u32 v4, v2, v4
    v_and_b32 v5, 3, v3
    v_lshrrev_b32 v6, 3, v3
    v_and_b32 v7, 1, v6
    v_lshl_or_b32 v5, v7, 2, v5
    v_lshlrev_b32 v5, 1, v5
    v_xor_b32 v4, v4, v5
    v_and_b32 v8, 7, v3
    s_cmp_lt_u32 s30, 48
    s_cbranch_scc1 w3_33_a1
    s_cmp_lt_u32 s30, 64
    s_cbranch_scc1 w3_33_b1
    s_sub_u32 s15, s30, 64
    s_lshl_b32 s15, s15, 3
    v_lshrrev_b32 v9, 2, v8
    v_lshl_add_u32 v9, v6, 1, v9
    v_add_u32 v9, s15, v9
    v_and_b32 v10, 3, v8
    v_add_u32 v10, 16, v10
    v_mul_u32_u24 v9, 20, v9
    v_add_u32 v9, v9, v10
    s_branch w3_33_c1
w3_33_b1:
    s_sub_u32 s15, s30, 48
    s_lshl_b32 s15, s15, 1
    v_lshrrev_b32 v9, 1, v6
    v_add_u32 v9, s15, v9
    v_and_b32 v10, 3, v8
    v_lshl_add_u32 v10, v7, 2, v10
    v_lshrrev_b32 v11, 2, v8
    v_lshl_add_u32 v10, v11, 3, v10
    v_mul_u32_u24 v9, 20, v9
    v_add_u32 v9, v9, v10
    s_branch w3_33_c1
w3_33_a1:
    s_lshl_b32 s15, s30, 5
    v_add_u32 v9, s15, v3
w3_33_c1:
    v_mul_u32_u24 v9, 1280, v9
    v_lshl_add_u32 v9, v4, 4, v9
    s_lshl_b32 s14, s14, 4
    s_add_u32 m0, s14, 16384
    s_nop 0
    buffer_load_dwordx4 v9, s[20:23], 0 offen nt lds
    s_mul_i32 s14, s3, 320
    s_add_u32 s14, s14, 128
    v_add_u32 v2, s14, v1
    v_mul_u32_u24 v3, 52429, v2
    v_lshrrev_b32 v3, 22, v3
    v_mul_u32_u24 v4, 80, v3
    v_sub_u32 v4, v2, v4
    v_and_b32 v5, 3, v3
    v_lshrrev_b32 v6, 3, v3
    v_and_b32 v7, 1, v6
    v_lshl_or_b32 v5, v7, 2, v5
    v_lshlrev_b32 v5, 1, v5
    v_xor_b32 v4, v4, v5
    v_and_b32 v8, 7, v3
    s_cmp_lt_u32 s30, 48
    s_cbranch_scc1 w3_33_a2
    s_cmp_lt_u32 s30, 64
    s_cbranch_scc1 w3_33_b2
    s_sub_u32 s15, s30, 64
    s_lshl_b32 s15, s15, 3
    v_lshrrev_b32 v9, 2, v8
    v_lshl_add_u32 v9, v6, 1, v9
    v_add_u32 v9, s15, v9
    v_and_b32 v10, 3, v8
    v_add_u32 v10, 16, v10
    v_mul_u32_u24 v9, 20, v9
    v_add_u32 v9, v9, v10
    s_branch w3_33_c2
w3_33_b2:
    s_sub_u32 s15, s30, 48
    s_lshl_b32 s15, s15, 1
    v_lshrrev_b32 v9, 1, v6
    v_add_u32 v9, s15, v9
    v_and_b32 v10, 3, v8
    v_lshl_add_u32 v10, v7, 2, v10
    v_lshrrev_b32 v11, 2, v8
    v_lshl_add_u32 v10, v11, 3, v10
    v_mul_u32_u24 v9, 20, v9
    v_add_u32 v9, v9, v10
    s_branch w3_33_c2
w3_33_a2:
    s_lshl_b32 s15, s30, 5
    v_add_u32 v9, s15, v3
w3_33_c2:
    v_mul_u32_u24 v9, 1280, v9
    v_lshl_add_u32 v9, v4, 4, v9
    s_lshl_b32 s14, s14, 4
    s_add_u32 m0, s14, 16384
    s_nop 0
    buffer_load_dwordx4 v9, s[20:23], 0 offen nt lds
    s_mul_i32 s14, s3, 320
    s_add_u32 s14, s14, 192
    v_add_u32 v2, s14, v1
    v_mul_u32_u24 v3, 52429, v2
    v_lshrrev_b32 v3, 22, v3
    v_mul_u32_u24 v4, 80, v3
    v_sub_u32 v4, v2, v4
    v_and_b32 v5, 3, v3
    v_lshrrev_b32 v6, 3, v3
    v_and_b32 v7, 1, v6
    v_lshl_or_b32 v5, v7, 2, v5
    v_lshlrev_b32 v5, 1, v5
    v_xor_b32 v4, v4, v5
    v_and_b32 v8, 7, v3
    s_cmp_lt_u32 s30, 48
    s_cbranch_scc1 w3_33_a3
    s_cmp_lt_u32 s30, 64
    s_cbranch_scc1 w3_33_b3
    s_sub_u32 s15, s30, 64
    s_lshl_b32 s15, s15, 3
    v_lshrrev_b32 v9, 2, v8
    v_lshl_add_u32 v9, v6, 1, v9
    v_add_u32 v9, s15, v9
    v_and_b32 v10, 3, v8
    v_add_u32 v10, 16, v10
    v_mul_u32_u24 v9, 20, v9
    v_add_u32 v9, v9, v10
    s_branch w3_33_c3
w3_33_b3:
    s_sub_u32 s15, s30, 48
    s_lshl_b32 s15, s15, 1
    v_lshrrev_b32 v9, 1, v6
    v_add_u32 v9, s15, v9
    v_and_b32 v10, 3, v8
    v_lshl_add_u32 v10, v7, 2, v10
    v_lshrrev_b32 v11, 2, v8
    v_lshl_add_u32 v10, v11, 3, v10
    v_mul_u32_u24 v9, 20, v9
    v_add_u32 v9, v9, v10
    s_branch w3_33_c3
w3_33_a3:
    s_lshl_b32 s15, s30, 5
    v_add_u32 v9, s15, v3
w3_33_c3:
    v_mul_u32_u24 v9, 1280, v9
    v_lshl_add_u32 v9, v4, 4, v9
    s_lshl_b32 s14, s14, 4
    s_add_u32 m0, s14, 16384
    s_nop 0
    buffer_load_dwordx4 v9, s[20:23], 0 offen nt lds
    s_mul_i32 s14, s3, 320
    s_add_u32 s14, s14, 256
    v_add_u32 v2, s14, v1
    v_mul_u32_u24 v3, 52429, v2
    v_lshrrev_b32 v3, 22, v3
    v_mul_u32_u24 v4, 80, v3
    v_sub_u32 v4, v2, v4
    v_and_b32 v5, 3, v3
    v_lshrrev_b32 v6, 3, v3
    v_and_b32 v7, 1, v6
    v_lshl_or_b32 v5, v7, 2, v5
    v_lshlrev_b32 v5, 1, v5
    v_xor_b32 v4, v4, v5
    v_and_b32 v8, 7, v3
    s_cmp_lt_u32 s30, 48
    s_cbranch_scc1 w3_33_a4
    s_cmp_lt_u32 s30, 64
    s_cbranch_scc1 w3_33_b4
    s_sub_u32 s15, s30, 64
    s_lshl_b32 s15, s15, 3
    v_lshrrev_b32 v9, 2, v8
    v_lshl_add_u32 v9, v6, 1, v9
    v_add_u32 v9, s15, v9
    v_and_b32 v10, 3, v8
    v_add_u32 v10, 16, v10
    v_mul_u32_u24 v9, 20, v9
    v_add_u32 v9, v9, v10
    s_branch w3_33_c4
w3_33_b4:
    s_sub_u32 s15, s30, 48
    s_lshl_b32 s15, s15, 1
    v_lshrrev_b32 v9, 1, v6
    v_add_u32 v9, s15, v9
    v_and_b32 v10, 3, v8
    v_lshl_add_u32 v10, v7, 2, v10
    v_lshrrev_b32 v11, 2, v8
    v_lshl_add_u32 v10, v11, 3, v10
    v_mul_u32_u24 v9, 20, v9
    v_add_u32 v9, v9, v10
    s_branch w3_33_c4
w3_33_a4:
    s_lshl_b32 s15, s30, 5
    v_add_u32 v9, s15, v3
w3_33_c4:
    v_mul_u32_u24 v9, 1280, v9
    v_lshl_add_u32 v9, v4, 4, v9
    s_lshl_b32 s14, s14, 4
    s_add_u32 m0, s14, 16384
    s_nop 0
    buffer_load_dwordx4 v9, s[20:23], 0 offen nt lds
w3l_32:
    s_cmp_ge_u32 s31, 68
    s_cbranch_scc1 w3l_34
    s_cmp_lt_u32 s31, 48
    s_cselect_b32 s20, s76, s68
    s_cselect_b32 s21, s77, s69
    s_mov_b32 s22, 819200
    s_cselect_b32 s22, 1966080, s22
    s_and_b32 s21, s21, 0xffff
    s_mov_b32 s23, 0x20000
    s_mul_i32 s14, s3, 320
    s_add_u32 s14, s14, 0
    v_add_u32 v2, s14, v1
    v_mul_u32_u24 v3, 52429, v2
    v_lshrrev_b32 v3, 22, v3
    v_mul_u32_u24 v4, 80, v3
    v_sub_u32 v4, v2, v4
    v_and_b32 v5, 3, v3
    v_lshrrev_b32 v6, 3, v3
    v_and_b32 v7, 1, v6
    v_lshl_or_b32 v5, v7, 2, v5
    v_lshlrev_b32 v5, 1, v5
    v_xor_b32 v4, v4, v5
    v_and_b32 v8, 7, v3
    s_cmp_lt_u32 s31, 48
    s_cbranch_scc1 w3_35_a0
    s_cmp_lt_u32 s31, 64
    s_cbranch_scc1 w3_35_b0
    s_sub_u32 s15, s31, 64
    s_lshl_b32 s15, s15, 3
    v_lshrrev_b32 v9, 2, v8
    v_lshl_add_u32 v9, v6, 1, v9
    v_add_u32 v9, s15, v9
    v_and_b32 v10, 3, v8
    v_add_u32 v10, 16, v10
    v_mul_u32_u24 v9, 20, v9
    v_add_u32 v9, v9, v10
    s_branch w3_35_c0
w3_35_b0:
    s_sub_u32 s15, s31, 48
    s_lshl_b32 s15, s15, 1
    v_lshrrev_b32 v9, 1, v6
    v_add_u32 v9, s15, v9
    v_and_b32 v10, 3, v8
    v_lshl_add_u32 v10, v7, 2, v10
    v_lshrrev_b32 v11, 2, v8
    v_lshl_add_u32 v10, v11, 3, v10
    v_mul_u32_u24 v9, 20, v9
    v_add_u32 v9, v9, v10
    s_branch w3_35_c0
w3_35_a0:
    s_lshl_b32 s15, s31, 5
    v_add_u32 v9, s15, v3
w3_35_c0:
    v_mul_u32_u24 v9, 1280, v9
    v_lshl_add_u32 v9, v4, 4, v9
    s_lshl_b32 s14, s14, 4
    s_add_u32 m0, s14, 57344
    s_nop 0
    buffer_load_dwordx4 v9, s[20:23], 0 offen nt lds
    s_mul_i32 s14, s3, 320
    s_add_u32 s14, s14, 64
    v_add_u32 v2, s14, v1
    v_mul_u32_u24 v3, 52429, v2
    v_lshrrev_b32 v3, 22, v3
    v_mul_u32_u24 v4, 80, v3
    v_sub_u32 v4, v2, v4
    v_and_b32 v5, 3, v3
    v_lshrrev_b32 v6, 3, v3
    v_and_b32 v7, 1, v6
    v_lshl_or_b32 v5, v7, 2, v5
    v_lshlrev_b32 v5, 1, v5
    v_xor_b32 v4, v4, v5
    v_and_b32 v8, 7, v3
    s_cmp_lt_u32 s31, 48
    s_cbranch_scc1 w3_35_a1
    s_cmp_lt_u32 s31, 64
    s_cbranch_scc1 w3_35_b1
    s_sub_u32 s15, s31, 64
    s_lshl_b32 s15, s15, 3
    v_lshrrev_b32 v9, 2, v8
    v_lshl_add_u32 v9, v6, 1, v9
    v_add_u32 v9, s15, v9
    v_and_b32 v10, 3, v8
    v_add_u32 v10, 16, v10
    v_mul_u32_u24 v9, 20, v9
    v_add_u32 v9, v9, v10
    s_branch w3_35_c1
w3_35_b1:
    s_sub_u32 s15, s31, 48
    s_lshl_b32 s15, s15, 1
    v_lshrrev_b32 v9, 1, v6
    v_add_u32 v9, s15, v9
    v_and_b32 v10, 3, v8
    v_lshl_add_u32 v10, v7, 2, v10
    v_lshrrev_b32 v11, 2, v8
    v_lshl_add_u32 v10, v11, 3, v10
    v_mul_u32_u24 v9, 20, v9
    v_add_u32 v9, v9, v10
    s_branch w3_35_c1
w3_35_a1:
    s_lshl_b32 s15, s31, 5
    v_add_u32 v9, s15, v3
w3_35_c1:
    v_mul_u32_u24 v9, 1280, v9
    v_lshl_add_u32 v9, v4, 4, v9
    s_lshl_b32 s14, s14, 4
    s_add_u32 m0, s14, 57344
    s_nop 0
    buffer_load_dwordx4 v9, s[20:23], 0 offen nt lds
    s_mul_i32 s14, s3, 320
    s_add_u32 s14, s14, 128
    v_add_u32 v2, s14, v1
    v_mul_u32_u24 v3, 52429, v2
    v_lshrrev_b32 v3, 22, v3
    v_mul_u32_u24 v4, 80, v3
    v_sub_u32 v4, v2, v4
    v_and_b32 v5, 3, v3
    v_lshrrev_b32 v6, 3, v3
    v_and_b32 v7, 1, v6
    v_lshl_or_b32 v5, v7, 2, v5
    v_lshlrev_b32 v5, 1, v5
    v_xor_b32 v4, v4, v5
    v_and_b32 v8, 7, v3
    s_cmp_lt_u32 s31, 48
    s_cbranch_scc1 w3_35_a2
    s_cmp_lt_u32 s31, 64
    s_cbranch_scc1 w3_35_b2
    s_sub_u32 s15, s31, 64
    s_lshl_b32 s15, s15, 3
    v_lshrrev_b32 v9, 2, v8
    v_lshl_add_u32 v9, v6, 1, v9
    v_add_u32 v9, s15, v9
    v_and_b32 v10, 3, v8
    v_add_u32 v10, 16, v10
    v_mul_u32_u24 v9, 20, v9
    v_add_u32 v9, v9, v10
    s_branch w3_35_c2
w3_35_b2:
    s_sub_u32 s15, s31, 48
    s_lshl_b32 s15, s15, 1
    v_lshrrev_b32 v9, 1, v6
    v_add_u32 v9, s15, v9
    v_and_b32 v10, 3, v8
    v_lshl_add_u32 v10, v7, 2, v10
    v_lshrrev_b32 v11, 2, v8
    v_lshl_add_u32 v10, v11, 3, v10
    v_mul_u32_u24 v9, 20, v9
    v_add_u32 v9, v9, v10
    s_branch w3_35_c2
w3_35_a2:
    s_lshl_b32 s15, s31, 5
    v_add_u32 v9, s15, v3
w3_35_c2:
    v_mul_u32_u24 v9, 1280, v9
    v_lshl_add_u32 v9, v4, 4, v9
    s_lshl_b32 s14, s14, 4
    s_add_u32 m0, s14, 57344
    s_nop 0
    buffer_load_dwordx4 v9, s[20:23], 0 offen nt lds
    s_mul_i32 s14, s3, 320
    s_add_u32 s14, s14, 192
    v_add_u32 v2, s14, v1
    v_mul_u32_u24 v3, 52429, v2
    v_lshrrev_b32 v3, 22, v3
    v_mul_u32_u24 v4, 80, v3
    v_sub_u32 v4, v2, v4
    v_and_b32 v5, 3, v3
    v_lshrrev_b32 v6, 3, v3
    v_and_b32 v7, 1, v6
    v_lshl_or_b32 v5, v7, 2, v5
    v_lshlrev_b32 v5, 1, v5
    v_xor_b32 v4, v4, v5
    v_and_b32 v8, 7, v3
    s_cmp_lt_u32 s31, 48
    s_cbranch_scc1 w3_35_a3
    s_cmp_lt_u32 s31, 64
    s_cbranch_scc1 w3_35_b3
    s_sub_u32 s15, s31, 64
    s_lshl_b32 s15, s15, 3
    v_lshrrev_b32 v9, 2, v8
    v_lshl_add_u32 v9, v6, 1, v9
    v_add_u32 v9, s15, v9
    v_and_b32 v10, 3, v8
    v_add_u32 v10, 16, v10
    v_mul_u32_u24 v9, 20, v9
    v_add_u32 v9, v9, v10
    s_branch w3_35_c3
w3_35_b3:
    s_sub_u32 s15, s31, 48
    s_lshl_b32 s15, s15, 1
    v_lshrrev_b32 v9, 1, v6
    v_add_u32 v9, s15, v9
    v_and_b32 v10, 3, v8
    v_lshl_add_u32 v10, v7, 2, v10
    v_lshrrev_b32 v11, 2, v8
    v_lshl_add_u32 v10, v11, 3, v10
    v_mul_u32_u24 v9, 20, v9
    v_add_u32 v9, v9, v10
    s_branch w3_35_c3
w3_35_a3:
    s_lshl_b32 s15, s31, 5
    v_add_u32 v9, s15, v3
w3_35_c3:
    v_mul_u32_u24 v9, 1280, v9
    v_lshl_add_u32 v9, v4, 4, v9
    s_lshl_b32 s14, s14, 4
    s_add_u32 m0, s14, 57344
    s_nop 0
    buffer_load_dwordx4 v9, s[20:23], 0 offen nt lds
    s_mul_i32 s14, s3, 320
    s_add_u32 s14, s14, 256
    v_add_u32 v2, s14, v1
    v_mul_u32_u24 v3, 52429, v2
    v_lshrrev_b32 v3, 22, v3
    v_mul_u32_u24 v4, 80, v3
    v_sub_u32 v4, v2, v4
    v_and_b32 v5, 3, v3
    v_lshrrev_b32 v6, 3, v3
    v_and_b32 v7, 1, v6
    v_lshl_or_b32 v5, v7, 2, v5
    v_lshlrev_b32 v5, 1, v5
    v_xor_b32 v4, v4, v5
    v_and_b32 v8, 7, v3
    s_cmp_lt_u32 s31, 48
    s_cbranch_scc1 w3_35_a4
    s_cmp_lt_u32 s31, 64
    s_cbranch_scc1 w3_35_b4
    s_sub_u32 s15, s31, 64
    s_lshl_b32 s15, s15, 3
    v_lshrrev_b32 v9, 2, v8
    v_lshl_add_u32 v9, v6, 1, v9
    v_add_u32 v9, s15, v9
    v_and_b32 v10, 3, v8
    v_add_u32 v10, 16, v10
    v_mul_u32_u24 v9, 20, v9
    v_add_u32 v9, v9, v10
    s_branch w3_35_c4
w3_35_b4:
    s_sub_u32 s15, s31, 48
    s_lshl_b32 s15, s15, 1
    v_lshrrev_b32 v9, 1, v6
    v_add_u32 v9, s15, v9
    v_and_b32 v10, 3, v8
    v_lshl_add_u32 v10, v7, 2, v10
    v_lshrrev_b32 v11, 2, v8
    v_lshl_add_u32 v10, v11, 3, v10
    v_mul_u32_u24 v9, 20, v9
    v_add_u32 v9, v9, v10
    s_branch w3_35_c4
w3_35_a4:
    s_lshl_b32 s15, s31, 5
    v_add_u32 v9, s15, v3
w3_35_c4:
    v_mul_u32_u24 v9, 1280, v9
    v_lshl_add_u32 v9, v4, 4, v9
    s_lshl_b32 s14, s14, 4
    s_add_u32 m0, s14, 57344
    s_nop 0
    buffer_load_dwordx4 v9, s[20:23], 0 offen nt lds
w3l_34:
    s_cmp_ge_u32 s32, 68
    s_cbranch_scc1 w3l_36
    s_cmp_lt_u32 s32, 48
    s_cselect_b32 s20, s76, s68
    s_cselect_b32 s21, s77, s69
    s_mov_b32 s22, 819200
    s_cselect_b32 s22, 1966080, s22
    s_and_b32 s21, s21, 0xffff
    s_mov_b32 s23, 0x20000
    s_mul_i32 s14, s3, 320
    s_add_u32 s14, s14, 0
    v_add_u32 v2, s14, v1
    v_mul_u32_u24 v3, 52429, v2
    v_lshrrev_b32 v3, 22, v3
    v_mul_u32_u24 v4, 80, v3
    v_sub_u32 v4, v2, v4
    v_and_b32 v5, 3, v3
    v_lshrrev_b32 v6, 3, v3
    v_and_b32 v7, 1, v6
    v_lshl_or_b32 v5, v7, 2, v5
    v_lshlrev_b32 v5, 1, v5
    v_xor_b32 v4, v4, v5
    v_and_b32 v8, 7, v3
    s_cmp_lt_u32 s32, 48
    s_cbranch_scc1 w3_37_a0
    s_cmp_lt_u32 s32, 64
    s_cbranch_scc1 w3_37_b0
    s_sub_u32 s15, s32, 64
    s_lshl_b32 s15, s15, 3
    v_lshrrev_b32 v9, 2, v8
    v_lshl_add_u32 v9, v6, 1, v9
    v_add_u32 v9, s15, v9
    v_and_b32 v10, 3, v8
    v_add_u32 v10, 16, v10
    v_mul_u32_u24 v9, 20, v9
    v_add_u32 v9, v9, v10
    s_branch w3_37_c0
w3_37_b0:
    s_sub_u32 s15, s32, 48
    s_lshl_b32 s15, s15, 1
    v_lshrrev_b32 v9, 1, v6
    v_add_u32 v9, s15, v9
    v_and_b32 v10, 3, v8
    v_lshl_add_u32 v10, v7, 2, v10
    v_lshrrev_b32 v11, 2, v8
    v_lshl_add_u32 v10, v11, 3, v10
    v_mul_u32_u24 v9, 20, v9
    v_add_u32 v9, v9, v10
    s_branch w3_37_c0
w3_37_a0:
    s_lshl_b32 s15, s32, 5
    v_add_u32 v9, s15, v3
w3_37_c0:
    v_mul_u32_u24 v9, 1280, v9
    v_lshl_add_u32 v9, v4, 4, v9
    s_lshl_b32 s14, s14, 4
    s_add_u32 m0, s14, 98304
    s_nop 0
    buffer_load_dwordx4 v9, s[20:23], 0 offen nt lds
    s_mul_i32 s14, s3, 320
    s_add_u32 s14, s14, 64
    v_add_u32 v2, s14, v1
    v_mul_u32_u24 v3, 52429, v2
    v_lshrrev_b32 v3, 22, v3
    v_mul_u32_u24 v4, 80, v3
    v_sub_u32 v4, v2, v4
    v_and_b32 v5, 3, v3
    v_lshrrev_b32 v6, 3, v3
    v_and_b32 v7, 1, v6
    v_lshl_or_b32 v5, v7, 2, v5
    v_lshlrev_b32 v5, 1, v5
    v_xor_b32 v4, v4, v5
    v_and_b32 v8, 7, v3
    s_cmp_lt_u32 s32, 48
    s_cbranch_scc1 w3_37_a1
    s_cmp_lt_u32 s32, 64
    s_cbranch_scc1 w3_37_b1
    s_sub_u32 s15, s32, 64
    s_lshl_b32 s15, s15, 3
    v_lshrrev_b32 v9, 2, v8
    v_lshl_add_u32 v9, v6, 1, v9
    v_add_u32 v9, s15, v9
    v_and_b32 v10, 3, v8
    v_add_u32 v10, 16, v10
    v_mul_u32_u24 v9, 20, v9
    v_add_u32 v9, v9, v10
    s_branch w3_37_c1
w3_37_b1:
    s_sub_u32 s15, s32, 48
    s_lshl_b32 s15, s15, 1
    v_lshrrev_b32 v9, 1, v6
    v_add_u32 v9, s15, v9
    v_and_b32 v10, 3, v8
    v_lshl_add_u32 v10, v7, 2, v10
    v_lshrrev_b32 v11, 2, v8
    v_lshl_add_u32 v10, v11, 3, v10
    v_mul_u32_u24 v9, 20, v9
    v_add_u32 v9, v9, v10
    s_branch w3_37_c1
w3_37_a1:
    s_lshl_b32 s15, s32, 5
    v_add_u32 v9, s15, v3
w3_37_c1:
    v_mul_u32_u24 v9, 1280, v9
    v_lshl_add_u32 v9, v4, 4, v9
    s_lshl_b32 s14, s14, 4
    s_add_u32 m0, s14, 98304
    s_nop 0
    buffer_load_dwordx4 v9, s[20:23], 0 offen nt lds
    s_mul_i32 s14, s3, 320
    s_add_u32 s14, s14, 128
    v_add_u32 v2, s14, v1
    v_mul_u32_u24 v3, 52429, v2
    v_lshrrev_b32 v3, 22, v3
    v_mul_u32_u24 v4, 80, v3
    v_sub_u32 v4, v2, v4
    v_and_b32 v5, 3, v3
    v_lshrrev_b32 v6, 3, v3
    v_and_b32 v7, 1, v6
    v_lshl_or_b32 v5, v7, 2, v5
    v_lshlrev_b32 v5, 1, v5
    v_xor_b32 v4, v4, v5
    v_and_b32 v8, 7, v3
    s_cmp_lt_u32 s32, 48
    s_cbranch_scc1 w3_37_a2
    s_cmp_lt_u32 s32, 64
    s_cbranch_scc1 w3_37_b2
    s_sub_u32 s15, s32, 64
    s_lshl_b32 s15, s15, 3
    v_lshrrev_b32 v9, 2, v8
    v_lshl_add_u32 v9, v6, 1, v9
    v_add_u32 v9, s15, v9
    v_and_b32 v10, 3, v8
    v_add_u32 v10, 16, v10
    v_mul_u32_u24 v9, 20, v9
    v_add_u32 v9, v9, v10
    s_branch w3_37_c2
w3_37_b2:
    s_sub_u32 s15, s32, 48
    s_lshl_b32 s15, s15, 1
    v_lshrrev_b32 v9, 1, v6
    v_add_u32 v9, s15, v9
    v_and_b32 v10, 3, v8
    v_lshl_add_u32 v10, v7, 2, v10
    v_lshrrev_b32 v11, 2, v8
    v_lshl_add_u32 v10, v11, 3, v10
    v_mul_u32_u24 v9, 20, v9
    v_add_u32 v9, v9, v10
    s_branch w3_37_c2
w3_37_a2:
    s_lshl_b32 s15, s32, 5
    v_add_u32 v9, s15, v3
w3_37_c2:
    v_mul_u32_u24 v9, 1280, v9
    v_lshl_add_u32 v9, v4, 4, v9
    s_lshl_b32 s14, s14, 4
    s_add_u32 m0, s14, 98304
    s_nop 0
    buffer_load_dwordx4 v9, s[20:23], 0 offen nt lds
    s_mul_i32 s14, s3, 320
    s_add_u32 s14, s14, 192
    v_add_u32 v2, s14, v1
    v_mul_u32_u24 v3, 52429, v2
    v_lshrrev_b32 v3, 22, v3
    v_mul_u32_u24 v4, 80, v3
    v_sub_u32 v4, v2, v4
    v_and_b32 v5, 3, v3
    v_lshrrev_b32 v6, 3, v3
    v_and_b32 v7, 1, v6
    v_lshl_or_b32 v5, v7, 2, v5
    v_lshlrev_b32 v5, 1, v5
    v_xor_b32 v4, v4, v5
    v_and_b32 v8, 7, v3
    s_cmp_lt_u32 s32, 48
    s_cbranch_scc1 w3_37_a3
    s_cmp_lt_u32 s32, 64
    s_cbranch_scc1 w3_37_b3
    s_sub_u32 s15, s32, 64
    s_lshl_b32 s15, s15, 3
    v_lshrrev_b32 v9, 2, v8
    v_lshl_add_u32 v9, v6, 1, v9
    v_add_u32 v9, s15, v9
    v_and_b32 v10, 3, v8
    v_add_u32 v10, 16, v10
    v_mul_u32_u24 v9, 20, v9
    v_add_u32 v9, v9, v10
    s_branch w3_37_c3
w3_37_b3:
    s_sub_u32 s15, s32, 48
    s_lshl_b32 s15, s15, 1
    v_lshrrev_b32 v9, 1, v6
    v_add_u32 v9, s15, v9
    v_and_b32 v10, 3, v8
    v_lshl_add_u32 v10, v7, 2, v10
    v_lshrrev_b32 v11, 2, v8
    v_lshl_add_u32 v10, v11, 3, v10
    v_mul_u32_u24 v9, 20, v9
    v_add_u32 v9, v9, v10
    s_branch w3_37_c3
w3_37_a3:
    s_lshl_b32 s15, s32, 5
    v_add_u32 v9, s15, v3
w3_37_c3:
    v_mul_u32_u24 v9, 1280, v9
    v_lshl_add_u32 v9, v4, 4, v9
    s_lshl_b32 s14, s14, 4
    s_add_u32 m0, s14, 98304
    s_nop 0
    buffer_load_dwordx4 v9, s[20:23], 0 offen nt lds
    s_mul_i32 s14, s3, 320
    s_add_u32 s14, s14, 256
    v_add_u32 v2, s14, v1
    v_mul_u32_u24 v3, 52429, v2
    v_lshrrev_b32 v3, 22, v3
    v_mul_u32_u24 v4, 80, v3
    v_sub_u32 v4, v2, v4
    v_and_b32 v5, 3, v3
    v_lshrrev_b32 v6, 3, v3
    v_and_b32 v7, 1, v6
    v_lshl_or_b32 v5, v7, 2, v5
    v_lshlrev_b32 v5, 1, v5
    v_xor_b32 v4, v4, v5
    v_and_b32 v8, 7, v3
    s_cmp_lt_u32 s32, 48
    s_cbranch_scc1 w3_37_a4
    s_cmp_lt_u32 s32, 64
    s_cbranch_scc1 w3_37_b4
    s_sub_u32 s15, s32, 64
    s_lshl_b32 s15, s15, 3
    v_lshrrev_b32 v9, 2, v8
    v_lshl_add_u32 v9, v6, 1, v9
    v_add_u32 v9, s15, v9
    v_and_b32 v10, 3, v8
    v_add_u32 v10, 16, v10
    v_mul_u32_u24 v9, 20, v9
    v_add_u32 v9, v9, v10
    s_branch w3_37_c4
w3_37_b4:
    s_sub_u32 s15, s32, 48
    s_lshl_b32 s15, s15, 1
    v_lshrrev_b32 v9, 1, v6
    v_add_u32 v9, s15, v9
    v_and_b32 v10, 3, v8
    v_lshl_add_u32 v10, v7, 2, v10
    v_lshrrev_b32 v11, 2, v8
    v_lshl_add_u32 v10, v11, 3, v10
    v_mul_u32_u24 v9, 20, v9
    v_add_u32 v9, v9, v10
    s_branch w3_37_c4
w3_37_a4:
    s_lshl_b32 s15, s32, 5
    v_add_u32 v9, s15, v3
w3_37_c4:
    v_mul_u32_u24 v9, 1280, v9
    v_lshl_add_u32 v9, v4, 4, v9
    s_lshl_b32 s14, s14, 4
    s_add_u32 m0, s14, 98304
    s_nop 0
    buffer_load_dwordx4 v9, s[20:23], 0 offen nt lds
w3l_36:
    s_waitcnt vmcnt(0)
    s_barrier
    s_cmp_ge_u32 s30, 68
    s_cbranch_scc1 w3p_38
    v_lshrrev_b32 v2, 4, v1
    v_and_b32 v3, 15, v1
    v_lshrrev_b32 v4, 2, v3
    v_lshl_add_u32 v4, v2, 3, v4
    v_and_b32 v5, 3, v4
    v_and_b32 v6, 1, v2
    v_lshl_or_b32 v5, v6, 2, v5
    v_lshlrev_b32 v5, 5, v5
    v_mul_u32_u24 v4, 1280, v4
    v_add_u32 v4, 16384, v4
    v_and_b32 v6, 3, v3
    v_lshlrev_b32 v6, 3, v6
    s_mul_i32 s14, s3, 160
    s_add_u32 s15, s14, 0
    v_add_u32 v7, s15, v6
    v_xor_b32 v7, v7, v5
    v_add_u32 v7, v7, v4
    ds_read_b64_tr_b16 v[16:17], v7
    ds_read_b64_tr_b16 v[18:19], v7 offset:5120
    s_add_u32 s15, s14, 32
    v_add_u32 v7, s15, v6
    v_xor_b32 v7, v7, v5
    v_add_u32 v7, v7, v4
    ds_read_b64_tr_b16 v[20:21], v7
    ds_read_b64_tr_b16 v[22:23], v7 offset:5120
    s_add_u32 s15, s14, 64
    v_add_u32 v7, s15, v6
    v_xor_b32 v7, v7, v5
    v_add_u32 v7, v7, v4
    ds_read_b64_tr_b16 v[24:25], v7
    ds_read_b64_tr_b16 v[26:27], v7 offset:5120
    s_add_u32 s15, s14, 96
    v_add_u32 v7, s15, v6
    v_xor_b32 v7, v7, v5
    v_add_u32 v7, v7, v4
    ds_read_b64_tr_b16 v[28:29], v7
    ds_read_b64_tr_b16 v[30:31], v7 offset:5120
    s_add_u32 s15, s14, 128
    v_add_u32 v7, s15, v6
    v_xor_b32 v7, v7, v5
    v_add_u32 v7, v7, v4
    ds_read_b64_tr_b16 v[32:33], v7
    ds_read_b64_tr_b16 v[34:35], v7 offset:5120
    s_mul_i32 s14, s3, 68
    s_add_u32 s14, s14, s30
    s_mul_i32 s14, s14, 5120
    s_add_u32 s14, s14, 16842752
    v_lshlrev_b32 v8, 4, v1
    s_waitcnt lgkmcnt(0)
    buffer_store_dwordx4 v[16:19], v8, s[4:7], s14 offen offset:0 sc1
    buffer_store_dwordx4 v[20:23], v8, s[4:7], s14 offen offset:1024 sc1
    buffer_store_dwordx4 v[24:27], v8, s[4:7], s14 offen offset:2048 sc1
    buffer_store_dwordx4 v[28:31], v8, s[4:7], s14 offen offset:3072 sc1
    s_add_u32 s14, s14, 4096
    buffer_store_dwordx4 v[32:35], v8, s[4:7], s14 offen offset:0 sc1
w3p_38:
    s_cmp_ge_u32 s31, 68
    s_cbranch_scc1 w3p_39
    v_lshrrev_b32 v2, 4, v1
    v_and_b32 v3, 15, v1
    v_lshrrev_b32 v4, 2, v3
    v_lshl_add_u32 v4, v2, 3, v4
    v_and_b32 v5, 3, v4
    v_and_b32 v6, 1, v2
    v_lshl_or_b32 v5, v6, 2, v5
    v_lshlrev_b32 v5, 5, v5
    v_mul_u32_u24 v4, 1280, v4
    v_add_u32 v4, 57344, v4
    v_and_b32 v6, 3, v3
    v_lshlrev_b32 v6, 3, v6
    s_mul_i32 s14, s3, 160
    s_add_u32 s15, s14, 0
    v_add_u32 v7, s15, v6
    v_xor_b32 v7, v7, v5
    v_add_u32 v7, v7, v4
    ds_read_b64_tr_b16 v[16:17], v7
    ds_read_b64_tr_b16 v[18:19], v7 offset:5120
    s_add_u32 s15, s14, 32
    v_add_u32 v7, s15, v6
    v_xor_b32 v7, v7, v5
    v_add_u32 v7, v7, v4
    ds_read_b64_tr_b16 v[20:21], v7
    ds_read_b64_tr_b16 v[22:23], v7 offset:5120
    s_add_u32 s15, s14, 64
    v_add_u32 v7, s15, v6
    v_xor_b32 v7, v7, v5
    v_add_u32 v7, v7, v4
    ds_read_b64_tr_b16 v[24:25], v7
    ds_read_b64_tr_b16 v[26:27], v7 offset:5120
    s_add_u32 s15, s14, 96
    v_add_u32 v7, s15, v6
    v_xor_b32 v7, v7, v5
    v_add_u32 v7, v7, v4
    ds_read_b64_tr_b16 v[28:29], v7
    ds_read_b64_tr_b16 v[30:31], v7 offset:5120
    s_add_u32 s15, s14, 128
    v_add_u32 v7, s15, v6
    v_xor_b32 v7, v7, v5
    v_add_u32 v7, v7, v4
    ds_read_b64_tr_b16 v[32:33], v7
    ds_read_b64_tr_b16 v[34:35], v7 offset:5120
    s_mul_i32 s14, s3, 68
    s_add_u32 s14, s14, s31
    s_mul_i32 s14, s14, 5120
    s_add_u32 s14, s14, 16842752
    v_lshlrev_b32 v8, 4, v1
    s_waitcnt lgkmcnt(0)
    buffer_store_dwordx4 v[16:19], v8, s[4:7], s14 offen offset:0 sc1
    buffer_store_dwordx4 v[20:23], v8, s[4:7], s14 offen offset:1024 sc1
    buffer_store_dwordx4 v[24:27], v8, s[4:7], s14 offen offset:2048 sc1
    buffer_store_dwordx4 v[28:31], v8, s[4:7], s14 offen offset:3072 sc1
    s_add_u32 s14, s14, 4096
    buffer_store_dwordx4 v[32:35], v8, s[4:7], s14 offen offset:0 sc1
w3p_39:
    s_cmp_ge_u32 s32, 68
    s_cbranch_scc1 w3p_40
    v_lshrrev_b32 v2, 4, v1
    v_and_b32 v3, 15, v1
    v_lshrrev_b32 v4, 2, v3
    v_lshl_add_u32 v4, v2, 3, v4
    v_and_b32 v5, 3, v4
    v_and_b32 v6, 1, v2
    v_lshl_or_b32 v5, v6, 2, v5
    v_lshlrev_b32 v5, 5, v5
    v_mul_u32_u24 v4, 1280, v4
    v_add_u32 v4, 98304, v4
    v_and_b32 v6, 3, v3
    v_lshlrev_b32 v6, 3, v6
    s_mul_i32 s14, s3, 160
    s_add_u32 s15, s14, 0
    v_add_u32 v7, s15, v6
    v_xor_b32 v7, v7, v5
    v_add_u32 v7, v7, v4
    ds_read_b64_tr_b16 v[16:17], v7
    ds_read_b64_tr_b16 v[18:19], v7 offset:5120
    s_add_u32 s15, s14, 32
    v_add_u32 v7, s15, v6
    v_xor_b32 v7, v7, v5
    v_add_u32 v7, v7, v4
    ds_read_b64_tr_b16 v[20:21], v7
    ds_read_b64_tr_b16 v[22:23], v7 offset:5120
    s_add_u32 s15, s14, 64
    v_add_u32 v7, s15, v6
    v_xor_b32 v7, v7, v5
    v_add_u32 v7, v7, v4
    ds_read_b64_tr_b16 v[24:25], v7
    ds_read_b64_tr_b16 v[26:27], v7 offset:5120
    s_add_u32 s15, s14, 96
    v_add_u32 v7, s15, v6
    v_xor_b32 v7, v7, v5
    v_add_u32 v7, v7, v4
    ds_read_b64_tr_b16 v[28:29], v7
    ds_read_b64_tr_b16 v[30:31], v7 offset:5120
    s_add_u32 s15, s14, 128
    v_add_u32 v7, s15, v6
    v_xor_b32 v7, v7, v5
    v_add_u32 v7, v7, v4
    ds_read_b64_tr_b16 v[32:33], v7
    ds_read_b64_tr_b16 v[34:35], v7 offset:5120
    s_mul_i32 s14, s3, 68
    s_add_u32 s14, s14, s32
    s_mul_i32 s14, s14, 5120
    s_add_u32 s14, s14, 16842752
    v_lshlrev_b32 v8, 4, v1
    s_waitcnt lgkmcnt(0)
    buffer_store_dwordx4 v[16:19], v8, s[4:7], s14 offen offset:0 sc1
    buffer_store_dwordx4 v[20:23], v8, s[4:7], s14 offen offset:1024 sc1
    buffer_store_dwordx4 v[24:27], v8, s[4:7], s14 offen offset:2048 sc1
    buffer_store_dwordx4 v[28:31], v8, s[4:7], s14 offen offset:3072 sc1
    s_add_u32 s14, s14, 4096
    buffer_store_dwordx4 v[32:35], v8, s[4:7], s14 offen offset:0 sc1
w3p_40:
    s_waitcnt vmcnt(0)
    s_barrier
    s_cmp_lg_u32 s3, 0
    s_cbranch_scc1 w0_41
    s_lshl_b32 s62, s12, 4
    s_add_u32 s62, s62, 19931136
    v_mov_b32 v2, 0
    v_mov_b32 v3, s60
    s_mov_b64 s[52:53], exec
    s_mov_b64 exec, 1
    buffer_store_dword v3, v2, s[4:7], s62 offen sc1
    s_mov_b64 exec, s[52:53]
w0_41:
    s_mov_b32 s18, 0
    s_mov_b32 s87, s18
    s_and_b32 s40, s2, 7
    s_lshr_b32 s41, s2, 3
    s_and_b32 s42, s41, 3
    s_lshl_b32 s12, s40, 2
    s_add_u32 s12, s12, s42
    s_lshr_b32 s13, s41, 2
    s_and_b32 s14, s12, 1
    s_lshr_b32 s40, s12, 1
    s_mul_i32 s40, s40, 5
    s_mul_i32 s41, s14, 3
    s_add_u32 s16, s41, s40
    s_add_u32 s17, s16, 1
    s_add_u32 s18, s40, 2
    s_lshl_b32 s19, s13, 8
    s_lshl_b32 s15, s13, 3
    s_add_u32 s15, s15, s3
    s_sub_u32 s15, s15, 8
    s_lshr_b32 s54, s12, 1
    s_mul_i32 s54, s54, 40
    s_lshl_b32 s55, s14, 4
    s_add_u32 s55, s54, s55
    s_add_u32 s62, s55, 23
    s_lshr_b32 s55, s55, 6
    s_lshr_b32 s62, s62, 6
    s_mul_i32 s54, s12, 20
    s_add_u32 s63, s54, 19
    s_lshr_b32 s54, s54, 6
    s_lshr_b32 s63, s63, 6
    v_and_b32 v12, 1, v1
    v_lshrrev_b32 v13, 1, v1
    v_cmp_eq_u32 vcc, 1, v12
    v_mov_b32 v14, s55
    v_mov_b32 v60, s62
    s_nop 0
    v_cndmask_b32 v14, v14, v60, vcc
    v_mov_b32 v12, s54
    v_mov_b32 v60, s63
    v_cndmask_b32 v12, v12, v60, vcc
    v_cmp_ne_u32 vcc, 0, v13
    v_add_u32 v60, 10, v14
    s_nop 0
    v_cndmask_b32 v14, v14, v60, vcc
    v_subrev_u32 v60, 14, v14
    v_lshrrev_b32 v60, 1, v60
    v_add_u32 v60, 24, v60
    v_cmp_gt_u32 vcc, 14, v14
    v_add_u32 v14, 10, v14
    s_nop 0
    v_cndmask_b32 v14, v60, v14, vcc
    v_cmp_le_u32 vcc, 3, v13
    s_nop 1
    v_cndmask_b32 v14, v14, v12, vcc
    s_cmp_eq_u32 s13, 0
    s_cselect_b32 s54, 0, 1
    v_cmp_eq_u32 vcc, 2, v13
    v_mov_b32 v12, s13
    v_subrev_u32 v60, s54, v12
    s_nop 0
    v_cndmask_b32 v12, v12, v60, vcc
    v_cmp_eq_u32 vcc, 4, v13
    s_nop 1
    v_cndmask_b32 v12, v12, v60, vcc
    v_lshl_add_u32 v12, v12, 5, v14
    v_lshlrev_b32 v59, 4, v12
    v_add_u32 v59, 19935232, v59
    v_lshlrev_b32 v61, 4, v1
    v_add_u32 v61, 19931136, v61
    s_cmp_lg_u32 s3, 0
    s_cbranch_scc1 w0_42
    buffer_load_dword v60, v59, s[4:7], 0 offen sc1
    buffer_load_dword v62, v61, s[4:7], 0 offen sc1
w0_42:
Lp2:
    v_and_b32 v2, 31, v1
    v_lshrrev_b32 v3, 5, v1
    s_lshl_b32 s54, s3, 5
    s_add_u32 s54, s54, s19
    v_add_u32 v12, s54, v2
    v_lshlrev_b32 v255, 4, v12
    v_lshl_add_u32 v254, v3, 15, v255
    v_lshlrev_b32 v56, 4, v1
    v_and_b32 v2, 31, v1
    v_lshrrev_b32 v3, 5, v1
    v_lshlrev_b32 v12, 2, v3
    v_sub_u32 v12, v2, v12
    v_cmp_le_i32 s[20:21], 0, v12
    v_cmp_le_i32 s[22:23], 1, v12
    v_cmp_le_i32 s[24:25], 2, v12
    v_cmp_le_i32 s[26:27], 3, v12
    v_cmp_le_i32 s[28:29], 8, v12
    v_cmp_le_i32 s[30:31], 9, v12
    v_cmp_le_i32 s[32:33], 10, v12
    v_cmp_le_i32 s[34:35], 11, v12
    v_cmp_le_i32 s[36:37], 16, v12
    v_cmp_le_i32 s[38:39], 17, v12
    v_cmp_le_i32 s[40:41], 18, v12
    v_cmp_le_i32 s[42:43], 19, v12
    v_cmp_le_i32 s[44:45], 24, v12
    v_cmp_le_i32 s[46:47], 25, v12
    v_cmp_le_i32 s[48:49], 26, v12
    v_cmp_le_i32 s[50:51], 27, v12
    v_mov_b32 v14, 0xffff
    v_mov_b32 v15, 0xffff0000
    v_cndmask_b32 v12, 0, v14, s[20:21]
    v_cndmask_b32 v13, 0, v15, s[22:23]
    v_or_b32 v16, v12, v13
    v_cndmask_b32 v12, 0, v14, s[24:25]
    v_cndmask_b32 v13, 0, v15, s[26:27]
    v_or_b32 v17, v12, v13
    v_cndmask_b32 v12, 0, v14, s[28:29]
    v_cndmask_b32 v13, 0, v15, s[30:31]
    v_or_b32 v18, v12, v13
    v_cndmask_b32 v12, 0, v14, s[32:33]
    v_cndmask_b32 v13, 0, v15, s[34:35]
    v_or_b32 v19, v12, v13
    v_cndmask_b32 v12, 0, v14, s[36:37]
    v_cndmask_b32 v13, 0, v15, s[38:39]
    v_or_b32 v20, v12, v13
    v_cndmask_b32 v12, 0, v14, s[40:41]
    v_cndmask_b32 v13, 0, v15, s[42:43]
    v_or_b32 v21, v12, v13
    v_cndmask_b32 v12, 0, v14, s[44:45]
    v_cndmask_b32 v13, 0, v15, s[46:47]
    v_or_b32 v22, v12, v13
    v_cndmask_b32 v12, 0, v14, s[48:49]
    v_cndmask_b32 v13, 0, v15, s[50:51]
    v_or_b32 v23, v12, v13
    s_lshl_b32 s54, s3, 9
    v_lshlrev_b32 v12, 4, v2
    v_add_u32 v12, s54, v12
    v_add_u32 v249, 16384, v12
    v_lshl_add_u32 v248, v3, 13, v12
    s_mul_i32 s54, s3, 1344
    v_mul_u32_u24 v12, 336, v3
    v_lshl_add_u32 v12, v2, 4, v12
    v_add_u32 v12, s54, v12
    v_add_u32 v250, 24576, v12
    v_cmp_lt_u32 vcc, 20, v1
    v_subrev_u32 v12, 21, v1
    s_nop 0
    v_cndmask_b32 v12, v1, v12, vcc
    v_cndmask_b32 v13, 0, 1, vcc
    v_lshlrev_b32 v12, 5, v12
    v_lshl_add_u32 v12, v13, 4, v12
    s_mul_i32 s54, s12, 640
    v_add_u32 v57, s54, v12
    s_mul_i32 s54, s3, 672
    v_lshlrev_b32 v12, 4, v1
    v_add_u32 v58, s54, v12
    v_mov_b32 v12, 0x3f803f80
    v_cmp_gt_u32 vcc, 32, v1
    v_mov_b32 v5, 0
    v_mov_b32 v6, 0
    v_cndmask_b32 v4, 0, v12, vcc
    v_mov_b32 v7, 0
    v_mov_b32 v9, 0
    v_mov_b32 v10, 0
    v_mov_b32 v11, 0
    s_and_b32 s54, s2, 7
    s_lshr_b32 s55, s2, 3
    s_lshr_b32 s62, s54, 1
    s_and_b32 s63, s54, 1
    s_lshl_b32 s64, s62, 3
    s_and_b32 s62, s55, 7
    s_add_u32 s64, s64, s62
    s_lshr_b32 s62, s55, 3
    s_lshl_b32 s65, s63, 2
    s_add_u32 s65, s65, s62
    s_lshl_b32 s66, s64, 6
    s_mul_i32 s67, s65, 68
    s_add_u32 s67, s67, s3
    s_mul_i32 s67, s67, 5120
    s_add_u32 s67, s67, 16842752
    s_mul_i32 s68, s3, 5120
    s_mul_i32 s71, s3, 5120
    s_cmp_ge_u32 s3, 4
    s_cselect_b32 s54, 121856, 0
    s_add_u32 s71, s71, s54
    s_and_b32 s55, s3, 3
    s_lshl_b32 s55, s55, 1
    s_mul_i32 s77, s55, 5120
    s_mul_i32 s62, s65, 68
    s_add_u32 s62, s62, s55
    s_mul_i32 s76, s62, 5120
    s_add_u32 s76, s76, 16842752
    s_cmp_ge_u32 s55, 4
    s_cselect_b32 s54, 121856, 0
    s_add_u32 s83, s77, s54
    s_lshr_b32 s54, s3, 2
    s_lshl_b32 s69, s54, 17
    s_lshl_b32 s70, s54, 17
    s_mov_b32 s72, s78
    s_and_b32 s73, s79, 0xffff
    s_mov_b32 s74, 1280
    s_mov_b32 s75, 0x20000
    s_lshl_b32 s54, s3, 6
    v_add_u32 v2, s54, v1
    v_mul_u32_u24 v3, 6554, v2
    v_lshrrev_b32 v3, 16, v3
    v_mul_u32_u24 v14, 10, v3
    v_sub_u32 v14, v2, v14
    v_add_u32 v3, s66, v3
    v_mul_u32_u24 v3, 1280, v3
    v_lshl_add_u32 v3, v14, 4, v3
    s_mul_i32 s55, s65, 160
    s_lshl_b32 s54, s54, 4
    s_add_u32 m0, s54, 131072
    s_nop 0
    buffer_load_dwordx4 v3, s[8:11], s55 offen lds
    s_cmp_gt_u32 s3, 2
    s_cbranch_scc1 rd_43_e
    s_cmp_eq_u32 s3, 2
    s_cbranch_scc1 rd_43_b
    s_add_u32 s62, s3, 8
    s_lshl_b32 s54, s62, 6
    v_add_u32 v2, s54, v1
    v_mul_u32_u24 v3, 6554, v2
    v_lshrrev_b32 v3, 16, v3
    v_mul_u32_u24 v14, 10, v3
    v_sub_u32 v14, v2, v14
    v_add_u32 v3, s66, v3
    v_mul_u32_u24 v3, 1280, v3
    v_lshl_add_u32 v3, v14, 4, v3
    s_mul_i32 s55, s65, 160
    s_lshl_b32 s54, s54, 4
    s_add_u32 m0, s54, 131072
    s_nop 0
    buffer_load_dwordx4 v3, s[8:11], s55 offen lds
    s_branch rd_43_e
rd_43_b:
    v_lshlrev_b32 v3, 4, v1
    s_mul_i32 s55, s65, 160
    s_mov_b32 m0, 141312
    s_nop 0
    buffer_load_dwordx4 v3, s[72:75], s55 offen lds
rd_43_e:
    s_cmp_lg_u32 s3, 0
    s_cbranch_scc1 w0_44
    s_cmp_lg_u32 s60, 0
    s_cbranch_scc1 tag_45_ok
    s_mov_b32 s61, 65536
    v_mov_b32 v2, 0
tag_45_loop:
    buffer_load_dword v3, v2, s[56:59], 0 offen sc1
    s_waitcnt vmcnt(0)
    v_readfirstlane_b32 s60, v3
    s_nop 3
    s_cmp_lg_u32 s60, 0
    s_cbranch_scc1 tag_45_ok
    s_sleep 2
    s_sub_u32 s61, s61, 1
    s_cmp_lg_u32 s61, 0
    s_cbranch_scc1 tag_45_loop
tag_45_ok:
    s_waitcnt vmcnt(2)
    v_cmp_gt_u32 vcc, 10, v1
    s_and_saveexec_b64 s[52:53], vcc
    s_mov_b32 s61, 65536
pf_46_loop:
    v_cmp_ne_u32 vcc, s60, v60
    s_nop 4
    s_cmp_eq_u64 vcc, 0
    s_cbranch_scc1 pf_46_done
    s_sleep 1
    buffer_load_dword v60, v59, s[4:7], 0 offen sc1
    s_waitcnt vmcnt(0)
    s_sub_u32 s61, s61, 1
    s_cmp_lg_u32 s61, 0
    s_cbranch_scc1 pf_46_loop
pf_46_done:
    s_mov_b64 exec, s[52:53]
    v_cmp_gt_u32 vcc, 40, v1
    s_and_saveexec_b64 s[52:53], vcc
    s_mov_b32 s61, 65536
pf_47_loop:
    v_cmp_ne_u32 vcc, s60, v62
    s_nop 4
    s_cmp_eq_u64 vcc, 0
    s_cbranch_scc1 pf_47_done
    s_sleep 1
    buffer_load_dword v62, v61, s[4:7], 0 offen sc1
    s_waitcnt vmcnt(0)
    s_sub_u32 s61, s61, 1
    s_cmp_lg_u32 s61, 0
    s_cbranch_scc1 pf_47_loop
pf_47_done:
    s_mov_b64 exec, s[52:53]
w0_44:
    s_barrier
    s_lshl_b32 s54, s16, 15
    s_add_u32 s54, s54, 65536
    buffer_load_dwordx4 v[224:227], v254, s[4:7], s54 offen sc1
    s_lshl_b32 s54, s18, 15
    s_add_u32 s54, s54, 65536
    buffer_load_dwordx4 v[228:231], v255, s[4:7], s54 offen sc1
    s_sub_u32 s55, s19, 256
    s_lshl_b32 s54, s3, 6
    s_add_u32 s55, s55, s54
    s_lshl_b32 s55, s55, 4
    s_add_u32 s55, s55, 2686976
    s_lshl_b32 s62, s3, 10
    s_cmp_eq_u32 s13, 0
    s_cselect_b32 s54, 1, 0
    s_cmp_lt_u32 s3, 4
    s_cselect_b32 s63, 1, 0
    s_and_b32 s54, s54, s63
    s_cmp_eq_u32 s54, 1
    s_cbranch_scc1 skK_48
    s_lshl_b32 s54, s16, 15
    s_add_u32 s54, s54, s55
    s_add_u32 m0, s62, 0
    s_nop 0
    buffer_load_dwordx4 v56, s[4:7], s54 offen sc1 lds
    s_lshl_b32 s54, s17, 15
    s_add_u32 s54, s54, s55
    s_add_u32 m0, s62, 8192
    s_nop 0
    buffer_load_dwordx4 v56, s[4:7], s54 offen sc1 lds
    s_lshl_b32 s54, s18, 15
    s_add_u32 s54, s54, s55
    s_add_u32 m0, s62, 16384
    s_nop 0
    buffer_load_dwordx4 v56, s[4:7], s54 offen sc1 lds
skK_48:
    v_mov_b32 v12, 0x3f803f80
    v_mov_b32 v13, 0x3f803f80
    v_mov_b32 v14, 0x3f803f80
    v_mov_b32 v15, 0x3f803f80
    s_mov_b32 s52, 0x00100000
    s_mov_b32 s53, 0x00000200
    s_mov_b64 exec, s[52:53]
    ds_write_b128 v58, v[12:15] offset:24576
    ds_write_b128 v58, v[12:15] offset:29952
    ds_write_b128 v58, v[12:15] offset:35328
    ds_write_b128 v58, v[12:15] offset:40704
    s_mov_b64 exec, -1
    s_waitcnt vmcnt(0) lgkmcnt(0)
    s_cmp_eq_u32 s14, 0
    s_cbranch_scc1 Lp2_qeven
    v_mov_b32 v228, 0
    v_mov_b32 v229, 0
    s_branch Lp2_qdone
Lp2_qeven:
    v_mov_b32 v230, 0
    v_mov_b32 v231, 0
Lp2_qdone:
    s_mov_b32 s54, 0
    s_mov_b32 s55, -1
    s_mov_b64 exec, s[54:55]
    v_mov_b32 v228, 0
    v_mov_b32 v229, 0
    v_mov_b32 v230, 0
    v_mov_b32 v231, 0
    s_mov_b64 exec, -1
    s_barrier
    s_cmp_lg_u32 s3, 0
    s_cbranch_scc1 w0_49
    s_cmp_eq_u32 s86, 0
    s_cbranch_scc1 fh_50
    v_mov_b32 v2, 0
    v_mov_b32 v3, s60
    s_mov_b64 s[52:53], exec
    s_mov_b64 exec, 1
    buffer_store_dword v3, v2, s[4:7], s86 offen sc1
    s_mov_b64 exec, s[52:53]
fh_50:
w0_49:
    s_lshl_b32 s86, s13, 5
    s_add_u32 s86, s86, s12
    s_lshl_b32 s86, s86, 4
    s_add_u32 s86, s86, 19951616
    ds_read_b128 v[232:235], v248 offset:0
    ds_read_b128 v[236:239], v249 offset:0
    ds_read_b128 v[240:243], v248 offset:4096
    ds_read_b128 v[244:247], v249 offset:4096
    s_waitcnt lgkmcnt(2)
    s_cmp_lt_i32 s15, 0
    s_cbranch_scc1 qk_51_inv
    v_mfma_f32_32x32x16_bf16 v[64:79], v[232:235], v[224:227], 0
    v_mfma_f32_32x32x16_bf16 v[64:79], v[236:239], v[228:231], v[64:79]
qk_51_ok:
    s_lshr_b32 s55, s19, 4
    s_sub_u32 s55, s55, 16
    s_add_u32 s55, s55, s3
    s_mul_i32 s55, s55, 20480
    s_add_u32 s55, s55, 5308416
    s_mul_i32 s62, s3, 672
    s_mov_b32 s52, 0xffefffff
    s_mov_b32 s53, 0x000001ff
    s_mov_b64 exec, s[52:53]
    s_cmp_eq_u32 s13, 0
    s_cbranch_scc1 Lp2_skipV
    s_add_u32 m0, s62, 24576
    s_add_u32 s54, s55, 0
    buffer_load_dwordx4 v57, s[4:7], s54 offen sc1 lds
    s_add_u32 m0, s62, 29952
    s_add_u32 s54, s55, 163840
    buffer_load_dwordx4 v57, s[4:7], s54 offen sc1 lds
Lp2_skipV:
    s_add_u32 m0, s62, 35328
    s_add_u32 s54, s55, 327680
    buffer_load_dwordx4 v57, s[4:7], s54 offen sc1 lds
    s_add_u32 m0, s62, 40704
    s_add_u32 s54, s55, 491520
    buffer_load_dwordx4 v57, s[4:7], s54 offen sc1 lds
    s_mov_b64 exec, -1
    ds_read_b128 v[232:235], v248 offset:512
    ds_read_b128 v[236:239], v249 offset:512
    s_waitcnt lgkmcnt(2)
    v_mfma_f32_32x32x16_bf16 v[192:207], v[240:243], v[224:227], 0
    v_mfma_f32_32x32x16_bf16 v[192:207], v[244:247], v[228:231], v[192:207]
    ds_read_b128 v[240:243], v248 offset:1024
    ds_read_b128 v[244:247], v249 offset:1024
    s_waitcnt lgkmcnt(2)
    s_cmp_lt_i32 s15, -1
    s_cbranch_scc1 qk_53_inv
    v_mfma_f32_32x32x16_bf16 v[80:95], v[232:235], v[224:227], 0
    v_mfma_f32_32x32x16_bf16 v[80:95], v[236:239], v[228:231], v[80:95]
qk_53_ok:
    ds_read_b128 v[232:235], v248 offset:1536
    ds_read_b128 v[236:239], v249 offset:1536
    s_waitcnt lgkmcnt(2)
    s_cmp_lt_i32 s15, -2
    s_cbranch_scc1 qk_54_inv
    v_mfma_f32_32x32x16_bf16 v[96:111], v[240:243], v[224:227], 0
    v_mfma_f32_32x32x16_bf16 v[96:111], v[244:247], v[228:231], v[96:111]
qk_54_ok:
    s_add_u32 m0, s68, 49152
    s_add_u32 s54, s67, 0
    buffer_load_dwordx4 v56, s[4:7], s54 offen sc1 lds
    s_nop 3
    v_cndmask_b32 v64, v64, v192, s[20:21]
    v_cndmask_b32 v65, v65, v193, s[22:23]
    v_cndmask_b32 v66, v66, v194, s[24:25]
    v_cndmask_b32 v67, v67, v195, s[26:27]
    v_cndmask_b32 v68, v68, v196, s[28:29]
    v_cndmask_b32 v69, v69, v197, s[30:31]
    v_cndmask_b32 v70, v70, v198, s[32:33]
    v_cndmask_b32 v71, v71, v199, s[34:35]
    v_cndmask_b32 v72, v72, v200, s[36:37]
    v_cndmask_b32 v73, v73, v201, s[38:39]
    v_cndmask_b32 v74, v74, v202, s[40:41]
    v_cndmask_b32 v75, v75, v203, s[42:43]
    v_cndmask_b32 v76, v76, v204, s[44:45]
    v_cndmask_b32 v77, v77, v205, s[46:47]
    v_cndmask_b32 v78, v78, v206, s[48:49]
    v_cndmask_b32 v79, v79, v207, s[50:51]
    v_max_f32 v251, v64, v65
    v_max_f32 v252, v66, v67
    v_max3_f32 v251, v251, v68, v69
    v_max3_f32 v252, v252, v70, v71
    v_max3_f32 v251, v251, v72, v73
    v_max3_f32 v252, v252, v74, v75
    v_max3_f32 v251, v251, v76, v77
    v_max3_f32 v252, v252, v78, v79
    ds_read_b128 v[240:243], v248 offset:2048
    ds_read_b128 v[244:247], v249 offset:2048
    s_waitcnt lgkmcnt(2)
    s_cmp_lt_i32 s15, -3
    s_cbranch_scc1 qk_55_inv
    v_mfma_f32_32x32x16_bf16 v[112:127], v[232:235], v[224:227], 0
    v_mfma_f32_32x32x16_bf16 v[112:127], v[236:239], v[228:231], v[112:127]
qk_55_ok:
    s_add_u32 m0, s68, 50176
    s_add_u32 s54, s67, 1024
    buffer_load_dwordx4 v56, s[4:7], s54 offen sc1 lds
    v_max3_f32 v251, v251, v80, v81
    v_max3_f32 v252, v252, v82, v83
    v_max3_f32 v251, v251, v84, v85
    v_max3_f32 v252, v252, v86, v87
    v_max3_f32 v251, v251, v88, v89
    v_max3_f32 v252, v252, v90, v91
    v_max3_f32 v251, v251, v92, v93
    v_max3_f32 v252, v252, v94, v95
    ds_read_b128 v[232:235], v248 offset:2560
    ds_read_b128 v[236:239], v249 offset:2560
    s_waitcnt lgkmcnt(2)
    s_cmp_lt_i32 s15, -4
    s_cbranch_scc1 qk_56_inv
    v_mfma_f32_32x32x16_bf16 v[128:143], v[240:243], v[224:227], 0
    v_mfma_f32_32x32x16_bf16 v[128:143], v[244:247], v[228:231], v[128:143]
qk_56_ok:
    s_add_u32 m0, s68, 51200
    s_add_u32 s54, s67, 2048
    buffer_load_dwordx4 v56, s[4:7], s54 offen sc1 lds
    v_max3_f32 v251, v251, v96, v97
    v_max3_f32 v252, v252, v98, v99
    v_max3_f32 v251, v251, v100, v101
    v_max3_f32 v252, v252, v102, v103
    v_max3_f32 v251, v251, v104, v105
    v_max3_f32 v252, v252, v106, v107
    v_max3_f32 v251, v251, v108, v109
    v_max3_f32 v252, v252, v110, v111
    ds_read_b128 v[240:243], v248 offset:3072
    ds_read_b128 v[244:247], v249 offset:3072
    s_waitcnt lgkmcnt(2)
    s_cmp_lt_i32 s15, -5
    s_cbranch_scc1 qk_57_inv
    v_mfma_f32_32x32x16_bf16 v[144:159], v[232:235], v[224:227], 0
    v_mfma_f32_32x32x16_bf16 v[144:159], v[236:239], v[228:231], v[144:159]
qk_57_ok:
    s_add_u32 m0, s68, 52224
    s_add_u32 s54, s67, 3072
    buffer_load_dwordx4 v56, s[4:7], s54 offen sc1 lds
    v_max3_f32 v251, v251, v112, v113
    v_max3_f32 v252, v252, v114, v115
    v_max3_f32 v251, v251, v116, v117
    v_max3_f32 v252, v252, v118, v119
    v_max3_f32 v251, v251, v120, v121
    v_max3_f32 v252, v252, v122, v123
    v_max3_f32 v251, v251, v124, v125
    v_max3_f32 v252, v252, v126, v127
    ds_read_b128 v[232:235], v248 offset:3584
    ds_read_b128 v[236:239], v249 offset:3584
    s_waitcnt lgkmcnt(2)
    s_cmp_lt_i32 s15, -6
    s_cbranch_scc1 qk_58_inv
    v_mfma_f32_32x32x16_bf16 v[160:175], v[240:243], v[224:227], 0
    v_mfma_f32_32x32x16_bf16 v[160:175], v[244:247], v[228:231], v[160:175]
qk_58_ok:
    s_add_u32 m0, s68, 53248
    s_add_u32 s54, s67, 4096
    buffer_load_dwordx4 v56, s[4:7], s54 offen sc1 lds
    v_max3_f32 v251, v251, v128, v129
    v_max3_f32 v252, v252, v130, v131
    v_max3_f32 v251, v251, v132, v133
    v_max3_f32 v252, v252, v134, v135
    v_max3_f32 v251, v251, v136, v137
    v_max3_f32 v252, v252, v138, v139
    v_max3_f32 v251, v251, v140, v141
    v_max3_f32 v252, v252, v142, v143
    s_waitcnt lgkmcnt(0)
    s_cmp_lt_i32 s15, -7
    s_cbranch_scc1 qk_59_inv
    v_mfma_f32_32x32x16_bf16 v[176:191], v[232:235], v[224:227], 0
    v_mfma_f32_32x32x16_bf16 v[176:191], v[236:239], v[228:231], v[176:191]
qk_59_ok:
    v_max3_f32 v251, v251, v144, v145
    v_max3_f32 v252, v252, v146, v147
    v_max3_f32 v251, v251, v148, v149
    v_max3_f32 v252, v252, v150, v151
    v_max3_f32 v251, v251, v152, v153
    v_max3_f32 v252, v252, v154, v155
    v_max3_f32 v251, v251, v156, v157
    v_max3_f32 v252, v252, v158, v159
    v_max3_f32 v251, v251, v160, v161
    v_max3_f32 v252, v252, v162, v163
    v_max3_f32 v251, v251, v164, v165
    v_max3_f32 v252, v252, v166, v167
    v_max3_f32 v251, v251, v168, v169
    v_max3_f32 v252, v252, v170, v171
    v_max3_f32 v251, v251, v172, v173
    v_max3_f32 v252, v252, v174, v175
    s_nop 3
    v_max3_f32 v251, v251, v176, v177
    v_max3_f32 v252, v252, v178, v179
    v_max3_f32 v251, v251, v180, v181
    v_max3_f32 v252, v252, v182, v183
    v_max3_f32 v251, v251, v184, v185
    v_max3_f32 v252, v252, v186, v187
    v_max3_f32 v251, v251, v188, v189
    v_max3_f32 v252, v252, v190, v191
    v_max_f32 v251, v251, v252
    v_mov_b32 v252, v251
    s_nop 1
    v_permlane32_swap_b32 v251, v252
    s_nop 1
    v_max_f32 v251, v251, v252
    v_and_b32 v252, 0xffff0000, v251
    v_sub_f32 v253, v251, v252
    v_cvt_pk_bf16_f32 v8, -v252, -v253
    s_waitcnt vmcnt(5)
    s_lshr_b32 s54, s64, 2
    s_lshl_b32 s54, s54, 9
    s_add_u32 s54, s54, 19943424
    v_lshlrev_b32 v59, 4, v1
    v_add_u32 v59, s54, v59
    s_and_b32 s54, s3, 3
    s_lshl_b32 s54, s54, 4
    s_add_u32 s54, s54, s66
    v_and_b32 v2, 15, v1
    v_add_u32 v2, s54, v2
    v_lshrrev_b32 v3, 4, v1
    v_lshlrev_b32 v14, 4, v2
    v_lshl_add_u32 v61, v3, 15, v14
    v_lshlrev_b32 v14, 3, v2
    v_lshl_add_u32 v62, v3, 15, v14
    s_barrier
    s_nop 1
    v_mfma_f32_32x32x16_bf16 v[64:79], v[4:7], v[8:11], v[64:79]
    v_mfma_f32_32x32x16_bf16 v[80:95], v[4:7], v[8:11], v[80:95]
    ds_read_b128 v[40:43], v250 offset:10752
    ds_read_b128 v[44:47], v250 offset:11424
    s_nop 7
    s_nop 1
    v_mfma_f32_32x32x16_bf16 v[96:111], v[4:7], v[8:11], v[96:111]
    ds_read_b128 v[48:51], v250 offset:0
    ds_read_b128 v[52:55], v250 offset:672
    v_exp_f32 v64, v64
    v_exp_f32 v65, v65
    v_exp_f32 v66, v66
    v_exp_f32 v67, v67
    s_add_u32 m0, s68, 90112
    s_add_u32 s54, s67, 40960
    buffer_load_dwordx4 v56, s[4:7], s54 offen sc1 lds
    v_exp_f32 v68, v68
    v_exp_f32 v69, v69
    v_exp_f32 v70, v70
    v_exp_f32 v71, v71
    v_exp_f32 v72, v72
    s_add_u32 m0, s68, 91136
    s_add_u32 s54, s67, 41984
    buffer_load_dwordx4 v56, s[4:7], s54 offen sc1 lds
    v_exp_f32 v73, v73
    v_exp_f32 v74, v74
    v_exp_f32 v75, v75
    v_exp_f32 v76, v76
    v_exp_f32 v77, v77
    s_add_u32 m0, s68, 92160
    s_add_u32 s54, s67, 43008
    buffer_load_dwordx4 v56, s[4:7], s54 offen sc1 lds
    v_exp_f32 v78, v78
    v_exp_f32 v79, v79
    v_cvt_pk_bf16_f32 v24, v64, v65
    v_cvt_pk_bf16_f32 v25, v66, v67
    v_cvt_pk_bf16_f32 v26, v68, v69
    v_cvt_pk_bf16_f32 v27, v70, v71
    v_cvt_pk_bf16_f32 v28, v72, v73
    v_cvt_pk_bf16_f32 v29, v74, v75
    v_cvt_pk_bf16_f32 v30, v76, v77
    v_cvt_pk_bf16_f32 v31, v78, v79
    v_and_b32 v32, v24, v16
    v_and_b32 v33, v25, v17
    v_and_b32 v34, v26, v18
    v_and_b32 v35, v27, v19
    v_and_b32 v36, v28, v20
    v_and_b32 v37, v29, v21
    v_and_b32 v38, v30, v22
    v_and_b32 v39, v31, v23
    v_xor_b32 v24, v24, v32
    v_xor_b32 v25, v25, v33
    v_xor_b32 v26, v26, v34
    v_xor_b32 v27, v27, v35
    v_xor_b32 v28, v28, v36
    v_xor_b32 v29, v29, v37
    v_xor_b32 v30, v30, v38
    v_xor_b32 v31, v31, v39
    s_waitcnt lgkmcnt(2)
    v_mfma_f32_32x32x16_bf16 v[208:223], v[40:43], v[32:35], 0
    v_mfma_f32_32x32x16_bf16 v[208:223], v[44:47], v[36:39], v[208:223]
    s_waitcnt lgkmcnt(0)
    s_cmp_lt_i32 s15, 0
    s_cbranch_scc1 pv_60
    v_mfma_f32_32x32x16_bf16 v[208:223], v[48:51], v[24:27], v[208:223]
    v_mfma_f32_32x32x16_bf16 v[208:223], v[52:55], v[28:31], v[208:223]
pv_60:
    ds_read_b128 v[40:43], v250 offset:1344
    ds_read_b128 v[44:47], v250 offset:2016
    v_mfma_f32_32x32x16_bf16 v[112:127], v[4:7], v[8:11], v[112:127]
    v_exp_f32 v80, v80
    v_exp_f32 v81, v81
    v_exp_f32 v82, v82
    v_exp_f32 v83, v83
    s_add_u32 m0, s68, 93184
    s_add_u32 s54, s67, 44032
    buffer_load_dwordx4 v56, s[4:7], s54 offen sc1 lds
    v_exp_f32 v84, v84
    v_exp_f32 v85, v85
    v_exp_f32 v86, v86
    v_exp_f32 v87, v87
    v_exp_f32 v88, v88
    s_add_u32 m0, s68, 94208
    s_add_u32 s54, s67, 45056
    buffer_load_dwordx4 v56, s[4:7], s54 offen sc1 lds
    v_exp_f32 v89, v89
    v_exp_f32 v90, v90
    v_exp_f32 v91, v91
    v_exp_f32 v92, v92
    v_exp_f32 v93, v93
    s_add_u32 m0, s71, 0
    s_add_u32 s54, s67, 81920
    buffer_load_dwordx4 v56, s[4:7], s54 offen sc1 lds
    v_exp_f32 v94, v94
    v_exp_f32 v95, v95
    v_cvt_pk_bf16_f32 v24, v80, v81
    v_cvt_pk_bf16_f32 v25, v82, v83
    v_cvt_pk_bf16_f32 v26, v84, v85
    v_cvt_pk_bf16_f32 v27, v86, v87
    v_cvt_pk_bf16_f32 v28, v88, v89
    v_cvt_pk_bf16_f32 v29, v90, v91
    v_cvt_pk_bf16_f32 v30, v92, v93
    v_cvt_pk_bf16_f32 v31, v94, v95
    s_waitcnt lgkmcnt(0)
    s_cmp_lt_i32 s15, -1
    s_cbranch_scc1 pv_61
    v_mfma_f32_32x32x16_bf16 v[208:223], v[40:43], v[24:27], v[208:223]
    v_mfma_f32_32x32x16_bf16 v[208:223], v[44:47], v[28:31], v[208:223]
pv_61:
    ds_read_b128 v[48:51], v250 offset:2688
    ds_read_b128 v[52:55], v250 offset:3360
    v_mfma_f32_32x32x16_bf16 v[128:143], v[4:7], v[8:11], v[128:143]
    v_exp_f32 v96, v96
    v_exp_f32 v97, v97
    v_exp_f32 v98, v98
    v_exp_f32 v99, v99
    s_add_u32 m0, s71, 1024
    s_add_u32 s54, s67, 82944
    buffer_load_dwordx4 v56, s[4:7], s54 offen sc1 lds
    v_exp_f32 v100, v100
    v_exp_f32 v101, v101
    v_exp_f32 v102, v102
    v_exp_f32 v103, v103
    v_exp_f32 v104, v104
    s_add_u32 m0, s71, 2048
    s_add_u32 s54, s67, 83968
    buffer_load_dwordx4 v56, s[4:7], s54 offen sc1 lds
    v_exp_f32 v105, v105
    v_exp_f32 v106, v106
    v_exp_f32 v107, v107
    v_exp_f32 v108, v108
    v_exp_f32 v109, v109
    s_add_u32 m0, s71, 3072
    s_add_u32 s54, s67, 84992
    buffer_load_dwordx4 v56, s[4:7], s54 offen sc1 lds
    v_exp_f32 v110, v110
    v_exp_f32 v111, v111
    v_cvt_pk_bf16_f32 v24, v96, v97
    v_cvt_pk_bf16_f32 v25, v98, v99
    v_cvt_pk_bf16_f32 v26, v100, v101
    v_cvt_pk_bf16_f32 v27, v102, v103
    v_cvt_pk_bf16_f32 v28, v104, v105
    v_cvt_pk_bf16_f32 v29, v106, v107
    v_cvt_pk_bf16_f32 v30, v108, v109
    v_cvt_pk_bf16_f32 v31, v110, v111
    s_waitcnt lgkmcnt(0)
    s_cmp_lt_i32 s15, -2
    s_cbranch_scc1 pv_62
    v_mfma_f32_32x32x16_bf16 v[208:223], v[48:51], v[24:27], v[208:223]
    v_mfma_f32_32x32x16_bf16 v[208:223], v[52:55], v[28:31], v[208:223]
pv_62:
    ds_read_b128 v[40:43], v250 offset:4032
    ds_read_b128 v[44:47], v250 offset:4704
    s_cmp_lg_u32 s3, 0
    s_cbranch_scc1 w0_63
    buffer_load_dword v60, v59, s[4:7], 0 offen sc1
w0_63:
    v_mfma_f32_32x32x16_bf16 v[144:159], v[4:7], v[8:11], v[144:159]
    v_exp_f32 v112, v112
    v_exp_f32 v113, v113
    v_exp_f32 v114, v114
    v_exp_f32 v115, v115
    s_add_u32 m0, s71, 4096
    s_add_u32 s54, s67, 86016
    buffer_load_dwordx4 v56, s[4:7], s54 offen sc1 lds
    v_exp_f32 v116, v116
    v_exp_f32 v117, v117
    v_exp_f32 v118, v118
    v_exp_f32 v119, v119
    v_exp_f32 v120, v120
    v_exp_f32 v121, v121
    v_exp_f32 v122, v122
    v_exp_f32 v123, v123
    v_exp_f32 v124, v124
    v_exp_f32 v125, v125
    v_exp_f32 v126, v126
    v_exp_f32 v127, v127
    v_cvt_pk_bf16_f32 v24, v112, v113
    v_cvt_pk_bf16_f32 v25, v114, v115
    v_cvt_pk_bf16_f32 v26, v116, v117
    v_cvt_pk_bf16_f32 v27, v118, v119
    v_cvt_pk_bf16_f32 v28, v120, v121
    v_cvt_pk_bf16_f32 v29, v122, v123
    v_cvt_pk_bf16_f32 v30, v124, v125
    v_cvt_pk_bf16_f32 v31, v126, v127
    s_waitcnt lgkmcnt(0)
    s_cmp_lt_i32 s15, -3
    s_cbranch_scc1 pv_64
    v_mfma_f32_32x32x16_bf16 v[208:223], v[40:43], v[24:27], v[208:223]
    v_mfma_f32_32x32x16_bf16 v[208:223], v[44:47], v[28:31], v[208:223]
pv_64:
    ds_read_b128 v[48:51], v250 offset:5376
    ds_read_b128 v[52:55], v250 offset:6048
    v_mfma_f32_32x32x16_bf16 v[160:175], v[4:7], v[8:11], v[160:175]
    v_exp_f32 v128, v128
    v_exp_f32 v129, v129
    v_exp_f32 v130, v130
    v_exp_f32 v131, v131
    v_exp_f32 v132, v132
    v_exp_f32 v133, v133
    v_exp_f32 v134, v134
    v_exp_f32 v135, v135
    v_exp_f32 v136, v136
    v_exp_f32 v137, v137
    v_exp_f32 v138, v138
    v_exp_f32 v139, v139
    v_exp_f32 v140, v140
    v_exp_f32 v141, v141
    v_exp_f32 v142, v142
    v_exp_f32 v143, v143
    v_cvt_pk_bf16_f32 v24, v128, v129
    v_cvt_pk_bf16_f32 v25, v130, v131
    v_cvt_pk_bf16_f32 v26, v132, v133
    v_cvt_pk_bf16_f32 v27, v134, v135
    v_cvt_pk_bf16_f32 v28, v136, v137
    v_cvt_pk_bf16_f32 v29, v138, v139
    v_cvt_pk_bf16_f32 v30, v140, v141
    v_cvt_pk_bf16_f32 v31, v142, v143
    s_waitcnt lgkmcnt(0)
    s_cmp_lt_i32 s15, -4
    s_cbranch_scc1 pv_65
    v_mfma_f32_32x32x16_bf16 v[208:223], v[48:51], v[24:27], v[208:223]
    v_mfma_f32_32x32x16_bf16 v[208:223], v[52:55], v[28:31], v[208:223]
pv_65:
    ds_read_b128 v[40:43], v250 offset:6720
    ds_read_b128 v[44:47], v250 offset:7392
    s_cmp_lg_u32 s3, 0
    s_cbranch_scc1 w0_66
    s_waitcnt vmcnt(0)
    v_cmp_gt_u32 vcc, 24, v1
    s_and_saveexec_b64 s[52:53], vcc
    s_mov_b32 s61, 65536
pf_67_loop:
    v_cmp_ne_u32 vcc, s60, v60
    s_nop 4
    s_cmp_eq_u64 vcc, 0
    s_cbranch_scc1 pf_67_done
    s_sleep 1
    buffer_load_dword v60, v59, s[4:7], 0 offen sc1
    s_waitcnt vmcnt(0)
    s_sub_u32 s61, s61, 1
    s_cmp_lg_u32 s61, 0
    s_cbranch_scc1 pf_67_loop
pf_67_done:
    s_mov_b64 exec, s[52:53]
w0_66:
    s_barrier
    v_mfma_f32_32x32x16_bf16 v[176:191], v[4:7], v[8:11], v[176:191]
    v_exp_f32 v144, v144
    v_exp_f32 v145, v145
    v_exp_f32 v146, v146
    v_exp_f32 v147, v147
    s_add_u32 s54, s69, 7929856
    buffer_load_dwordx4 v[96:99], v61, s[4:7], s54 offen sc1
    v_exp_f32 v148, v148
    v_exp_f32 v149, v149
    v_exp_f32 v150, v150
    v_exp_f32 v151, v151
    v_exp_f32 v152, v152
    s_add_u32 s54, s69, 8192000
    buffer_load_dwordx4 v[100:103], v61, s[4:7], s54 offen sc1
    v_exp_f32 v153, v153
    v_exp_f32 v154, v154
    v_exp_f32 v155, v155
    v_exp_f32 v156, v156
    v_exp_f32 v157, v157
    s_add_u32 s54, s69, 8454144
    buffer_load_dwordx4 v[104:107], v61, s[4:7], s54 offen sc1
    v_exp_f32 v158, v158
    v_exp_f32 v159, v159
    v_cvt_pk_bf16_f32 v24, v144, v145
    v_cvt_pk_bf16_f32 v25, v146, v147
    v_cvt_pk_bf16_f32 v26, v148, v149
    v_cvt_pk_bf16_f32 v27, v150, v151
    v_cvt_pk_bf16_f32 v28, v152, v153
    v_cvt_pk_bf16_f32 v29, v154, v155
    v_cvt_pk_bf16_f32 v30, v156, v157
    v_cvt_pk_bf16_f32 v31, v158, v159
    s_waitcnt lgkmcnt(0)
    s_cmp_lt_i32 s15, -5
    s_cbranch_scc1 pv_68
    v_mfma_f32_32x32x16_bf16 v[208:223], v[40:43], v[24:27], v[208:223]
    v_mfma_f32_32x32x16_bf16 v[208:223], v[44:47], v[28:31], v[208:223]
pv_68:
    ds_read_b128 v[48:51], v250 offset:8064
    ds_read_b128 v[52:55], v250 offset:8736
    v_exp_f32 v160, v160
    v_exp_f32 v161, v161
    v_exp_f32 v162, v162
    v_exp_f32 v163, v163
    s_add_u32 s54, s69, 8716288
    buffer_load_dwordx4 v[108:111], v61, s[4:7], s54 offen sc1
    v_exp_f32 v164, v164
    v_exp_f32 v165, v165
    v_exp_f32 v166, v166
    v_exp_f32 v167, v167
    v_exp_f32 v168, v168
    s_add_u32 s54, s69, 8978432
    buffer_load_dwordx4 v[112:115], v61, s[4:7], s54 offen sc1
    v_exp_f32 v169, v169
    v_exp_f32 v170, v170
    v_exp_f32 v171, v171
    v_exp_f32 v172, v172
    v_exp_f32 v173, v173
    s_add_u32 s54, s69, 9240576
    buffer_load_dwordx4 v[116:119], v61, s[4:7], s54 offen sc1
    v_exp_f32 v174, v174
    v_exp_f32 v175, v175
    v_cvt_pk_bf16_f32 v24, v160, v161
    v_cvt_pk_bf16_f32 v25, v162, v163
    v_cvt_pk_bf16_f32 v26, v164, v165
    v_cvt_pk_bf16_f32 v27, v166, v167
    v_cvt_pk_bf16_f32 v28, v168, v169
    v_cvt_pk_bf16_f32 v29, v170, v171
    v_cvt_pk_bf16_f32 v30, v172, v173
    v_cvt_pk_bf16_f32 v31, v174, v175
    s_waitcnt lgkmcnt(0)
    s_cmp_lt_i32 s15, -6
    s_cbranch_scc1 pv_69
    v_mfma_f32_32x32x16_bf16 v[208:223], v[48:51], v[24:27], v[208:223]
    v_mfma_f32_32x32x16_bf16 v[208:223], v[52:55], v[28:31], v[208:223]
pv_69:
    ds_read_b128 v[40:43], v250 offset:9408
    ds_read_b128 v[44:47], v250 offset:10080
    v_exp_f32 v176, v176
    v_exp_f32 v177, v177
    v_exp_f32 v178, v178
    v_exp_f32 v179, v179
    s_add_u32 s54, s69, 9502720
    buffer_load_dwordx4 v[120:123], v61, s[4:7], s54 offen sc1
    v_exp_f32 v180, v180
    v_exp_f32 v181, v181
    v_exp_f32 v182, v182
    v_exp_f32 v183, v183
    v_exp_f32 v184, v184
    s_add_u32 s54, s69, 9764864
    buffer_load_dwordx4 v[124:127], v61, s[4:7], s54 offen sc1
    v_exp_f32 v185, v185
    v_exp_f32 v186, v186
    v_exp_f32 v187, v187
    v_exp_f32 v188, v188
    v_exp_f32 v189, v189
    v_exp_f32 v190, v190
    v_exp_f32 v191, v191
    v_cvt_pk_bf16_f32 v24, v176, v177
    v_cvt_pk_bf16_f32 v25, v178, v179
    v_cvt_pk_bf16_f32 v26, v180, v181
    v_cvt_pk_bf16_f32 v27, v182, v183
    v_cvt_pk_bf16_f32 v28, v184, v185
    v_cvt_pk_bf16_f32 v29, v186, v187
    v_cvt_pk_bf16_f32 v30, v188, v189
    v_cvt_pk_bf16_f32 v31, v190, v191
    s_waitcnt lgkmcnt(0)
    s_cmp_lt_i32 s15, -7
    s_cbranch_scc1 pv_70
    v_mfma_f32_32x32x16_bf16 v[208:223], v[40:43], v[24:27], v[208:223]
    v_mfma_f32_32x32x16_bf16 v[208:223], v[44:47], v[28:31], v[208:223]
pv_70:
    s_nop 7
    s_nop 7
    v_mov_b32 v252, v216
    v_mov_b32 v253, v216
    s_nop 1
    v_permlane32_swap_b32 v252, v253
    s_nop 1
    v_rcp_f32 v253, v253
    s_nop 0
    v_mul_f32 v208, v208, v253
    v_mul_f32 v209, v209, v253
    v_mul_f32 v210, v210, v253
    v_mul_f32 v211, v211, v253
    v_mul_f32 v212, v212, v253
    v_mul_f32 v213, v213, v253
    v_mul_f32 v214, v214, v253
    v_mul_f32 v215, v215, v253
    v_mul_f32 v216, v216, v253
    v_mul_f32 v217, v217, v253
    v_mul_f32 v218, v218, v253
    v_mul_f32 v219, v219, v253
    v_cvt_pk_bf16_f32 v24, v208, v209
    v_cvt_pk_bf16_f32 v25, v210, v211
    v_cvt_pk_bf16_f32 v26, v212, v213
    v_cvt_pk_bf16_f32 v27, v214, v215
    v_cvt_pk_bf16_f32 v28, v216, v217
    v_cvt_pk_bf16_f32 v29, v218, v219
    s_lshl_b32 s54, s12, 16
    s_add_u32 s54, s54, 14221312
    buffer_store_dwordx4 v[24:27], v254, s[4:7], s54 offen sc1
    v_lshrrev_b32 v12, 1, v255
    s_lshl_b32 s54, s12, 14
    s_add_u32 s54, s54, 16318464
    s_mov_b32 s52, -1
    s_mov_b32 s53, 0
    s_mov_b64 exec, s[52:53]
    buffer_store_dwordx2 v[28:29], v12, s[4:7], s54 offen sc1
    s_mov_b64 exec, -1
    s_branch oolend_71
qk_51_inv:
    v_mov_b32 v64, 0xf149f2ca
    v_mov_b32 v65, 0xf149f2ca
    v_mov_b32 v66, 0xf149f2ca
    v_mov_b32 v67, 0xf149f2ca
    v_mov_b32 v68, 0xf149f2ca
    v_mov_b32 v69, 0xf149f2ca
    v_mov_b32 v70, 0xf149f2ca
    v_mov_b32 v71, 0xf149f2ca
    v_mov_b32 v72, 0xf149f2ca
    v_mov_b32 v73, 0xf149f2ca
    v_mov_b32 v74, 0xf149f2ca
    v_mov_b32 v75, 0xf149f2ca
    v_mov_b32 v76, 0xf149f2ca
    v_mov_b32 v77, 0xf149f2ca
    v_mov_b32 v78, 0xf149f2ca
    v_mov_b32 v79, 0xf149f2ca
    s_branch qk_51_ok
qk_53_inv:
    v_mov_b32 v80, 0xf149f2ca
    v_mov_b32 v81, 0xf149f2ca
    v_mov_b32 v82, 0xf149f2ca
    v_mov_b32 v83, 0xf149f2ca
    v_mov_b32 v84, 0xf149f2ca
    v_mov_b32 v85, 0xf149f2ca
    v_mov_b32 v86, 0xf149f2ca
    v_mov_b32 v87, 0xf149f2ca
    v_mov_b32 v88, 0xf149f2ca
    v_mov_b32 v89, 0xf149f2ca
    v_mov_b32 v90, 0xf149f2ca
    v_mov_b32 v91, 0xf149f2ca
    v_mov_b32 v92, 0xf149f2ca
    v_mov_b32 v93, 0xf149f2ca
    v_mov_b32 v94, 0xf149f2ca
    v_mov_b32 v95, 0xf149f2ca
    s_branch qk_53_ok
qk_54_inv:
    v_mov_b32 v96, 0xf149f2ca
    v_mov_b32 v97, 0xf149f2ca
    v_mov_b32 v98, 0xf149f2ca
    v_mov_b32 v99, 0xf149f2ca
    v_mov_b32 v100, 0xf149f2ca
    v_mov_b32 v101, 0xf149f2ca
    v_mov_b32 v102, 0xf149f2ca
    v_mov_b32 v103, 0xf149f2ca
    v_mov_b32 v104, 0xf149f2ca
    v_mov_b32 v105, 0xf149f2ca
    v_mov_b32 v106, 0xf149f2ca
    v_mov_b32 v107, 0xf149f2ca
    v_mov_b32 v108, 0xf149f2ca
    v_mov_b32 v109, 0xf149f2ca
    v_mov_b32 v110, 0xf149f2ca
    v_mov_b32 v111, 0xf149f2ca
    s_branch qk_54_ok
qk_55_inv:
    v_mov_b32 v112, 0xf149f2ca
    v_mov_b32 v113, 0xf149f2ca
    v_mov_b32 v114, 0xf149f2ca
    v_mov_b32 v115, 0xf149f2ca
    v_mov_b32 v116, 0xf149f2ca
    v_mov_b32 v117, 0xf149f2ca
    v_mov_b32 v118, 0xf149f2ca
    v_mov_b32 v119, 0xf149f2ca
    v_mov_b32 v120, 0xf149f2ca
    v_mov_b32 v121, 0xf149f2ca
    v_mov_b32 v122, 0xf149f2ca
    v_mov_b32 v123, 0xf149f2ca
    v_mov_b32 v124, 0xf149f2ca
    v_mov_b32 v125, 0xf149f2ca
    v_mov_b32 v126, 0xf149f2ca
    v_mov_b32 v127, 0xf149f2ca
    s_branch qk_55_ok
qk_56_inv:
    v_mov_b32 v128, 0xf149f2ca
    v_mov_b32 v129, 0xf149f2ca
    v_mov_b32 v130, 0xf149f2ca
    v_mov_b32 v131, 0xf149f2ca
    v_mov_b32 v132, 0xf149f2ca
    v_mov_b32 v133, 0xf149f2ca
    v_mov_b32 v134, 0xf149f2ca
    v_mov_b32 v135, 0xf149f2ca
    v_mov_b32 v136, 0xf149f2ca
    v_mov_b32 v137, 0xf149f2ca
    v_mov_b32 v138, 0xf149f2ca
    v_mov_b32 v139, 0xf149f2ca
    v_mov_b32 v140, 0xf149f2ca
    v_mov_b32 v141, 0xf149f2ca
    v_mov_b32 v142, 0xf149f2ca
    v_mov_b32 v143, 0xf149f2ca
    s_branch qk_56_ok
qk_57_inv:
    v_mov_b32 v144, 0xf149f2ca
    v_mov_b32 v145, 0xf149f2ca
    v_mov_b32 v146, 0xf149f2ca
    v_mov_b32 v147, 0xf149f2ca
    v_mov_b32 v148, 0xf149f2ca
    v_mov_b32 v149, 0xf149f2ca
    v_mov_b32 v150, 0xf149f2ca
    v_mov_b32 v151, 0xf149f2ca
    v_mov_b32 v152, 0xf149f2ca
    v_mov_b32 v153, 0xf149f2ca
    v_mov_b32 v154, 0xf149f2ca
    v_mov_b32 v155, 0xf149f2ca
    v_mov_b32 v156, 0xf149f2ca
    v_mov_b32 v157, 0xf149f2ca
    v_mov_b32 v158, 0xf149f2ca
    v_mov_b32 v159, 0xf149f2ca
    s_branch qk_57_ok
qk_58_inv:
    v_mov_b32 v160, 0xf149f2ca
    v_mov_b32 v161, 0xf149f2ca
    v_mov_b32 v162, 0xf149f2ca
    v_mov_b32 v163, 0xf149f2ca
    v_mov_b32 v164, 0xf149f2ca
    v_mov_b32 v165, 0xf149f2ca
    v_mov_b32 v166, 0xf149f2ca
    v_mov_b32 v167, 0xf149f2ca
    v_mov_b32 v168, 0xf149f2ca
    v_mov_b32 v169, 0xf149f2ca
    v_mov_b32 v170, 0xf149f2ca
    v_mov_b32 v171, 0xf149f2ca
    v_mov_b32 v172, 0xf149f2ca
    v_mov_b32 v173, 0xf149f2ca
    v_mov_b32 v174, 0xf149f2ca
    v_mov_b32 v175, 0xf149f2ca
    s_branch qk_58_ok
qk_59_inv:
    v_mov_b32 v176, 0xf149f2ca
    v_mov_b32 v177, 0xf149f2ca
    v_mov_b32 v178, 0xf149f2ca
    v_mov_b32 v179, 0xf149f2ca
    v_mov_b32 v180, 0xf149f2ca
    v_mov_b32 v181, 0xf149f2ca
    v_mov_b32 v182, 0xf149f2ca
    v_mov_b32 v183, 0xf149f2ca
    v_mov_b32 v184, 0xf149f2ca
    v_mov_b32 v185, 0xf149f2ca
    v_mov_b32 v186, 0xf149f2ca
    v_mov_b32 v187, 0xf149f2ca
    v_mov_b32 v188, 0xf149f2ca
    v_mov_b32 v189, 0xf149f2ca
    v_mov_b32 v190, 0xf149f2ca
    v_mov_b32 v191, 0xf149f2ca
    s_branch qk_59_ok
oolend_71:
    v_lshlrev_b32 v56, 4, v1
    s_lshr_b32 s54, s3, 2
    s_mul_i32 s54, s54, 5120
    v_add_u32 v12, s54, v56
    v_add_u32 v13, 65536, v12
    v_add_u32 v14, 131072, v12
    v_mov_b32 v64, 0
    v_mov_b32 v65, 0
    v_mov_b32 v66, 0
    v_mov_b32 v67, 0
    v_mov_b32 v68, 0
    v_mov_b32 v69, 0
    v_mov_b32 v70, 0
    v_mov_b32 v71, 0
    v_mov_b32 v72, 0
    v_mov_b32 v73, 0
    v_mov_b32 v74, 0
    v_mov_b32 v75, 0
    v_mov_b32 v76, 0
    v_mov_b32 v77, 0
    v_mov_b32 v78, 0
    v_mov_b32 v79, 0
    v_mov_b32 v80, 0
    v_mov_b32 v81, 0
    v_mov_b32 v82, 0
    v_mov_b32 v83, 0
    s_waitcnt vmcnt(6)
    s_barrier
    ds_read_b128 v[144:147], v12 offset:49152
    ds_read_b128 v[148:151], v12 offset:50176
    ds_read_b128 v[152:155], v12 offset:51200
    ds_read_b128 v[156:159], v12 offset:52224
    ds_read_b128 v[160:163], v12 offset:53248
    ds_read_b128 v[164:167], v12 offset:59392
    ds_read_b128 v[168:171], v12 offset:60416
    ds_read_b128 v[172:175], v12 offset:61440
    ds_read_b128 v[176:179], v12 offset:62464
    ds_read_b128 v[180:183], v12 offset:63488
    s_waitcnt lgkmcnt(5)
    v_mfma_f32_16x16x32_bf16 v[64:67], v[144:147], v[96:99], v[64:67]
    v_mfma_f32_16x16x32_bf16 v[68:71], v[148:151], v[96:99], v[68:71]
    v_mfma_f32_16x16x32_bf16 v[72:75], v[152:155], v[96:99], v[72:75]
    v_mfma_f32_16x16x32_bf16 v[76:79], v[156:159], v[96:99], v[76:79]
    v_mfma_f32_16x16x32_bf16 v[80:83], v[160:163], v[96:99], v[80:83]
    s_add_u32 s54, s69, 10027008
    buffer_load_dwordx4 v[96:99], v61, s[4:7], s54 offen sc1
    ds_read_b128 v[144:147], v13 offset:4096
    ds_read_b128 v[148:151], v13 offset:5120
    ds_read_b128 v[152:155], v13 offset:6144
    ds_read_b128 v[156:159], v13 offset:7168
    ds_read_b128 v[160:163], v13 offset:8192
    s_waitcnt lgkmcnt(5)
    v_mfma_f32_16x16x32_bf16 v[64:67], v[164:167], v[100:103], v[64:67]
    v_mfma_f32_16x16x32_bf16 v[68:71], v[168:171], v[100:103], v[68:71]
    v_mfma_f32_16x16x32_bf16 v[72:75], v[172:175], v[100:103], v[72:75]
    v_mfma_f32_16x16x32_bf16 v[76:79], v[176:179], v[100:103], v[76:79]
    v_mfma_f32_16x16x32_bf16 v[80:83], v[180:183], v[100:103], v[80:83]
    s_add_u32 s54, s69, 10289152
    buffer_load_dwordx4 v[100:103], v61, s[4:7], s54 offen sc1
    ds_read_b128 v[164:167], v13 offset:14336
    ds_read_b128 v[168:171], v13 offset:15360
    ds_read_b128 v[172:175], v13 offset:16384
    ds_read_b128 v[176:179], v13 offset:17408
    ds_read_b128 v[180:183], v13 offset:18432
    s_waitcnt lgkmcnt(5)
    v_mfma_f32_16x16x32_bf16 v[64:67], v[144:147], v[104:107], v[64:67]
    v_mfma_f32_16x16x32_bf16 v[68:71], v[148:151], v[104:107], v[68:71]
    v_mfma_f32_16x16x32_bf16 v[72:75], v[152:155], v[104:107], v[72:75]
    v_mfma_f32_16x16x32_bf16 v[76:79], v[156:159], v[104:107], v[76:79]
    v_mfma_f32_16x16x32_bf16 v[80:83], v[160:163], v[104:107], v[80:83]
    s_add_u32 s54, s69, 10551296
    buffer_load_dwordx4 v[104:107], v61, s[4:7], s54 offen sc1
    s_waitcnt lgkmcnt(0)
    v_mfma_f32_16x16x32_bf16 v[64:67], v[164:167], v[108:111], v[64:67]
    v_mfma_f32_16x16x32_bf16 v[68:71], v[168:171], v[108:111], v[68:71]
    v_mfma_f32_16x16x32_bf16 v[72:75], v[172:175], v[108:111], v[72:75]
    v_mfma_f32_16x16x32_bf16 v[76:79], v[176:179], v[108:111], v[76:79]
    v_mfma_f32_16x16x32_bf16 v[80:83], v[180:183], v[108:111], v[80:83]
    s_add_u32 s54, s69, 10813440
    buffer_load_dwordx4 v[108:111], v61, s[4:7], s54 offen sc1
    s_waitcnt vmcnt(4)
    s_barrier
    s_cmp_lg_u32 s3, 0
    s_cbranch_scc1 w0_72
    v_mov_b32 v2, 0
    v_mov_b32 v3, s60
    s_mov_b64 s[52:53], exec
    s_mov_b64 exec, 1
    buffer_store_dword v3, v2, s[4:7], s86 offen sc1
    s_mov_b64 exec, s[52:53]
w0_72:
    ds_read_b128 v[144:147], v13 offset:24576
    ds_read_b128 v[148:151], v13 offset:25600
    ds_read_b128 v[152:155], v13 offset:26624
    ds_read_b128 v[156:159], v13 offset:27648
    ds_read_b128 v[160:163], v13 offset:28672
    ds_read_b128 v[164:167], v13 offset:34816
    ds_read_b128 v[168:171], v13 offset:35840
    ds_read_b128 v[172:175], v13 offset:36864
    ds_read_b128 v[176:179], v13 offset:37888
    ds_read_b128 v[180:183], v13 offset:38912
    s_add_u32 m0, s68, 49152
    s_add_u32 s54, s67, 122880
    buffer_load_dwordx4 v56, s[4:7], s54 offen sc1 lds
    s_add_u32 m0, s68, 50176
    s_add_u32 s54, s67, 123904
    buffer_load_dwordx4 v56, s[4:7], s54 offen sc1 lds
    s_add_u32 m0, s68, 51200
    s_add_u32 s54, s67, 124928
    buffer_load_dwordx4 v56, s[4:7], s54 offen sc1 lds
    s_add_u32 m0, s68, 52224
    s_add_u32 s54, s67, 125952
    buffer_load_dwordx4 v56, s[4:7], s54 offen sc1 lds
    s_add_u32 m0, s68, 53248
    s_add_u32 s54, s67, 126976
    buffer_load_dwordx4 v56, s[4:7], s54 offen sc1 lds
    s_waitcnt lgkmcnt(5)
    v_mfma_f32_16x16x32_bf16 v[64:67], v[144:147], v[112:115], v[64:67]
    v_mfma_f32_16x16x32_bf16 v[68:71], v[148:151], v[112:115], v[68:71]
    v_mfma_f32_16x16x32_bf16 v[72:75], v[152:155], v[112:115], v[72:75]
    v_mfma_f32_16x16x32_bf16 v[76:79], v[156:159], v[112:115], v[76:79]
    v_mfma_f32_16x16x32_bf16 v[80:83], v[160:163], v[112:115], v[80:83]
    s_add_u32 s54, s69, 11075584
    buffer_load_dwordx4 v[112:115], v61, s[4:7], s54 offen sc1
    ds_read_b128 v[144:147], v13 offset:45056
    ds_read_b128 v[148:151], v13 offset:46080
    ds_read_b128 v[152:155], v13 offset:47104
    ds_read_b128 v[156:159], v13 offset:48128
    ds_read_b128 v[160:163], v13 offset:49152
    s_waitcnt lgkmcnt(5)
    v_mfma_f32_16x16x32_bf16 v[64:67], v[164:167], v[116:119], v[64:67]
    v_mfma_f32_16x16x32_bf16 v[68:71], v[168:171], v[116:119], v[68:71]
    v_mfma_f32_16x16x32_bf16 v[72:75], v[172:175], v[116:119], v[72:75]
    v_mfma_f32_16x16x32_bf16 v[76:79], v[176:179], v[116:119], v[76:79]
    v_mfma_f32_16x16x32_bf16 v[80:83], v[180:183], v[116:119], v[80:83]
    s_add_u32 s54, s69, 11337728
    buffer_load_dwordx4 v[116:119], v61, s[4:7], s54 offen sc1
    ds_read_b128 v[164:167], v13 offset:55296
    ds_read_b128 v[168:171], v13 offset:56320
    ds_read_b128 v[172:175], v13 offset:57344
    ds_read_b128 v[176:179], v13 offset:58368
    ds_read_b128 v[180:183], v13 offset:59392
    s_waitcnt lgkmcnt(5)
    v_mfma_f32_16x16x32_bf16 v[64:67], v[144:147], v[120:123], v[64:67]
    v_mfma_f32_16x16x32_bf16 v[68:71], v[148:151], v[120:123], v[68:71]
    v_mfma_f32_16x16x32_bf16 v[72:75], v[152:155], v[120:123], v[72:75]
    v_mfma_f32_16x16x32_bf16 v[76:79], v[156:159], v[120:123], v[76:79]
    v_mfma_f32_16x16x32_bf16 v[80:83], v[160:163], v[120:123], v[80:83]
    s_add_u32 s54, s69, 11599872
    buffer_load_dwordx4 v[120:123], v61, s[4:7], s54 offen sc1
    s_waitcnt lgkmcnt(0)
    v_mfma_f32_16x16x32_bf16 v[64:67], v[164:167], v[124:127], v[64:67]
    v_mfma_f32_16x16x32_bf16 v[68:71], v[168:171], v[124:127], v[68:71]
    v_mfma_f32_16x16x32_bf16 v[72:75], v[172:175], v[124:127], v[72:75]
    v_mfma_f32_16x16x32_bf16 v[76:79], v[176:179], v[124:127], v[76:79]
    v_mfma_f32_16x16x32_bf16 v[80:83], v[180:183], v[124:127], v[80:83]
    s_add_u32 s54, s69, 11862016
    buffer_load_dwordx4 v[124:127], v61, s[4:7], s54 offen sc1
    s_waitcnt vmcnt(9)
    s_barrier
    ds_read_b128 v[144:147], v12 offset:0
    ds_read_b128 v[148:151], v12 offset:1024
    ds_read_b128 v[152:155], v12 offset:2048
    ds_read_b128 v[156:159], v12 offset:3072
    ds_read_b128 v[160:163], v12 offset:4096
    ds_read_b128 v[164:167], v12 offset:10240
    ds_read_b128 v[168:171], v12 offset:11264
    ds_read_b128 v[172:175], v12 offset:12288
    ds_read_b128 v[176:179], v12 offset:13312
    ds_read_b128 v[180:183], v12 offset:14336
    s_add_u32 m0, s68, 90112
    s_add_u32 s54, s67, 163840
    buffer_load_dwordx4 v56, s[4:7], s54 offen sc1 lds
    s_add_u32 m0, s68, 91136
    s_add_u32 s54, s67, 164864
    buffer_load_dwordx4 v56, s[4:7], s54 offen sc1 lds
    s_add_u32 m0, s68, 92160
    s_add_u32 s54, s67, 165888
    buffer_load_dwordx4 v56, s[4:7], s54 offen sc1 lds
    s_add_u32 m0, s68, 93184
    s_add_u32 s54, s67, 166912
    buffer_load_dwordx4 v56, s[4:7], s54 offen sc1 lds
    s_add_u32 m0, s68, 94208
    s_add_u32 s54, s67, 167936
    buffer_load_dwordx4 v56, s[4:7], s54 offen sc1 lds
    s_waitcnt lgkmcnt(5)
    v_mfma_f32_16x16x32_bf16 v[64:67], v[144:147], v[96:99], v[64:67]
    v_mfma_f32_16x16x32_bf16 v[68:71], v[148:151], v[96:99], v[68:71]
    v_mfma_f32_16x16x32_bf16 v[72:75], v[152:155], v[96:99], v[72:75]
    v_mfma_f32_16x16x32_bf16 v[76:79], v[156:159], v[96:99], v[76:79]
    v_mfma_f32_16x16x32_bf16 v[80:83], v[160:163], v[96:99], v[80:83]
    s_add_u32 s54, s69, 12124160
    buffer_load_dwordx4 v[96:99], v61, s[4:7], s54 offen sc1
    ds_read_b128 v[144:147], v14 offset:11264
    ds_read_b128 v[148:151], v14 offset:12288
    ds_read_b128 v[152:155], v14 offset:13312
    ds_read_b128 v[156:159], v14 offset:14336
    ds_read_b128 v[160:163], v14 offset:15360
    s_waitcnt lgkmcnt(5)
    v_mfma_f32_16x16x32_bf16 v[64:67], v[164:167], v[100:103], v[64:67]
    v_mfma_f32_16x16x32_bf16 v[68:71], v[168:171], v[100:103], v[68:71]
    v_mfma_f32_16x16x32_bf16 v[72:75], v[172:175], v[100:103], v[72:75]
    v_mfma_f32_16x16x32_bf16 v[76:79], v[176:179], v[100:103], v[76:79]
    v_mfma_f32_16x16x32_bf16 v[80:83], v[180:183], v[100:103], v[80:83]
    s_add_u32 s54, s69, 12386304
    buffer_load_dwordx4 v[100:103], v61, s[4:7], s54 offen sc1
    ds_read_b128 v[164:167], v14 offset:21504
    ds_read_b128 v[168:171], v14 offset:22528
    ds_read_b128 v[172:175], v14 offset:23552
    ds_read_b128 v[176:179], v14 offset:24576
    ds_read_b128 v[180:183], v14 offset:25600
    s_waitcnt lgkmcnt(5)
    v_mfma_f32_16x16x32_bf16 v[64:67], v[144:147], v[104:107], v[64:67]
    v_mfma_f32_16x16x32_bf16 v[68:71], v[148:151], v[104:107], v[68:71]
    v_mfma_f32_16x16x32_bf16 v[72:75], v[152:155], v[104:107], v[72:75]
    v_mfma_f32_16x16x32_bf16 v[76:79], v[156:159], v[104:107], v[76:79]
    v_mfma_f32_16x16x32_bf16 v[80:83], v[160:163], v[104:107], v[80:83]
    s_add_u32 s54, s69, 12648448
    buffer_load_dwordx4 v[104:107], v61, s[4:7], s54 offen sc1
    s_waitcnt lgkmcnt(0)
    v_mfma_f32_16x16x32_bf16 v[64:67], v[164:167], v[108:111], v[64:67]
    v_mfma_f32_16x16x32_bf16 v[68:71], v[168:171], v[108:111], v[68:71]
    v_mfma_f32_16x16x32_bf16 v[72:75], v[172:175], v[108:111], v[72:75]
    v_mfma_f32_16x16x32_bf16 v[76:79], v[176:179], v[108:111], v[76:79]
    v_mfma_f32_16x16x32_bf16 v[80:83], v[180:183], v[108:111], v[80:83]
    s_add_u32 s54, s69, 12910592
    buffer_load_dwordx4 v[108:111], v61, s[4:7], s54 offen sc1
    s_waitcnt vmcnt(9)
    s_barrier
    s_lshr_b32 s54, s64, 2
    s_lshl_b32 s54, s54, 9
    s_add_u32 s54, s54, 19951616
    v_lshlrev_b32 v59, 4, v1
    v_add_u32 v59, s54, v59
    s_cmp_lg_u32 s3, 0
    s_cbranch_scc1 w0_73
    buffer_load_dword v60, v59, s[4:7], 0 offen sc1
w0_73:
    ds_read_b128 v[144:147], v12 offset:49152
    ds_read_b128 v[148:151], v12 offset:50176
    ds_read_b128 v[152:155], v12 offset:51200
    ds_read_b128 v[156:159], v12 offset:52224
    ds_read_b128 v[160:163], v12 offset:53248
    ds_read_b128 v[164:167], v12 offset:59392
    ds_read_b128 v[168:171], v12 offset:60416
    ds_read_b128 v[172:175], v12 offset:61440
    ds_read_b128 v[176:179], v12 offset:62464
    ds_read_b128 v[180:183], v12 offset:63488
    s_add_u32 m0, s68, 0
    s_add_u32 s54, s67, 204800
    buffer_load_dwordx4 v56, s[4:7], s54 offen sc1 lds
    s_add_u32 m0, s68, 1024
    s_add_u32 s54, s67, 205824
    buffer_load_dwordx4 v56, s[4:7], s54 offen sc1 lds
    s_add_u32 m0, s68, 2048
    s_add_u32 s54, s67, 206848
    buffer_load_dwordx4 v56, s[4:7], s54 offen sc1 lds
    s_add_u32 m0, s68, 3072
    s_add_u32 s54, s67, 207872
    buffer_load_dwordx4 v56, s[4:7], s54 offen sc1 lds
    s_add_u32 m0, s68, 4096
    s_add_u32 s54, s67, 208896
    buffer_load_dwordx4 v56, s[4:7], s54 offen sc1 lds
    s_waitcnt lgkmcnt(5)
    v_mfma_f32_16x16x32_bf16 v[64:67], v[144:147], v[112:115], v[64:67]
    v_mfma_f32_16x16x32_bf16 v[68:71], v[148:151], v[112:115], v[68:71]
    v_mfma_f32_16x16x32_bf16 v[72:75], v[152:155], v[112:115], v[72:75]
    v_mfma_f32_16x16x32_bf16 v[76:79], v[156:159], v[112:115], v[76:79]
    v_mfma_f32_16x16x32_bf16 v[80:83], v[160:163], v[112:115], v[80:83]
    s_add_u32 s54, s69, 13172736
    buffer_load_dwordx4 v[112:115], v61, s[4:7], s54 offen sc1
    ds_read_b128 v[144:147], v13 offset:4096
    ds_read_b128 v[148:151], v13 offset:5120
    ds_read_b128 v[152:155], v13 offset:6144
    ds_read_b128 v[156:159], v13 offset:7168
    ds_read_b128 v[160:163], v13 offset:8192
    s_waitcnt lgkmcnt(5)
    v_mfma_f32_16x16x32_bf16 v[64:67], v[164:167], v[116:119], v[64:67]
    v_mfma_f32_16x16x32_bf16 v[68:71], v[168:171], v[116:119], v[68:71]
    v_mfma_f32_16x16x32_bf16 v[72:75], v[172:175], v[116:119], v[72:75]
    v_mfma_f32_16x16x32_bf16 v[76:79], v[176:179], v[116:119], v[76:79]
    v_mfma_f32_16x16x32_bf16 v[80:83], v[180:183], v[116:119], v[80:83]
    s_add_u32 s54, s69, 13434880
    buffer_load_dwordx4 v[116:119], v61, s[4:7], s54 offen sc1
    ds_read_b128 v[164:167], v13 offset:14336
    ds_read_b128 v[168:171], v13 offset:15360
    ds_read_b128 v[172:175], v13 offset:16384
    ds_read_b128 v[176:179], v13 offset:17408
    ds_read_b128 v[180:183], v13 offset:18432
    s_waitcnt lgkmcnt(5)
    v_mfma_f32_16x16x32_bf16 v[64:67], v[144:147], v[120:123], v[64:67]
    v_mfma_f32_16x16x32_bf16 v[68:71], v[148:151], v[120:123], v[68:71]
    v_mfma_f32_16x16x32_bf16 v[72:75], v[152:155], v[120:123], v[72:75]
    v_mfma_f32_16x16x32_bf16 v[76:79], v[156:159], v[120:123], v[76:79]
    v_mfma_f32_16x16x32_bf16 v[80:83], v[160:163], v[120:123], v[80:83]
    s_add_u32 s54, s69, 13697024
    buffer_load_dwordx4 v[120:123], v61, s[4:7], s54 offen sc1
    s_waitcnt lgkmcnt(0)
    v_mfma_f32_16x16x32_bf16 v[64:67], v[164:167], v[124:127], v[64:67]
    v_mfma_f32_16x16x32_bf16 v[68:71], v[168:171], v[124:127], v[68:71]
    v_mfma_f32_16x16x32_bf16 v[72:75], v[172:175], v[124:127], v[72:75]
    v_mfma_f32_16x16x32_bf16 v[76:79], v[176:179], v[124:127], v[76:79]
    v_mfma_f32_16x16x32_bf16 v[80:83], v[180:183], v[124:127], v[80:83]
    s_add_u32 s54, s69, 13959168
    buffer_load_dwordx4 v[124:127], v61, s[4:7], s54 offen sc1
    s_waitcnt vmcnt(9)
    s_barrier
    s_cmp_lg_u32 s3, 0
    s_cbranch_scc1 w0_74
    v_cmp_gt_u32 vcc, 32, v1
    s_and_saveexec_b64 s[52:53], vcc
    s_mov_b32 s61, 65536
pf_75_loop:
    v_cmp_ne_u32 vcc, s60, v60
    s_nop 4
    s_cmp_eq_u64 vcc, 0
    s_cbranch_scc1 pf_75_done
    s_sleep 1
    buffer_load_dword v60, v59, s[4:7], 0 offen sc1
    s_waitcnt vmcnt(0)
    s_sub_u32 s61, s61, 1
    s_cmp_lg_u32 s61, 0
    s_cbranch_scc1 pf_75_loop
pf_75_done:
    s_mov_b64 exec, s[52:53]
w0_74:
    s_barrier
    ds_read_b128 v[144:147], v13 offset:24576
    ds_read_b128 v[148:151], v13 offset:25600
    ds_read_b128 v[152:155], v13 offset:26624
    ds_read_b128 v[156:159], v13 offset:27648
    ds_read_b128 v[160:163], v13 offset:28672
    ds_read_b128 v[164:167], v13 offset:34816
    ds_read_b128 v[168:171], v13 offset:35840
    ds_read_b128 v[172:175], v13 offset:36864
    ds_read_b128 v[176:179], v13 offset:37888
    ds_read_b128 v[180:183], v13 offset:38912
    s_add_u32 m0, s68, 49152
    s_add_u32 s54, s67, 245760
    buffer_load_dwordx4 v56, s[4:7], s54 offen sc1 lds
    s_add_u32 m0, s68, 50176
    s_add_u32 s54, s67, 246784
    buffer_load_dwordx4 v56, s[4:7], s54 offen sc1 lds
    s_add_u32 m0, s68, 51200
    s_add_u32 s54, s67, 247808
    buffer_load_dwordx4 v56, s[4:7], s54 offen sc1 lds
    s_add_u32 m0, s68, 52224
    s_add_u32 s54, s67, 248832
    buffer_load_dwordx4 v56, s[4:7], s54 offen sc1 lds
    s_add_u32 m0, s68, 53248
    s_add_u32 s54, s67, 249856
    buffer_load_dwordx4 v56, s[4:7], s54 offen sc1 lds
    s_waitcnt lgkmcnt(5)
    v_mfma_f32_16x16x32_bf16 v[64:67], v[144:147], v[96:99], v[64:67]
    v_mfma_f32_16x16x32_bf16 v[68:71], v[148:151], v[96:99], v[68:71]
    v_mfma_f32_16x16x32_bf16 v[72:75], v[152:155], v[96:99], v[72:75]
    v_mfma_f32_16x16x32_bf16 v[76:79], v[156:159], v[96:99], v[76:79]
    v_mfma_f32_16x16x32_bf16 v[80:83], v[160:163], v[96:99], v[80:83]
    s_add_u32 s54, s69, 14221312
    buffer_load_dwordx4 v[96:99], v61, s[4:7], s54 offen sc1
    ds_read_b128 v[144:147], v13 offset:45056
    ds_read_b128 v[148:151], v13 offset:46080
    ds_read_b128 v[152:155], v13 offset:47104
    ds_read_b128 v[156:159], v13 offset:48128
    ds_read_b128 v[160:163], v13 offset:49152
    s_waitcnt lgkmcnt(5)
    v_mfma_f32_16x16x32_bf16 v[64:67], v[164:167], v[100:103], v[64:67]
    v_mfma_f32_16x16x32_bf16 v[68:71], v[168:171], v[100:103], v[68:71]
    v_mfma_f32_16x16x32_bf16 v[72:75], v[172:175], v[100:103], v[72:75]
    v_mfma_f32_16x16x32_bf16 v[76:79], v[176:179], v[100:103], v[76:79]
    v_mfma_f32_16x16x32_bf16 v[80:83], v[180:183], v[100:103], v[80:83]
    s_add_u32 s54, s69, 14483456
    buffer_load_dwordx4 v[100:103], v61, s[4:7], s54 offen sc1
    ds_read_b128 v[164:167], v13 offset:55296
    ds_read_b128 v[168:171], v13 offset:56320
    ds_read_b128 v[172:175], v13 offset:57344
    ds_read_b128 v[176:179], v13 offset:58368
    ds_read_b128 v[180:183], v13 offset:59392
    s_waitcnt lgkmcnt(5)
    v_mfma_f32_16x16x32_bf16 v[64:67], v[144:147], v[104:107], v[64:67]
    v_mfma_f32_16x16x32_bf16 v[68:71], v[148:151], v[104:107], v[68:71]
    v_mfma_f32_16x16x32_bf16 v[72:75], v[152:155], v[104:107], v[72:75]
    v_mfma_f32_16x16x32_bf16 v[76:79], v[156:159], v[104:107], v[76:79]
    v_mfma_f32_16x16x32_bf16 v[80:83], v[160:163], v[104:107], v[80:83]
    s_add_u32 s54, s69, 14745600
    buffer_load_dwordx4 v[104:107], v61, s[4:7], s54 offen sc1
    s_waitcnt lgkmcnt(0)
    v_mfma_f32_16x16x32_bf16 v[64:67], v[164:167], v[108:111], v[64:67]
    v_mfma_f32_16x16x32_bf16 v[68:71], v[168:171], v[108:111], v[68:71]
    v_mfma_f32_16x16x32_bf16 v[72:75], v[172:175], v[108:111], v[72:75]
    v_mfma_f32_16x16x32_bf16 v[76:79], v[176:179], v[108:111], v[76:79]
    v_mfma_f32_16x16x32_bf16 v[80:83], v[180:183], v[108:111], v[80:83]
    s_add_u32 s54, s69, 15007744
    buffer_load_dwordx4 v[108:111], v61, s[4:7], s54 offen sc1
    s_waitcnt vmcnt(9)
    s_barrier
    s_mov_b32 s24, s80
    s_and_b32 s25, s81, 0xffff
    s_mov_b32 s26, 2621440
    s_mov_b32 s27, 0x20000
    s_lshr_b32 s41, s3, 2
    s_and_b32 s42, s3, 3
    s_mul_i32 s43, s42, 5120
    v_add_u32 v2, s43, v56
    v_add_u32 v2, 49152, v2
    s_lshl_b32 s42, s42, 4
    v_and_b32 v184, 15, v1
    v_add_u32 v184, s42, v184
    v_lshrrev_b32 v185, 4, v1
    v_lshlrev_b32 v185, 3, v185
    s_mul_i32 s41, s41, 96
    v_add_u32 v185, s41, v185
    v_mul_u32_u24 v186, 160, v184
    v_add_u32 v186, v186, v185
    v_add_u32 v186, 131072, v186
    v_add_u32 v187, 141312, v185
    v_add_u32 v184, s66, v184
    v_mul_u32_u24 v184, 1280, v184
    v_add_u32 v190, v184, v185
    s_mul_i32 s43, s65, 160
    ds_read_b64 v[84:85], v186 offset:0
    ds_read_b64 v[90:91], v187 offset:0
    ds_read_b64 v[86:87], v186 offset:32
    ds_read_b64 v[92:93], v187 offset:32
    ds_read_b64 v[88:89], v186 offset:64
    ds_read_b64 v[94:95], v187 offset:64
    s_waitcnt lgkmcnt(0)
    v_lshlrev_b32 v192, 16, v84
    v_and_b32 v193, 0xffff0000, v84
    v_lshlrev_b32 v194, 16, v90
    v_and_b32 v195, 0xffff0000, v90
    v_add_f32 v192, v192, v194
    v_add_f32 v193, v193, v195
    v_lshlrev_b32 v196, 16, v85
    v_and_b32 v197, 0xffff0000, v85
    v_lshlrev_b32 v198, 16, v91
    v_and_b32 v199, 0xffff0000, v91
    v_add_f32 v196, v196, v198
    v_add_f32 v197, v197, v199
    v_lshlrev_b32 v200, 16, v86
    v_and_b32 v201, 0xffff0000, v86
    v_lshlrev_b32 v202, 16, v92
    v_and_b32 v203, 0xffff0000, v92
    v_add_f32 v200, v200, v202
    v_add_f32 v201, v201, v203
    v_lshlrev_b32 v204, 16, v87
    v_and_b32 v205, 0xffff0000, v87
    v_lshlrev_b32 v206, 16, v93
    v_and_b32 v207, 0xffff0000, v93
    v_add_f32 v204, v204, v206
    v_add_f32 v205, v205, v207
    v_lshlrev_b32 v208, 16, v88
    v_and_b32 v209, 0xffff0000, v88
    v_lshlrev_b32 v210, 16, v94
    v_and_b32 v211, 0xffff0000, v94
    v_add_f32 v208, v208, v210
    v_add_f32 v209, v209, v211
    v_lshlrev_b32 v212, 16, v89
    v_and_b32 v213, 0xffff0000, v89
    v_lshlrev_b32 v214, 16, v95
    v_and_b32 v215, 0xffff0000, v95
    v_add_f32 v212, v212, v214
    v_add_f32 v213, v213, v215
    s_lshr_b32 s41, s3, 2
    s_cmp_eq_u32 s41, 0
    s_cbranch_scc0 ra_76_1
    v_add_f32 v64, v64, v192
    v_add_f32 v65, v65, v193
    v_add_f32 v66, v66, v196
    v_add_f32 v67, v67, v197
    v_add_f32 v68, v68, v200
    v_add_f32 v69, v69, v201
    v_add_f32 v70, v70, v204
    v_add_f32 v71, v71, v205
    v_add_f32 v72, v72, v208
    v_add_f32 v73, v73, v209
    v_add_f32 v74, v74, v212
    v_add_f32 v75, v75, v213
    s_branch ra_76_e
ra_76_1:
    v_add_f32 v76, v76, v192
    v_add_f32 v77, v77, v193
    v_add_f32 v78, v78, v196
    v_add_f32 v79, v79, v197
    v_add_f32 v80, v80, v200
    v_add_f32 v81, v81, v201
    v_add_f32 v82, v82, v204
    v_add_f32 v83, v83, v205
ra_76_e:
    s_nop 1
    ds_read_b128 v[144:147], v12 offset:0
    ds_read_b128 v[148:151], v12 offset:1024
    ds_read_b128 v[152:155], v12 offset:2048
    ds_read_b128 v[156:159], v12 offset:3072
    ds_read_b128 v[160:163], v12 offset:4096
    ds_read_b128 v[164:167], v12 offset:10240
    ds_read_b128 v[168:171], v12 offset:11264
    ds_read_b128 v[172:175], v12 offset:12288
    ds_read_b128 v[176:179], v12 offset:13312
    ds_read_b128 v[180:183], v12 offset:14336
    s_add_u32 m0, s68, 90112
    s_add_u32 s54, s67, 286720
    buffer_load_dwordx4 v56, s[4:7], s54 offen sc1 lds
    s_add_u32 m0, s68, 91136
    s_add_u32 s54, s67, 287744
    buffer_load_dwordx4 v56, s[4:7], s54 offen sc1 lds
    s_add_u32 m0, s68, 92160
    s_add_u32 s54, s67, 288768
    buffer_load_dwordx4 v56, s[4:7], s54 offen sc1 lds
    s_add_u32 m0, s68, 93184
    s_add_u32 s54, s67, 289792
    buffer_load_dwordx4 v56, s[4:7], s54 offen sc1 lds
    s_add_u32 m0, s68, 94208
    s_add_u32 s54, s67, 290816
    buffer_load_dwordx4 v56, s[4:7], s54 offen sc1 lds
    s_waitcnt lgkmcnt(5)
    v_mfma_f32_16x16x32_bf16 v[64:67], v[144:147], v[112:115], v[64:67]
    v_mfma_f32_16x16x32_bf16 v[68:71], v[148:151], v[112:115], v[68:71]
    v_mfma_f32_16x16x32_bf16 v[72:75], v[152:155], v[112:115], v[72:75]
    v_mfma_f32_16x16x32_bf16 v[76:79], v[156:159], v[112:115], v[76:79]
    v_mfma_f32_16x16x32_bf16 v[80:83], v[160:163], v[112:115], v[80:83]
    s_add_u32 s54, s69, 15269888
    buffer_load_dwordx4 v[112:115], v61, s[4:7], s54 offen sc1
    ds_read_b128 v[144:147], v12 offset:20480
    ds_read_b128 v[148:151], v12 offset:21504
    ds_read_b128 v[152:155], v12 offset:22528
    ds_read_b128 v[156:159], v12 offset:23552
    ds_read_b128 v[160:163], v12 offset:24576
    s_waitcnt lgkmcnt(5)
    v_mfma_f32_16x16x32_bf16 v[64:67], v[164:167], v[116:119], v[64:67]
    v_mfma_f32_16x16x32_bf16 v[68:71], v[168:171], v[116:119], v[68:71]
    v_mfma_f32_16x16x32_bf16 v[72:75], v[172:175], v[116:119], v[72:75]
    v_mfma_f32_16x16x32_bf16 v[76:79], v[176:179], v[116:119], v[76:79]
    v_mfma_f32_16x16x32_bf16 v[80:83], v[180:183], v[116:119], v[80:83]
    s_add_u32 s54, s69, 15532032
    buffer_load_dwordx4 v[116:119], v61, s[4:7], s54 offen sc1
    ds_read_b128 v[164:167], v12 offset:30720
    ds_read_b128 v[168:171], v12 offset:31744
    ds_read_b128 v[172:175], v12 offset:32768
    ds_read_b128 v[176:179], v12 offset:33792
    ds_read_b128 v[180:183], v12 offset:34816
    s_waitcnt lgkmcnt(5)
    v_mfma_f32_16x16x32_bf16 v[64:67], v[144:147], v[120:123], v[64:67]
    v_mfma_f32_16x16x32_bf16 v[68:71], v[148:151], v[120:123], v[68:71]
    v_mfma_f32_16x16x32_bf16 v[72:75], v[152:155], v[120:123], v[72:75]
    v_mfma_f32_16x16x32_bf16 v[76:79], v[156:159], v[120:123], v[76:79]
    v_mfma_f32_16x16x32_bf16 v[80:83], v[160:163], v[120:123], v[80:83]
    s_add_u32 s54, s69, 15794176
    buffer_load_dwordx4 v[120:123], v61, s[4:7], s54 offen sc1
    s_waitcnt lgkmcnt(0)
    v_mfma_f32_16x16x32_bf16 v[64:67], v[164:167], v[124:127], v[64:67]
    v_mfma_f32_16x16x32_bf16 v[68:71], v[168:171], v[124:127], v[68:71]
    v_mfma_f32_16x16x32_bf16 v[72:75], v[172:175], v[124:127], v[72:75]
    v_mfma_f32_16x16x32_bf16 v[76:79], v[176:179], v[124:127], v[76:79]
    v_mfma_f32_16x16x32_bf16 v[80:83], v[180:183], v[124:127], v[80:83]
    s_add_u32 s54, s69, 16056320
    buffer_load_dwordx4 v[124:127], v61, s[4:7], s54 offen sc1
    s_waitcnt vmcnt(9)
    s_barrier
    s_cmp_ge_u32 s3, 4
    s_cbranch_scc1 p3skip_77
    s_add_u32 m0, s68, 0
    s_add_u32 s40, s67, 327680
    buffer_load_dwordx4 v56, s[4:7], s40 offen sc1 lds
    s_add_u32 m0, s68, 1024
    s_add_u32 s40, s67, 328704
    buffer_load_dwordx4 v56, s[4:7], s40 offen sc1 lds
    s_add_u32 m0, s68, 2048
    s_add_u32 s40, s67, 329728
    buffer_load_dwordx4 v56, s[4:7], s40 offen sc1 lds
    s_add_u32 m0, s68, 3072
    s_add_u32 s40, s67, 330752
    buffer_load_dwordx4 v56, s[4:7], s40 offen sc1 lds
    s_add_u32 m0, s68, 4096
    s_add_u32 s40, s67, 331776
    buffer_load_dwordx4 v56, s[4:7], s40 offen sc1 lds
p3skip_77:
    ds_read_b128 v[144:147], v12 offset:49152
    ds_read_b128 v[148:151], v12 offset:50176
    ds_read_b128 v[152:155], v12 offset:51200
    ds_read_b128 v[156:159], v12 offset:52224
    ds_read_b128 v[160:163], v12 offset:53248
    ds_read_b128 v[164:167], v12 offset:59392
    ds_read_b128 v[168:171], v12 offset:60416
    ds_read_b128 v[172:175], v12 offset:61440
    ds_read_b128 v[176:179], v12 offset:62464
    ds_read_b128 v[180:183], v12 offset:63488
    s_waitcnt lgkmcnt(5)
    v_mfma_f32_16x16x32_bf16 v[64:67], v[144:147], v[96:99], v[64:67]
    v_mfma_f32_16x16x32_bf16 v[68:71], v[148:151], v[96:99], v[68:71]
    v_mfma_f32_16x16x32_bf16 v[72:75], v[152:155], v[96:99], v[72:75]
    v_mfma_f32_16x16x32_bf16 v[76:79], v[156:159], v[96:99], v[76:79]
    v_mfma_f32_16x16x32_bf16 v[80:83], v[160:163], v[96:99], v[80:83]
    s_add_u32 s54, s70, 16318464
    buffer_load_dwordx2 v[96:97], v62, s[4:7], s54 offen sc1
    s_add_u32 s54, s54, 16384
    buffer_load_dwordx2 v[98:99], v62, s[4:7], s54 offen sc1
    ds_read_b128 v[144:147], v13 offset:4096
    ds_read_b128 v[148:151], v13 offset:5120
    ds_read_b128 v[152:155], v13 offset:6144
    ds_read_b128 v[156:159], v13 offset:7168
    ds_read_b128 v[160:163], v13 offset:8192
    s_waitcnt lgkmcnt(5)
    v_mfma_f32_16x16x32_bf16 v[64:67], v[164:167], v[100:103], v[64:67]
    v_mfma_f32_16x16x32_bf16 v[68:71], v[168:171], v[100:103], v[68:71]
    v_mfma_f32_16x16x32_bf16 v[72:75], v[172:175], v[100:103], v[72:75]
    v_mfma_f32_16x16x32_bf16 v[76:79], v[176:179], v[100:103], v[76:79]
    v_mfma_f32_16x16x32_bf16 v[80:83], v[180:183], v[100:103], v[80:83]
    s_add_u32 s54, s70, 16580608
    buffer_load_dwordx2 v[100:101], v62, s[4:7], s54 offen sc1
    s_add_u32 s54, s54, 16384
    buffer_load_dwordx2 v[102:103], v62, s[4:7], s54 offen sc1
    ds_read_b128 v[164:167], v13 offset:14336
    ds_read_b128 v[168:171], v13 offset:15360
    ds_read_b128 v[172:175], v13 offset:16384
    ds_read_b128 v[176:179], v13 offset:17408
    ds_read_b128 v[180:183], v13 offset:18432
    s_waitcnt lgkmcnt(5)
    v_mfma_f32_16x16x32_bf16 v[64:67], v[144:147], v[104:107], v[64:67]
    v_mfma_f32_16x16x32_bf16 v[68:71], v[148:151], v[104:107], v[68:71]
    v_mfma_f32_16x16x32_bf16 v[72:75], v[152:155], v[104:107], v[72:75]
    v_mfma_f32_16x16x32_bf16 v[76:79], v[156:159], v[104:107], v[76:79]
    v_mfma_f32_16x16x32_bf16 v[80:83], v[160:163], v[104:107], v[80:83]
    s_waitcnt lgkmcnt(0)
    v_mfma_f32_16x16x32_bf16 v[64:67], v[164:167], v[108:111], v[64:67]
    v_mfma_f32_16x16x32_bf16 v[68:71], v[168:171], v[108:111], v[68:71]
    v_mfma_f32_16x16x32_bf16 v[72:75], v[172:175], v[108:111], v[72:75]
    v_mfma_f32_16x16x32_bf16 v[76:79], v[176:179], v[108:111], v[76:79]
    v_mfma_f32_16x16x32_bf16 v[80:83], v[180:183], v[108:111], v[80:83]
    s_waitcnt vmcnt(4)
    s_barrier
    ds_read_b128 v[144:147], v13 offset:24576
    ds_read_b128 v[148:151], v13 offset:25600
    ds_read_b128 v[152:155], v13 offset:26624
    ds_read_b128 v[156:159], v13 offset:27648
    ds_read_b128 v[160:163], v13 offset:28672
    ds_read_b128 v[164:167], v13 offset:34816
    ds_read_b128 v[168:171], v13 offset:35840
    ds_read_b128 v[172:175], v13 offset:36864
    ds_read_b128 v[176:179], v13 offset:37888
    ds_read_b128 v[180:183], v13 offset:38912
    ds_read_b128 v[192:195], v13 offset:45056
    ds_read_b128 v[196:199], v13 offset:46080
    ds_read_b128 v[200:203], v13 offset:47104
    ds_read_b128 v[204:207], v13 offset:48128
    ds_read_b128 v[208:211], v13 offset:49152
    s_waitcnt lgkmcnt(10)
    v_mfma_f32_16x16x32_bf16 v[64:67], v[144:147], v[112:115], v[64:67]
    v_mfma_f32_16x16x32_bf16 v[68:71], v[148:151], v[112:115], v[68:71]
    v_mfma_f32_16x16x32_bf16 v[72:75], v[152:155], v[112:115], v[72:75]
    v_mfma_f32_16x16x32_bf16 v[76:79], v[156:159], v[112:115], v[76:79]
    v_mfma_f32_16x16x32_bf16 v[80:83], v[160:163], v[112:115], v[80:83]
    ds_read_b128 v[144:147], v13 offset:55296
    ds_read_b128 v[148:151], v13 offset:56320
    ds_read_b128 v[152:155], v13 offset:57344
    ds_read_b128 v[156:159], v13 offset:58368
    ds_read_b128 v[160:163], v13 offset:59392
    s_waitcnt lgkmcnt(10)
    v_mfma_f32_16x16x32_bf16 v[64:67], v[164:167], v[116:119], v[64:67]
    v_mfma_f32_16x16x32_bf16 v[68:71], v[168:171], v[116:119], v[68:71]
    v_mfma_f32_16x16x32_bf16 v[72:75], v[172:175], v[116:119], v[72:75]
    v_mfma_f32_16x16x32_bf16 v[76:79], v[176:179], v[116:119], v[76:79]
    v_mfma_f32_16x16x32_bf16 v[80:83], v[180:183], v[116:119], v[80:83]
    s_waitcnt lgkmcnt(5)
    v_mfma_f32_16x16x32_bf16 v[64:67], v[192:195], v[120:123], v[64:67]
    v_mfma_f32_16x16x32_bf16 v[68:71], v[196:199], v[120:123], v[68:71]
    v_mfma_f32_16x16x32_bf16 v[72:75], v[200:203], v[120:123], v[72:75]
    v_mfma_f32_16x16x32_bf16 v[76:79], v[204:207], v[120:123], v[76:79]
    v_mfma_f32_16x16x32_bf16 v[80:83], v[208:211], v[120:123], v[80:83]
    s_waitcnt lgkmcnt(0)
    v_mfma_f32_16x16x32_bf16 v[64:67], v[144:147], v[124:127], v[64:67]
    v_mfma_f32_16x16x32_bf16 v[68:71], v[148:151], v[124:127], v[68:71]
    v_mfma_f32_16x16x32_bf16 v[72:75], v[152:155], v[124:127], v[72:75]
    v_mfma_f32_16x16x32_bf16 v[76:79], v[156:159], v[124:127], v[76:79]
    v_mfma_f32_16x16x32_bf16 v[80:83], v[160:163], v[124:127], v[80:83]
    s_waitcnt vmcnt(0)
    s_barrier
    ds_read_b128 v[144:147], v12 offset:0
    ds_read_b128 v[148:151], v12 offset:1024
    ds_read_b128 v[152:155], v12 offset:2048
    ds_read_b128 v[156:159], v12 offset:3072
    ds_read_b128 v[160:163], v12 offset:4096
    ds_read_b128 v[164:167], v12 offset:10240
    ds_read_b128 v[168:171], v12 offset:11264
    ds_read_b128 v[172:175], v12 offset:12288
    ds_read_b128 v[176:179], v12 offset:13312
    ds_read_b128 v[180:183], v12 offset:14336
    s_waitcnt lgkmcnt(5)
    v_mfma_f32_16x16x32_bf16 v[64:67], v[144:147], v[96:99], v[64:67]
    v_mfma_f32_16x16x32_bf16 v[68:71], v[148:151], v[96:99], v[68:71]
    v_mfma_f32_16x16x32_bf16 v[72:75], v[152:155], v[96:99], v[72:75]
    v_mfma_f32_16x16x32_bf16 v[76:79], v[156:159], v[96:99], v[76:79]
    v_mfma_f32_16x16x32_bf16 v[80:83], v[160:163], v[96:99], v[80:83]
    s_waitcnt lgkmcnt(0)
    v_mfma_f32_16x16x32_bf16 v[64:67], v[164:167], v[100:103], v[64:67]
    v_mfma_f32_16x16x32_bf16 v[68:71], v[168:171], v[100:103], v[68:71]
    v_mfma_f32_16x16x32_bf16 v[72:75], v[172:175], v[100:103], v[72:75]
    v_mfma_f32_16x16x32_bf16 v[76:79], v[176:179], v[100:103], v[76:79]
    v_mfma_f32_16x16x32_bf16 v[80:83], v[180:183], v[100:103], v[80:83]
    s_lshr_b32 s41, s3, 2
    s_cmp_eq_u32 s41, 0
    s_nop 4
    s_cbranch_scc1 Lp3_k0
    ds_write_b128 v2, v[64:67] offset:0
    ds_write_b128 v2, v[68:71] offset:1024
    ds_write_b128 v2, v[72:75] offset:2048
    s_waitcnt lgkmcnt(0)
    s_barrier
    ds_read_b128 v[128:131], v2 offset:3072
    ds_read_b128 v[132:135], v2 offset:4096
    s_waitcnt lgkmcnt(1)
    v_pk_add_f32 v[76:77], v[76:77], v[128:129]
    v_pk_add_f32 v[78:79], v[78:79], v[130:131]
    v_cvt_pk_bf16_f32 v150, v76, v77
    v_cvt_pk_bf16_f32 v151, v78, v79
    buffer_store_dwordx2 v[150:151], v190, s[24:27], s43 offen offset:0
    s_waitcnt lgkmcnt(0)
    v_pk_add_f32 v[80:81], v[80:81], v[132:133]
    v_pk_add_f32 v[82:83], v[82:83], v[134:135]
    v_cvt_pk_bf16_f32 v152, v80, v81
    v_cvt_pk_bf16_f32 v153, v82, v83
    buffer_store_dwordx2 v[152:153], v190, s[24:27], s43 offen offset:32
    s_branch Lp3_end
Lp3_k0:
    ds_write_b128 v2, v[76:79] offset:3072
    ds_write_b128 v2, v[80:83] offset:4096
    s_waitcnt lgkmcnt(0)
    s_barrier
    ds_read_b128 v[128:131], v2 offset:0
    ds_read_b128 v[132:135], v2 offset:1024
    ds_read_b128 v[136:139], v2 offset:2048
    s_waitcnt lgkmcnt(2)
    v_pk_add_f32 v[64:65], v[64:65], v[128:129]
    v_pk_add_f32 v[66:67], v[66:67], v[130:131]
    v_cvt_pk_bf16_f32 v150, v64, v65
    v_cvt_pk_bf16_f32 v151, v66, v67
    buffer_store_dwordx2 v[150:151], v190, s[24:27], s43 offen offset:0
    s_waitcnt lgkmcnt(1)
    v_pk_add_f32 v[68:69], v[68:69], v[132:133]
    v_pk_add_f32 v[70:71], v[70:71], v[134:135]
    v_cvt_pk_bf16_f32 v152, v68, v69
    v_cvt_pk_bf16_f32 v153, v70, v71
    buffer_store_dwordx2 v[152:153], v190, s[24:27], s43 offen offset:32
    s_waitcnt lgkmcnt(0)
    v_pk_add_f32 v[72:73], v[72:73], v[136:137]
    v_pk_add_f32 v[74:75], v[74:75], v[138:139]
    v_cvt_pk_bf16_f32 v154, v72, v73
    v_cvt_pk_bf16_f32 v155, v74, v75
    buffer_store_dwordx2 v[154:155], v190, s[24:27], s43 offen offset:64
Lp3_end:
Lend:
    s_endpgm
Lcode_end:
.fill 576, 4, 0xBF800000
.section .rodata,"a"
.p2align 6
.amdhsa_kernel parallel_sum__sliding_block__mixer_channel_mlp__prompt_kernel
  .amdhsa_next_free_vgpr 256
  .amdhsa_next_free_sgpr 102
  .amdhsa_accum_offset 256
  .amdhsa_group_segment_fixed_size 0
  .amdhsa_kernarg_size 88
  .amdhsa_user_sgpr_count 2
  .amdhsa_user_sgpr_kernarg_segment_ptr 1
  .amdhsa_system_sgpr_workgroup_id_x 1
  .amdhsa_float_denorm_mode_32 3
  .amdhsa_float_denorm_mode_16_64 3
.end_amdhsa_kernel
```
